```python
import torch

def _softmax(x, axis=-1):
    return torch.softmax(x, dim=axis)
def _gelu(x):
    return torch.nn.functional.gelu(x, approximate="tanh")
def _silu(x):
    return torch.nn.functional.silu(x)
def _sigmoid(x):
    return torch.sigmoid(x)
def _layernorm(x, axis=-1, eps=1e-5):
    m = x.mean(dim=axis, keepdim=True)
    v = x.var(dim=axis, keepdim=True, unbiased=False)
    return (x - m) / torch.sqrt(v + eps)
def _scatter_add(tgt, idx, src, axis=0):
    return tgt.clone().index_add_(axis, idx, src)
def _segment_sum(src, seg, n):
    out = torch.zeros((n,) + src.shape[1:], dtype=src.dtype)
    return out.index_add_(0, seg, src)
def _pad(x, pw):
    flat = tuple(v for pair in reversed(pw) for v in pair)
    return torch.nn.functional.pad(x, flat)

kernel_name = 'recurrent_scan__ssm_conv_s4__dense_activation_gelu__prompt'

def setup_inputs():

    _w = (lambda a: (lambda t: t.to(torch.bfloat16) if t.is_floating_point() else t)(torch.as_tensor(a)))
    def _A_setup():
        B, L, D, N = 1, 2048, 640, 128
        A_re = -(lambda _x: torch.exp(torch.as_tensor(_x)))((lambda *s: torch.randn(*s, dtype=torch.bfloat16) * 6.4)(D, N))
        A_im = torch.pi * (lambda *s: torch.randn(*s, dtype=torch.bfloat16) * 0.2)(D, N)
        B_re = (lambda *s: torch.randn(*s, dtype=torch.bfloat16) * 0.2)(D, N)
        B_im = (lambda *s: torch.randn(*s, dtype=torch.bfloat16) * 0.2)(D, N)
        C_re = (lambda *s: torch.randn(*s, dtype=torch.bfloat16) * 0.2)(D, N)
        C_im = (lambda *s: torch.randn(*s, dtype=torch.bfloat16) * 0.2)(D, N)
        log_dt = (lambda *s: torch.randn(*s, dtype=torch.bfloat16) * 0.2)(D) * 0.5 - 4.0
        Dskip = (lambda *s: torch.randn(*s, dtype=torch.bfloat16) * 0.2)(D)
        return {
            "u": _w((lambda *s: torch.randn(*s, dtype=torch.bfloat16) * 0.05)(B, L, D)),
            "A_re": _w(A_re),
            "A_im": _w(A_im),
            "B_re": _w(B_re),
            "B_im": _w(B_im),
            "C_re": _w(C_re),
            "C_im": _w(C_im),
            "log_dt": _w(log_dt),
            "Dskip": _w(Dskip),
        }
    _A_in = _A_setup()

    def _B_setup():
        B, S, D, F = 1, 2048, 640, 1728
        return {
            "x": _w((lambda *s: torch.randn(*s, dtype=torch.bfloat16) * 0.05)(B, S, D)),
            "w1": _w((lambda *s: torch.randn(*s, dtype=torch.bfloat16) * 0.8)(D, F) * (D ** -0.5)),
            "b1": _w((lambda *s: torch.randn(*s, dtype=torch.bfloat16) * 0.1)(F) * 0.01),
            "w2": _w((lambda *s: torch.randn(*s, dtype=torch.bfloat16) * 0.1)(F, D) * (F ** -0.5)),
            "b2": _w((lambda *s: torch.randn(*s, dtype=torch.bfloat16) * 0.1)(D) * 0.01),
        }
    _B_in = _B_setup()

    return {
        "A_u": _A_in["u"],
        "A_A_re": _A_in["A_re"],
        "A_A_im": _A_in["A_im"],
        "A_B_re": _A_in["B_re"],
        "A_B_im": _A_in["B_im"],
        "A_C_re": _A_in["C_re"],
        "A_C_im": _A_in["C_im"],
        "A_log_dt": _A_in["log_dt"],
        "A_Dskip": _A_in["Dskip"],
        "B_x": _B_in["x"],
        "B_w1": _B_in["w1"],
        "B_b1": _B_in["b1"],
        "B_w2": _B_in["w2"],
        "B_b2": _B_in["b2"],
    }

def reference(A_u, A_A_re, A_A_im, A_B_re, A_B_im, A_C_re, A_C_im, A_log_dt, A_Dskip, B_x, B_w1, B_b1, B_w2, B_b2):
    def _A_ref(u, A_re, A_im, B_re, B_im, C_re, C_im, log_dt, Dskip):
        Bsz, L, D = u.shape
        dt = torch.exp(log_dt)[:, None]
        A = A_re + 1j * A_im
        Bc = B_re + 1j * B_im
        Cc = C_re + 1j * C_im
        logdA = dt * A
        dB = dt * Bc
        l = (lambda x, dt: x.to(dt))(torch.arange(L), A_re.dtype)
        P = torch.exp(logdA[:, :, None] * l[None, None, :])
        K = torch.einsum("dn,dnl,dn->dl", Cc, P, dB).real
        L2 = 2 * L
        Kp = _pad(K, ((0, 0), (0, L)))
        up = (lambda x, *d: x.permute(*d))(u, 0, 2, 1)
        up = _pad(up, ((0, 0), (0, 0), (0, L)))
        Kf = (lambda x, axes=(-2,-1): torch.fft.rfft2(x.float(), dim=axes))(Kp[:, None, :], axes=(-2, -1))
        Uf = (lambda x, axes=(-2,-1): torch.fft.rfft2(x.float(), dim=axes))(up[:, :, None, :], axes=(-2, -1))
        Yf = Uf * Kf[None, :, :, :]
        y = (lambda x, s, axes=(-2,-1): torch.fft.irfft2(x, s=s, dim=axes).to(torch.bfloat16))(Yf, (1, L2), axes=(-2, -1))[:, :, 0, :L]
        y = (lambda x, *d: x.permute(*d))(y, 0, 2, 1) + u * Dskip[None, None, :]
        return y

    def _B_ref(x, w1, b1, w2, b2):
        h = torch.einsum("bsd,df->bsf", x, w1) + b1
        h = _gelu(h)
        return torch.einsum("bsf,fd->bsd", h, w2) + b2

    x = A_u
    xn = _layernorm(x, axis=-1)
    s = _A_ref(xn, A_A_re, A_A_im, A_B_re, A_B_im, A_C_re, A_C_im, A_log_dt, A_Dskip)
    g = _silu(_B_ref(xn, B_w1, B_b1, B_w2, B_b2))
    return x + s * g
```

```asm
; @launch grid=(256,1,1) block=(256,1,1) lds=163840
.amdgcn_target "amdgcn-amd-amdhsa--gfx950"
.text
.globl recurrent_scan__ssm_conv_s4__dense_activation_gelu__prompt_kernel
.p2align 8
.type recurrent_scan__ssm_conv_s4__dense_activation_gelu__prompt_kernel,@function
recurrent_scan__ssm_conv_s4__dense_activation_gelu__prompt_kernel:
    s_load_dwordx16 s[4:19], s[0:1], 0
    s_load_dwordx16 s[20:35], s[0:1], 64
    s_load_dwordx2 s[36:37], s[0:1], 128
    s_cmp_ge_u32 s2, 256
    s_cbranch_scc1 L_end
    v_lshrrev_b32 v106, 5, v0
    s_and_b32 s3, s2, 7
    s_lshl_b32 s3, s3, 5
    s_lshr_b32 s77, s2, 3
    s_add_u32 s3, s3, s77
    s_mul_i32 s77, s3, 10240
    v_lshl_add_u32 v101, v106, 10, s77
    v_lshlrev_b32 v100, 8, v106
    v_sub_u32 v100, v101, v100
    v_lshl_add_u32 v100, v0, 4, v100
    v_lshl_add_u32 v101, v0, 3, v101
    s_getpc_b64 s[38:39]
    s_lshr_b32 s66, s2, 3
    s_mul_i32 s77, s66, 1536
    v_and_b32_e64 v1, 63, v0
    v_lshl_add_u32 v7, v0, 7, s77
    v_min_u32 v7, 0xb400, v7
    v_cmp_gt_u32 vcc, 12, v0
    s_nop 0
    s_and_saveexec_b64 s[96:97], vcc
    s_cbranch_execz L_nopf
    global_load_dword v127, v7, s[38:39]
L_nopf:
    s_mov_b64 exec, s[96:97]
    s_waitcnt lgkmcnt(0)
    global_load_dwordx4 v[84:87], v100, s[4:5]
    global_load_dwordx4 v[88:91], v100, s[4:5] offset:512
    global_load_dwordx2 v[92:93], v101, s[4:5] offset:1024
    v_lshrrev_b32 v6, 6, v0
    v_mov_b32 v3, 0
    v_mov_b32 v111, 0
    v_readfirstlane_b32 s64, v6
    s_add_u32 s40, s36, 0
    s_addc_u32 s41, s37, 0
    s_mov_b32 s42, 18874368
    s_mov_b32 s43, 0x20000
    s_and_b32 s65, s2, 7
    s_mul_i32 s69, s65, 40
    s_add_u32 s69, s69, s66
    s_sub_u32 s77, s66, 28
    s_lshl_b32 s77, s77, 1
    s_cmp_ge_u32 s66, 28
    s_cselect_b32 s77, s77, 0
    s_add_u32 s69, s69, s77
    s_lshl_b32 s77, s69, 9
    v_lshl_add_u32 v104, v0, 1, s77
    s_lshl_b32 s77, s69, 2
    s_and_b32 s78, s64, 2
    s_add_u32 s77, s77, s78
    v_mov_b32 v105, s77
    v_mov_b64 v[48:49], 0
    v_mov_b64 v[50:51], 0
    v_mov_b64 v[52:53], 0
    v_mov_b64_e64 v[54:55], 0
    global_load_short_d16_hi v48, v104, s[6:7]
    global_load_short_d16_hi v49, v104, s[8:9]
    global_load_short_d16_hi v50, v104, s[10:11]
    global_load_short_d16_hi v51, v104, s[12:13]
    global_load_short_d16_hi v52, v104, s[14:15]
    global_load_short_d16_hi v53, v104, s[16:17]
    global_load_short_d16_hi v54, v105, s[18:19]
    global_load_short_d16_hi v55, v105, s[20:21]
    buffer_load_dwordx2 v[94:95], v111, s[40:43], 0 offen sc1
    s_mov_b64 s[48:49], s[28:29]
    s_mov_b32 s50, 2211840
    s_mov_b32 s51, 0x20000
    v_lshrrev_b32 v112, 4, v1
    v_and_b32 v113, 15, v1
    v_lshlrev_b32 v114, 1, v112
    v_xor_b32_e64 v114, v114, v113
    v_mul_u32_u24 v102, 1280, v112
    v_lshl_add_u32 v102, v114, 4, v102
    v_xor_b32 v103, 128, v102
    v_add_u32 v103, 4096, v103
    s_mul_i32 s77, s2, 52429
    s_lshr_b32 s77, s77, 18
    s_mul_i32 s78, s77, 39680
    s_lshl_b32 s77, s2, 8
    s_add_u32 s77, s77, s78
    s_lshl_b32 s79, s64, 11
    s_add_u32 m0, s79, 69632
    s_mul_i32 s78, s64, 10240
    s_add_u32 s77, s77, s78
    buffer_load_dwordx4 v102, s[48:51], s77 offen lds
    buffer_load_dwordx4 v103, s[48:51], s77 offen offset:1024 lds
    s_sub_u32 s80, s2, 224
    s_cmp_ge_u32 s80, 14
    s_cbranch_scc1 L_j0
    s_add_u32 s80, s2, 32
    s_mul_i32 s77, s80, 52429
    s_lshr_b32 s77, s77, 18
    s_mul_i32 s78, s77, 39680
    s_lshl_b32 s77, s80, 8
    s_add_u32 s77, s77, s78
    s_lshl_b32 s79, s64, 11
    s_add_u32 m0, s79, 131072
    s_mul_i32 s78, s64, 10240
    s_add_u32 s77, s77, s78
    buffer_load_dwordx4 v102, s[48:51], s77 offen lds
    buffer_load_dwordx4 v103, s[48:51], s77 offen offset:1024 lds
L_j0:
    s_mov_b64 s[56:57], s[4:5]
    s_mov_b64 s[60:61], s[32:33]
    s_mov_b32 s58, 2621440
    s_mov_b32 s59, 0x20000
    s_lshl_b32 s96, s64, 12
    s_cmp_ge_u32 s66, 28
    s_cbranch_scc1 L_spare
    s_lshr_b32 s77, s65, 1
    s_lshl_b32 s77, s77, 2
    s_and_b32 s67, s66, 3
    s_add_u32 s67, s67, s77
    s_and_b32 s77, s65, 1
    s_mul_i32 s77, s77, 7
    s_lshr_b32 s68, s66, 2
    s_add_u32 s68, s68, s77
    v_lshlrev_b32 v114, 2, v112
    v_xor_b32 v114, v114, v113
    v_mul_u32_u24 v4, 3456, v112
    v_lshl_add_u32 v4, v114, 4, v4
    v_add_u32 v5, 12800, v4
    v_add_u32 v6, 25600, v4
    v_add_u32 v7, 38400, v4
    s_lshr_b32 s77, s65, 1
    s_mul_i32 s77, s77, 5
    s_lshr_b32 s77, s77, 1
    s_lshl_b32 s82, s77, 12
    s_mul_i32 s72, s64, 55296
    s_lshl_b32 s78, s68, 8
    s_add_u32 s72, s72, s78
    s_mov_b64 s[44:45], s[24:25]
    s_mov_b32 s46, 2211840
    s_mov_b32 s47, 0x20000
    s_mul_i32 s33, s82, 54
    s_add_u32 s33, s33, s72
    s_add_u32 m0, s96, 114688
    s_nop 0
    buffer_load_dwordx4 v4, s[44:47], s33 offen offset:0 lds
    buffer_load_dwordx4 v5, s[44:47], s33 offen offset:1024 lds
    buffer_load_dwordx4 v6, s[44:47], s33 offen offset:2048 lds
    buffer_load_dwordx4 v7, s[44:47], s33 offen offset:3072 lds
    s_mov_b64 s[52:53], s[26:27]
    s_mov_b32 s54, 3456
    s_mov_b32 s55, 0x20000
    s_lshl_b32 s27, s67, 2
    s_add_u32 s27, s27, s64
    s_mul_i32 s27, s27, 40960
    v_lshrrev_b32 v114, 3, v1
    v_mul_u32_u24 v252, 1280, v114
    v_and_b32 v114, 7, v1
    v_xor_b32 v114, v114, v112
    v_lshl_add_u32 v252, v114, 4, v252
    v_xor_b32_e64 v253, 64, v252
    v_add_u32 v253, 9216, v253
    v_add_u32 v254, 18432, v252
    v_add_u32 v255, 18432, v253
    s_add_u32 s77, s82, 4096
    s_sub_u32 s78, s77, 40960
    s_min_u32 s83, s77, s78
    s_add_u32 s77, s82, 8192
    s_sub_u32 s78, s77, 40960
    s_min_u32 s84, s77, s78
    s_add_u32 s77, s82, 12288
    s_sub_u32 s78, s77, 40960
    s_min_u32 s85, s77, s78
    s_add_u32 s77, s82, 16384
    s_sub_u32 s78, s77, 40960
    s_min_u32 s86, s77, s78
    s_add_u32 s77, s82, 20480
    s_sub_u32 s78, s77, 40960
    s_min_u32 s87, s77, s78
    s_add_u32 s77, s82, 24576
    s_sub_u32 s78, s77, 40960
    s_min_u32 s88, s77, s78
    s_add_u32 s77, s82, 28672
    s_sub_u32 s78, s77, 40960
    s_min_u32 s89, s77, s78
    s_add_u32 s77, s82, 32768
    s_sub_u32 s78, s77, 40960
    s_min_u32 s90, s77, s78
    s_add_u32 s77, s82, 36864
    s_sub_u32 s78, s77, 40960
    s_min_u32 s91, s77, s78
    v_lshlrev_b32 v2, 4, v1
    v_lshlrev_b32 v110, 2, v106
    v_and_b32 v107, 31, v0
    v_mul_u32_u24 v106, 1344, v106
    v_add_u32 v106, 98304, v106
    v_lshl_add_u32 v112, v107, 3, v106
    v_lshl_add_u32 v106, v107, 4, v106
    v_mov_b32 v107, v112
    s_lshl_b32 s77, s64, 7
    s_add_u32 s77, s77, 98304
    v_bfe_u32 v112, v1, 2, 2
    v_mul_u32_u24 v156, 1344, v112
    v_lshrrev_b32_e64 v113, 4, v1
    v_lshl_add_u32 v156, v113, 5, v156
    v_and_b32_e64 v114, 3, v1
    v_lshl_add_u32 v156, v114, 3, v156
    v_add_u32_e64 v156, s77, v156
    v_bfe_u32 v112, v1, 2, 3
    v_lshrrev_b32_e64 v113, 5, v1
    v_lshl_add_u32 v113, v113, 4, v112
    v_lshlrev_b32_e64 v113, 8, v113
    v_lshl_add_u32 v113, v114, 3, v113
    s_lshl_b32 s77, s64, 1
    v_xor_b32 v112, s77, v112
    v_lshl_add_u32 v158, v112, 5, v113
    v_add_u32 v158, 69632, v158
    v_xor_b32_e64 v159, 32, v158
    s_mov_b32 s62, 2621440
    s_mov_b32 s63, 0x20000
    s_mul_i32 s23, s3, 10240
    s_lshl_b32 s77, s64, 10
    s_add_u32 s23, s23, s77
    s_add_u32 s23, s23, 3670016
    s_add_u32 s35, s23, 4096
    s_add_u32 s29, s23, 8192
    s_lshl_b32 s34, s3, 5
    s_add_u32 s34, s34, 1048576
    s_lshl_b32 s22, s2, 2
    s_add_u32 s22, s22, s64
    s_lshl_b32 s22, s22, 11
    s_add_u32 s22, s22, 6291456
    s_add_u32 s32, s22, 262144
    s_lshr_b32 s28, s2, 2
    s_lshl_b32 s28, s28, 7
    s_and_b32 s77, s2, 3
    s_lshl_b32 s77, s77, 3
    s_add_u32 s28, s28, s77
    s_add_u32 s28, s28, 4096
    s_cmp_ge_u32 s64, 2
    s_cselect_b32 s77, 0x70000000, 0
    v_or_b32 v157, s77, v2
    s_lshr_b32 s75, s65, 1
    s_lshl_b32 s75, s75, 3
    s_lshr_b32 s77, s66, 2
    s_add_u32 s75, s75, s77
    s_and_b32 s76, s65, 1
    s_lshl_b32 s76, s76, 2
    s_and_b32 s77, s66, 3
    s_add_u32 s76, s76, s77
    s_lshr_b32 s79, s64, 1
    s_and_b32 s80, s64, 1
    s_lshl_b32 s73, s64, 8
    s_lshl_b32 s77, s79, 9
    v_lshrrev_b32 v112, 4, v1
    v_lshl_add_u32 v114, v112, 4, s77
    v_and_b32 v113, 15, v1
    v_add_u32 v28, 47, v113
    v_mul_u32_u24 v28, 1056, v28
    v_add_u32_e64 v28, v28, v114
    v_and_b32 v31, 127, v0
    s_mul_i32 s77, s79, 4112
    s_add_u32 s77, s77, 122880
    s_lshl_b32 s78, s80, 11
    s_add_u32 s95, s77, s78
    v_lshl_add_u32 v30, v1, 2, s95
    v_lshlrev_b32 v29, 5, v113
    v_sub_u32 v29, s77, v29
    s_cmp_eq_u32 s80, 0
    s_cbranch_scc0 L_adh1
    s_mov_b32 s36, 0x89abcdef
    s_mov_b32 s37, 0x01234567
    s_mov_b32 s38, 0x00477758
    s_mov_b32 s39, 0xbb122230
    s_mov_b32 s77, 0
    s_mov_b32 s95, 16
    v_lshl_add_u32 v29, v112, 3, v29
    v_add_u32 v29, 3552, v29
    s_branch L_adj
L_adh1:
    s_mov_b32 s36, 0x778999a6
    s_mov_b32 s37, 0x330444db
    s_mov_b32 s38, 0x556b0097
    s_mov_b32 s39, 0x223c448a
    s_mov_b32 s77, 22
    s_mov_b32 s95, 34
    v_lshlrev_b32 v115, 9, v112
    v_sub_u32_e64 v26, v29, v115
    v_add_u32 v26, 2016, v26
    v_and_b32 v115, 32, v1
    v_lshlrev_b32 v115, 4, v115
    v_sub_u32 v29, v29, v115
    v_and_b32 v115, 16, v1
    v_sub_u32_e64 v29, v29, v115
    v_add_u32 v29, 3056, v29
L_adj:
    v_lshlrev_b32_e64 v115, 2, v113
    v_lshrrev_b64 v[24:25], v115, s[36:37]
    v_lshrrev_b64 v[20:21], v115, s[38:39]
    v_and_b32 v24, 15, v24
    v_and_b32 v25, 15, v20
    v_add_u32 v24, s77, v24
    v_add_u32 v25, s95, v25
    v_mul_u32_u24 v24, 1056, v24
    v_mul_u32_u24 v25, 1056, v25
    v_add_u32 v24, v24, v114
    v_add_u32 v25, v25, v114
    s_lshr_b32 s33, s82, 5
    s_add_u32 s33, s33, s27
    s_add_u32 m0, s96, 81920
    s_nop 0
    buffer_load_dwordx4 v252, s[56:59], s33 offen offset:0 lds
    buffer_load_dwordx4 v253, s[56:59], s33 offen offset:1024 lds
    buffer_load_dwordx4 v254, s[56:59], s33 offen offset:2048 lds
    buffer_load_dwordx4 v255, s[56:59], s33 offen offset:3072 lds
    s_waitcnt vmcnt(19)
    v_lshlrev_b32_e64 v64, 16, v84
    v_and_b32 v65, 0xffff0000, v84
    v_lshlrev_b32_e64 v66, 16, v85
    v_and_b32 v67, 0xffff0000, v85
    v_lshlrev_b32_e64 v68, 16, v86
    v_and_b32 v69, 0xffff0000, v86
    v_lshlrev_b32_e64 v70, 16, v87
    v_and_b32 v71, 0xffff0000, v87
    v_lshlrev_b32_e64 v72, 16, v88
    v_and_b32 v73, 0xffff0000, v88
    v_lshlrev_b32_e64 v74, 16, v89
    v_and_b32 v75, 0xffff0000, v89
    v_lshlrev_b32_e64 v76, 16, v90
    v_and_b32 v77, 0xffff0000, v90
    v_lshlrev_b32_e64 v78, 16, v91
    v_and_b32 v79, 0xffff0000, v91
    v_lshlrev_b32_e64 v80, 16, v92
    v_and_b32 v81, 0xffff0000, v92
    v_lshlrev_b32_e64 v82, 16, v93
    v_and_b32 v83, 0xffff0000, v93
    v_pk_add_f32 v[120:121], v[64:65], v[66:67]
    v_pk_add_f32 v[120:121], v[120:121], v[68:69]
    v_pk_add_f32 v[120:121], v[120:121], v[70:71]
    v_pk_add_f32 v[120:121], v[120:121], v[72:73]
    v_pk_add_f32 v[120:121], v[120:121], v[74:75]
    v_pk_add_f32 v[120:121], v[120:121], v[76:77]
    v_pk_add_f32 v[120:121], v[120:121], v[78:79]
    v_pk_add_f32 v[120:121], v[120:121], v[80:81]
    v_pk_add_f32 v[120:121], v[120:121], v[82:83]
    v_add_f32 v120, v120, v121
    s_nop 1
    v_add_f32_dpp v120, v120, v120 row_ror:8 row_mask:0xf bank_mask:0xf
    s_nop 1
    v_add_f32_dpp v120, v120, v120 row_ror:4 row_mask:0xf bank_mask:0xf
    s_nop 1
    v_add_f32_dpp v120, v120, v120 row_ror:2 row_mask:0xf bank_mask:0xf
    s_nop 1
    v_add_f32_dpp v120, v120, v120 row_ror:1 row_mask:0xf bank_mask:0xf
    v_mov_b32 v121, v120
    s_nop 1
    v_permlane16_swap_b32 v120, v121
    v_add_f32_e64 v120, v120, v121
    v_mul_f32 v124, 0x3acccccd, v120
    v_pk_add_f32 v[64:65], v[64:65], v[124:125] op_sel_hi:[1,0] neg_lo:[0,1] neg_hi:[0,1]
    v_pk_add_f32 v[66:67], v[66:67], v[124:125] op_sel_hi:[1,0] neg_lo:[0,1] neg_hi:[0,1]
    v_pk_add_f32 v[68:69], v[68:69], v[124:125] op_sel_hi:[1,0] neg_lo:[0,1] neg_hi:[0,1]
    v_pk_add_f32 v[70:71], v[70:71], v[124:125] op_sel_hi:[1,0] neg_lo:[0,1] neg_hi:[0,1]
    v_pk_add_f32 v[72:73], v[72:73], v[124:125] op_sel_hi:[1,0] neg_lo:[0,1] neg_hi:[0,1]
    v_pk_add_f32 v[74:75], v[74:75], v[124:125] op_sel_hi:[1,0] neg_lo:[0,1] neg_hi:[0,1]
    v_pk_add_f32 v[76:77], v[76:77], v[124:125] op_sel_hi:[1,0] neg_lo:[0,1] neg_hi:[0,1]
    v_pk_add_f32 v[78:79], v[78:79], v[124:125] op_sel_hi:[1,0] neg_lo:[0,1] neg_hi:[0,1]
    v_pk_add_f32 v[80:81], v[80:81], v[124:125] op_sel_hi:[1,0] neg_lo:[0,1] neg_hi:[0,1]
    v_pk_add_f32 v[82:83], v[82:83], v[124:125] op_sel_hi:[1,0] neg_lo:[0,1] neg_hi:[0,1]
    v_pk_mul_f32 v[120:121], v[64:65], v[64:65]
    v_pk_fma_f32 v[120:121], v[66:67], v[66:67], v[120:121]
    v_pk_fma_f32 v[120:121], v[68:69], v[68:69], v[120:121]
    v_pk_fma_f32 v[120:121], v[70:71], v[70:71], v[120:121]
    v_pk_fma_f32 v[120:121], v[72:73], v[72:73], v[120:121]
    v_pk_fma_f32 v[120:121], v[74:75], v[74:75], v[120:121]
    v_pk_fma_f32 v[120:121], v[76:77], v[76:77], v[120:121]
    v_pk_fma_f32 v[120:121], v[78:79], v[78:79], v[120:121]
    v_pk_fma_f32 v[120:121], v[80:81], v[80:81], v[120:121]
    v_pk_fma_f32 v[120:121], v[82:83], v[82:83], v[120:121]
    v_add_f32 v120, v120, v121
    s_nop 1
    v_add_f32_dpp v120, v120, v120 row_ror:8 row_mask:0xf bank_mask:0xf
    s_nop 1
    v_add_f32_dpp v120, v120, v120 row_ror:4 row_mask:0xf bank_mask:0xf
    s_nop 1
    v_add_f32_dpp v120, v120, v120 row_ror:2 row_mask:0xf bank_mask:0xf
    s_nop 1
    v_add_f32_dpp v120, v120, v120 row_ror:1 row_mask:0xf bank_mask:0xf
    v_mov_b32 v121, v120
    s_nop 1
    v_permlane16_swap_b32 v120, v121
    v_add_f32_e64 v120, v120, v121
    v_mul_f32 v120, 0x3acccccd, v120
    v_cvt_pk_bf16_f32 v120, v120, v124
    v_and_b32 v125, 0xffff0000, v120
    v_lshlrev_b32_e64 v120, 16, v120
    v_add_f32 v120, 0x3727c5ac, v120
    v_cvt_pk_bf16_f32 v120, v120, v120
    v_lshlrev_b32 v120, 16, v120
    v_sqrt_f32 v120, v120
    v_lshrrev_b32 v126, 16, v125
    v_sub_f32 v125, v124, v125
    v_cvt_pk_bf16_f32 v120, v120, v120
    v_xor_b32 v126, 0x8000, v126
    v_lshlrev_b32 v120, 16, v120
    v_or_b32 v126, v126, v120
    v_rcp_f32 v120, v120
    s_nop 0
    v_mul_f32_e64 v122, v125, v120
    v_pk_fma_f32 v[64:65], v[64:65], v[120:121], v[122:123] op_sel_hi:[1,0,0]
    v_cvt_pk_bf16_f32 v84, v64, v65
    v_pk_fma_f32 v[66:67], v[66:67], v[120:121], v[122:123] op_sel_hi:[1,0,0]
    v_cvt_pk_bf16_f32 v85, v66, v67
    v_pk_fma_f32 v[68:69], v[68:69], v[120:121], v[122:123] op_sel_hi:[1,0,0]
    v_cvt_pk_bf16_f32 v86, v68, v69
    v_pk_fma_f32 v[70:71], v[70:71], v[120:121], v[122:123] op_sel_hi:[1,0,0]
    v_cvt_pk_bf16_f32 v87, v70, v71
    v_pk_fma_f32 v[72:73], v[72:73], v[120:121], v[122:123] op_sel_hi:[1,0,0]
    v_cvt_pk_bf16_f32 v88, v72, v73
    v_pk_fma_f32 v[74:75], v[74:75], v[120:121], v[122:123] op_sel_hi:[1,0,0]
    v_cvt_pk_bf16_f32 v89, v74, v75
    v_pk_fma_f32 v[76:77], v[76:77], v[120:121], v[122:123] op_sel_hi:[1,0,0]
    v_cvt_pk_bf16_f32 v90, v76, v77
    v_pk_fma_f32 v[78:79], v[78:79], v[120:121], v[122:123] op_sel_hi:[1,0,0]
    v_cvt_pk_bf16_f32 v91, v78, v79
    v_pk_fma_f32 v[80:81], v[80:81], v[120:121], v[122:123] op_sel_hi:[1,0,0]
    v_cvt_pk_bf16_f32 v92, v80, v81
    v_pk_fma_f32 v[82:83], v[82:83], v[120:121], v[122:123] op_sel_hi:[1,0,0]
    v_cvt_pk_bf16_f32 v93, v82, v83
    ds_write_b128 v106, v[84:87]
    ds_write_b128 v106, v[88:91] offset:512
    ds_write_b64 v107, v[92:93] offset:1024
    s_mov_b32 exec_lo, 1
    s_mov_b32 exec_hi, 1
    buffer_store_dword v126, v110, s[40:43], s34 offen sc1
    s_mov_b64 exec, -1
    s_mul_i32 s77, s64, 573440
    s_mul_i32 s78, s76, 5120
    s_add_u32 s77, s77, s78
    s_add_u32 s77, s77, 6291456
    v_add_u32_e64 v8, s77, v2
    v_add_u32 v9, 4096, v8
    s_cmp_eq_u32 s64, 3
    s_cselect_b32 s94, 0x70000000, 0
    s_mul_i32 s77, s75, 221184
    s_mul_i32 s78, s64, 14336
    s_add_u32 s77, s77, s78
    s_add_u32 s77, s77, 11272192
    v_add_u32 v10, s77, v2
    v_or_b32 v11, s94, v10
    v_lshrrev_b32 v12, 3, v1
    v_lshlrev_b32 v12, 12, v12
    v_and_b32_e64 v112, 7, v1
    v_lshl_add_u32 v12, v112, 4, v12
    s_mul_i32 s77, s76, 327680
    s_lshl_b32 s78, s75, 7
    s_add_u32 s77, s77, s78
    s_lshl_b32 s78, s64, 15
    s_add_u32 s77, s77, s78
    s_add_u32 s77, s77, 8650752
    v_add_u32 v12, s77, v12
    v_min_u32 v112, 39, v1
    v_mul_u32_u24 v113, 26, v112
    v_lshrrev_b32 v113, 8, v113
    v_mul_u32_u24 v114, 10, v113
    v_sub_u32 v114, v112, v114
    v_lshl_add_u32 v115, v113, 2, s64
    v_mul_u32_u24 v13, 1280, v115
    v_lshl_add_u32 v13, v114, 4, v13
    s_mul_i32 s77, s75, 81920
    s_mul_i32 s78, s76, 160
    s_add_u32 s77, s77, s78
    v_add_u32 v13, s77, v13
    v_cmp_gt_u32_e64 vcc, 40, v1
    v_mov_b32 v112, 0x70000000
    v_lshl_add_u32 v17, v114, 4, s78
    v_cndmask_b32_e64 v13, v112, v13, vcc
    v_mul_u32_u24 v15, 1040, v114
    v_and_b32_e64 v112, 1, v113
    v_lshl_add_u32 v15, v112, 3, v15
    v_lshrrev_b32_e64 v112, 1, v113
    v_lshl_add_u32 v15, v112, 6, v15
    s_lshl_b32 s77, s64, 4
    s_add_u32 s77, s77, 86016
    v_add_u32 v15, s77, v15
    v_lshrrev_b32_e64 v112, 1, v114
    v_mul_u32_u24 v14, 1040, v112
    v_lshl_add_u32 v14, v113, 6, v14
    v_and_b32_e64 v112, 1, v114
    v_lshl_add_u32 v14, v112, 5, v14
    s_lshl_b32 s77, s64, 8
    s_add_u32 s77, s77, 33792
    v_add_u32 v14, s77, v14
    s_mul_i32 s77, s64, 1040
    s_add_u32 s77, s77, 86016
    v_add_u32_e64 v16, s77, v2
    s_mul_i32 s77, s76, 40
    s_lshl_b32 s78, s64, 2
    s_add_u32 s77, s77, s78
    s_lshl_b32 s77, s77, 7
    s_add_u32 s77, s77, 163840
    s_cmp_lt_u32 s64, 2
    s_cselect_b32 s78, 2, 1
    v_lshrrev_b32 v112, 2, v1
    v_min_u32 v112, s78, v112
    v_lshl_add_u32 v19, v112, 11, s77
    v_and_b32_e64 v113, 3, v1
    v_lshl_add_u32 v19, v113, 7, v19
    s_mul_i32 s77, s75, 28
    s_mul_i32 s78, s64, 7
    s_lshr_b32 s78, s78, 1
    s_add_u32 s77, s77, s78
    s_lshl_b32 s77, s77, 7
    s_add_u32 s77, s77, 40960
    v_lshl_add_u32 v18, v113, 7, s77
    v_bfe_u32 v112, v1, 2, 1
    v_mul_u32_u24 v112, 1792, v112
    v_add_u32 v18, v18, v112
    s_lshr_b32 s79, s64, 1
    s_and_b32 s80, s64, 1
    v_lshrrev_b32 v112, 4, v1
    v_and_b32_e64 v113, 15, v1
    s_lshl_b32 s78, s80, 11
    s_mul_i32 s95, s79, 16640
    s_add_u32 s95, s95, 33792
    s_add_u32 s74, s95, s78
    v_mul_u32_u24 v42, 4160, v112
    v_lshl_add_u32 v42, v113, 2, v42
    v_lshrrev_b32 v114, 5, v1
    v_lshlrev_b32 v115, 2, v114
    v_sub_u32 v42, v42, v115
    s_add_u32 s77, s95, 4096
    v_add_u32 v42, s77, v42
    s_add_u32 s77, s80, 57
    v_min_u32_e64 v41, s77, v1
    s_mul_i32 s77, s64, 4640
    s_add_u32 s77, s77, 102912
    v_lshl_add_u32 v41, v41, 3, s77
    v_and_b32_e64 v115, 1, v1
    v_mul_u32_u24 v40, 9280, v115
    v_lshrrev_b32_e64 v39, 1, v1
    s_mul_i32 s33, s83, 54
    s_add_u32 s33, s33, s72
    s_add_u32 m0, s96, 131072
    s_nop 0
    buffer_load_dwordx4 v4, s[44:47], s33 offen offset:0 lds
    buffer_load_dwordx4 v5, s[44:47], s33 offen offset:1024 lds
    buffer_load_dwordx4 v6, s[44:47], s33 offen offset:2048 lds
    buffer_load_dwordx4 v7, s[44:47], s33 offen offset:3072 lds
    s_waitcnt vmcnt(13) lgkmcnt(0)
    s_barrier
    ds_read_b64_tr_b16 v[160:161], v156 offset:0
    ds_read_b64_tr_b16 v[162:163], v156 offset:5376
    ds_read_b64_tr_b16 v[164:165], v156 offset:512
    ds_read_b64_tr_b16 v[166:167], v156 offset:5888
    ds_read_b64_tr_b16 v[168:169], v156 offset:1024
    ds_read_b64_tr_b16 v[170:171], v156 offset:6400
    ds_read_b64_tr_b16 v[148:149], v158 offset:0
    ds_read_b64_tr_b16 v[150:151], v158 offset:2048
    ds_read_b64_tr_b16 v[152:153], v159 offset:0
    ds_read_b64_tr_b16 v[154:155], v159 offset:2048
    v_readfirstlane_b32 s70, v94
    v_readfirstlane_b32 s71, v95
    s_nop 1
    s_mul_i32 s70, s70, 0x9E3779B1
    s_add_u32 s70, s70, 0x7F4A7C15
    s_add_u32 s71, s71, 1
    v_mov_b32 v22, s70
    v_mov_b32 v23, s71
    s_waitcnt lgkmcnt(8)
    buffer_store_dwordx4 v[160:163], v2, s[40:43], s23 offen sc1
    s_waitcnt lgkmcnt(6)
    buffer_store_dwordx4 v[164:167], v2, s[40:43], s35 offen sc1
    s_waitcnt lgkmcnt(4)
    buffer_store_dwordx4 v[168:171], v157, s[40:43], s29 offen sc1
    s_waitcnt lgkmcnt(0)
    buffer_store_dwordx4 v[148:151], v2, s[40:43], s22 offen sc1
    buffer_store_dwordx4 v[152:155], v2, s[40:43], s22 offen offset:1024 sc1
    s_lshl_b32 s77, s64, 6
    v_add_u32_e64 v39, s77, v39
    v_lshl_add_u32 v40, v39, 4, v40
    v_add_u32 v40, 102912, v40
    v_mul_u32_u24 v39, 10240, v39
    v_lshl_add_u32 v39, v115, 4, v39
    s_lshl_b32 s77, s69, 5
    s_add_u32 s77, s77, 3670016
    v_add_u32 v39, s77, v39
    s_lshl_b32 s78, s80, 8
    s_sub_u32 s95, s95, s78
    v_mul_u32_u24 v115, 4640, v115
    v_bfe_u32 v44, v1, 1, 3
    v_lshlrev_b32_e64 v44, 6, v44
    v_lshl_add_u32 v44, v112, 4, v44
    v_sub_u32_e64 v44, v44, v115
    s_mul_i32 s77, s79, 9280
    s_sub_u32 s77, s77, s78
    s_add_u32 s77, s77, 107824
    v_add_u32 v44, s77, v44
    v_and_b32 v115, 3, v1
    v_sub_u32 v43, 3, v115
    v_mul_u32_u24 v43, 4160, v43
    v_lshl_add_u32 v43, v112, 4, v43
    v_and_b32 v45, 12, v1
    v_lshlrev_b32 v45, 2, v45
    v_sub_u32_e64 v43, v43, v45
    s_add_u32 s77, s95, 304
    v_add_u32 v43, s77, v43
    v_and_b32 v45, 24, v1
    v_lshlrev_b32 v45, 1, v45
    v_and_b32 v46, 4, v1
    v_lshl_add_u32 v45, v46, 4, v45
    v_lshl_add_u32 v46, v114, 2, v115
    v_mul_u32_u24 v46, 264, v46
    v_add_u32_e64 v45, v45, v46
    s_mul_i32 s77, s79, 16896
    s_mul_i32 s78, s80, 4224
    s_add_u32 s77, s77, s78
    v_add_u32_e64 v45, s77, v45
    s_lshl_b32 s77, s64, 11
    s_add_u32 s77, s77, 4096
    v_lshrrev_b32_e64 v47, 2, v1
    v_lshl_add_u32 v47, v47, 7, s77
    v_lshl_add_u32 v47, v115, 3, v47
    v_mov_b64_e64 v[62:63], 0
    v_mul_f32 v96, 0x3fb8aa3b, v54
    v_exp_f32 v96, v96
    v_cmp_eq_u32 vcc, 48, v31
    v_cvt_pk_bf16_f32 v96, v96, v96
    v_lshlrev_b32 v96, 16, v96
    v_cndmask_b32 v55, 0, v55, vcc
    v_mul_f32 v97, v96, v48
    v_mul_f32 v98, v96, v49
    v_mul_f32 v97, 0x3fb8aa3b, v97
    v_mul_f32 v98, 0.15915494, v98
    v_exp_f32 v99, v97
    v_fract_f32 v100, v98
    v_cos_f32 v102, v100
    s_lshr_b32 s33, s83, 5
    s_add_u32 s33, s33, s27
    v_sin_f32 v103, v100
    v_mul_f32 v102, v99, v102
    v_mul_f32_e64 v103, v99, v103
    v_mul_f32 v99, 0x41800000, v97
    v_mul_f32 v100, 0x41800000, v98
    v_exp_f32 v99, v99
    v_fract_f32 v100, v100
    v_cos_f32 v104, v100
    v_sin_f32 v105, v100
    v_mul_f32 v104, v99, v104
    v_mul_f32 v105, v99, v105
    v_mul_f32 v99, 0x43800000, v97
    v_mul_f32 v100, 0x43800000, v98
    v_exp_f32 v99, v99
    v_fract_f32 v100, v100
    v_cos_f32 v106, v100
    v_sin_f32 v107, v100
    v_mul_f32 v106, v99, v106
    v_mul_f32 v107, v99, v107
    v_pk_mul_f32 v[108:109], v[50:51], v[52:53] op_sel:[0,0] op_sel_hi:[1,0]
    v_pk_fma_f32 v[114:115], v[50:51], v[52:53], v[108:109] op_sel:[1,1,0] op_sel_hi:[0,1,1] neg_lo:[1,0,0]
    v_pk_mul_f32 v[114:115], v[114:115], v[96:97] op_sel_hi:[1,0]
    v_cvt_pk_bf16_f32 v176, v114, -v115
    v_mov_b32 v223, 0x3f80
    s_add_u32 m0, s96, 32768
    v_cvt_pk_bf16_f32 v224, v104, v105
    v_pk_mul_f32 v[108:109], v[114:115], v[102:103] op_sel:[0,0] op_sel_hi:[1,0]
    v_pk_fma_f32 v[112:113], v[114:115], v[102:103], v[108:109] op_sel:[1,1,0] op_sel_hi:[0,1,1] neg_lo:[1,0,0]
    v_cvt_pk_bf16_f32 v177, v112, -v113
    v_pk_mul_f32 v[108:109], v[112:113], v[102:103] op_sel:[0,0] op_sel_hi:[1,0]
    v_pk_fma_f32 v[116:117], v[112:113], v[102:103], v[108:109] op_sel:[1,1,0] op_sel_hi:[0,1,1] neg_lo:[1,0,0]
    v_cvt_pk_bf16_f32 v178, v116, -v117
    v_pk_mul_f32 v[108:109], v[104:105], v[104:105] op_sel:[0,0] op_sel_hi:[1,0]
    v_pk_fma_f32 v[110:111], v[104:105], v[104:105], v[108:109] op_sel:[1,1,0] op_sel_hi:[0,1,1] neg_lo:[1,0,0]
    v_cvt_pk_bf16_f32 v225, v110, v111
    v_pk_mul_f32 v[108:109], v[116:117], v[102:103] op_sel:[0,0] op_sel_hi:[1,0]
    v_pk_fma_f32 v[112:113], v[116:117], v[102:103], v[108:109] op_sel:[1,1,0] op_sel_hi:[0,1,1] neg_lo:[1,0,0]
    v_cvt_pk_bf16_f32 v179, v112, -v113
    v_pk_mul_f32 v[108:109], v[110:111], v[104:105] op_sel:[0,0] op_sel_hi:[1,0]
    v_pk_fma_f32 v[110:111], v[110:111], v[104:105], v[108:109] op_sel:[1,1,0] op_sel_hi:[0,1,1] neg_lo:[1,0,0]
    v_cvt_pk_bf16_f32 v226, v110, v111
    v_pk_mul_f32 v[108:109], v[112:113], v[102:103] op_sel:[0,0] op_sel_hi:[1,0]
    v_pk_fma_f32 v[118:119], v[112:113], v[102:103], v[108:109] op_sel:[1,1,0] op_sel_hi:[0,1,1] neg_lo:[1,0,0]
    v_cvt_pk_bf16_f32 v180, v118, -v119
    v_pk_mul_f32 v[108:109], v[110:111], v[104:105] op_sel:[0,0] op_sel_hi:[1,0]
    v_pk_fma_f32 v[110:111], v[110:111], v[104:105], v[108:109] op_sel:[1,1,0] op_sel_hi:[0,1,1] neg_lo:[1,0,0]
    v_cvt_pk_bf16_f32 v227, v110, v111
    v_pk_mul_f32 v[108:109], v[118:119], v[102:103] op_sel:[0,0] op_sel_hi:[1,0]
    v_pk_fma_f32 v[112:113], v[118:119], v[102:103], v[108:109] op_sel:[1,1,0] op_sel_hi:[0,1,1] neg_lo:[1,0,0]
    buffer_load_dwordx4 v252, s[56:59], s33 offen offset:0 lds
    v_cvt_pk_bf16_f32 v181, v112, -v113
    v_pk_mul_f32 v[108:109], v[110:111], v[104:105] op_sel:[0,0] op_sel_hi:[1,0]
    v_pk_fma_f32 v[110:111], v[110:111], v[104:105], v[108:109] op_sel:[1,1,0] op_sel_hi:[0,1,1] neg_lo:[1,0,0]
    v_cvt_pk_bf16_f32 v228, v110, v111
    v_pk_mul_f32 v[108:109], v[112:113], v[102:103] op_sel:[0,0] op_sel_hi:[1,0]
    v_pk_fma_f32 v[120:121], v[112:113], v[102:103], v[108:109] op_sel:[1,1,0] op_sel_hi:[0,1,1] neg_lo:[1,0,0]
    v_cvt_pk_bf16_f32 v182, v120, -v121
    v_pk_mul_f32 v[108:109], v[110:111], v[104:105] op_sel:[0,0] op_sel_hi:[1,0]
    v_pk_fma_f32 v[110:111], v[110:111], v[104:105], v[108:109] op_sel:[1,1,0] op_sel_hi:[0,1,1] neg_lo:[1,0,0]
    v_cvt_pk_bf16_f32 v229, v110, v111
    v_pk_mul_f32 v[108:109], v[120:121], v[102:103] op_sel:[0,0] op_sel_hi:[1,0]
    v_pk_fma_f32 v[112:113], v[120:121], v[102:103], v[108:109] op_sel:[1,1,0] op_sel_hi:[0,1,1] neg_lo:[1,0,0]
    v_cvt_pk_bf16_f32 v183, v112, -v113
    v_pk_mul_f32 v[108:109], v[110:111], v[104:105] op_sel:[0,0] op_sel_hi:[1,0]
    v_pk_fma_f32 v[110:111], v[110:111], v[104:105], v[108:109] op_sel:[1,1,0] op_sel_hi:[0,1,1] neg_lo:[1,0,0]
    v_cvt_pk_bf16_f32 v230, v110, v111
    v_pk_mul_f32 v[108:109], v[112:113], v[102:103] op_sel:[0,0] op_sel_hi:[1,0]
    v_pk_fma_f32 v[122:123], v[112:113], v[102:103], v[108:109] op_sel:[1,1,0] op_sel_hi:[0,1,1] neg_lo:[1,0,0]
    v_cvt_pk_bf16_f32 v184, v122, -v123
    v_pk_mul_f32 v[108:109], v[110:111], v[104:105] op_sel:[0,0] op_sel_hi:[1,0]
    v_pk_fma_f32 v[110:111], v[110:111], v[104:105], v[108:109] op_sel:[1,1,0] op_sel_hi:[0,1,1] neg_lo:[1,0,0]
    v_cvt_pk_bf16_f32 v231, v110, v111
    v_pk_mul_f32 v[108:109], v[122:123], v[102:103] op_sel:[0,0] op_sel_hi:[1,0]
    v_pk_fma_f32 v[112:113], v[122:123], v[102:103], v[108:109] op_sel:[1,1,0] op_sel_hi:[0,1,1] neg_lo:[1,0,0]
    buffer_load_dwordx4 v253, s[56:59], s33 offen offset:1024 lds
    v_cvt_pk_bf16_f32 v185, v112, -v113
    v_pk_mul_f32 v[108:109], v[110:111], v[104:105] op_sel:[0,0] op_sel_hi:[1,0]
    v_pk_fma_f32 v[110:111], v[110:111], v[104:105], v[108:109] op_sel:[1,1,0] op_sel_hi:[0,1,1] neg_lo:[1,0,0]
    v_cvt_pk_bf16_f32 v232, v110, v111
    v_pk_mul_f32 v[108:109], v[112:113], v[102:103] op_sel:[0,0] op_sel_hi:[1,0]
    v_pk_fma_f32 v[124:125], v[112:113], v[102:103], v[108:109] op_sel:[1,1,0] op_sel_hi:[0,1,1] neg_lo:[1,0,0]
    v_cvt_pk_bf16_f32 v186, v124, -v125
    v_pk_mul_f32 v[108:109], v[110:111], v[104:105] op_sel:[0,0] op_sel_hi:[1,0]
    v_pk_fma_f32 v[110:111], v[110:111], v[104:105], v[108:109] op_sel:[1,1,0] op_sel_hi:[0,1,1] neg_lo:[1,0,0]
    v_cvt_pk_bf16_f32 v233, v110, v111
    v_pk_mul_f32 v[108:109], v[124:125], v[102:103] op_sel:[0,0] op_sel_hi:[1,0]
    v_pk_fma_f32 v[112:113], v[124:125], v[102:103], v[108:109] op_sel:[1,1,0] op_sel_hi:[0,1,1] neg_lo:[1,0,0]
    v_cvt_pk_bf16_f32 v187, v112, -v113
    v_pk_mul_f32 v[108:109], v[110:111], v[104:105] op_sel:[0,0] op_sel_hi:[1,0]
    v_pk_fma_f32 v[110:111], v[110:111], v[104:105], v[108:109] op_sel:[1,1,0] op_sel_hi:[0,1,1] neg_lo:[1,0,0]
    v_cvt_pk_bf16_f32 v234, v110, v111
    v_pk_mul_f32 v[108:109], v[112:113], v[102:103] op_sel:[0,0] op_sel_hi:[1,0]
    v_pk_fma_f32 v[126:127], v[112:113], v[102:103], v[108:109] op_sel:[1,1,0] op_sel_hi:[0,1,1] neg_lo:[1,0,0]
    v_cvt_pk_bf16_f32 v188, v126, -v127
    v_pk_mul_f32 v[108:109], v[110:111], v[104:105] op_sel:[0,0] op_sel_hi:[1,0]
    v_pk_fma_f32 v[110:111], v[110:111], v[104:105], v[108:109] op_sel:[1,1,0] op_sel_hi:[0,1,1] neg_lo:[1,0,0]
    v_cvt_pk_bf16_f32 v235, v110, v111
    v_pk_mul_f32 v[108:109], v[126:127], v[102:103] op_sel:[0,0] op_sel_hi:[1,0]
    v_pk_fma_f32 v[112:113], v[126:127], v[102:103], v[108:109] op_sel:[1,1,0] op_sel_hi:[0,1,1] neg_lo:[1,0,0]
    buffer_load_dwordx4 v254, s[56:59], s33 offen offset:2048 lds
    v_cvt_pk_bf16_f32 v189, v112, -v113
    v_pk_mul_f32 v[108:109], v[110:111], v[104:105] op_sel:[0,0] op_sel_hi:[1,0]
    v_pk_fma_f32 v[110:111], v[110:111], v[104:105], v[108:109] op_sel:[1,1,0] op_sel_hi:[0,1,1] neg_lo:[1,0,0]
    v_cvt_pk_bf16_f32 v236, v110, v111
    v_pk_mul_f32 v[108:109], v[112:113], v[102:103] op_sel:[0,0] op_sel_hi:[1,0]
    v_pk_fma_f32 v[128:129], v[112:113], v[102:103], v[108:109] op_sel:[1,1,0] op_sel_hi:[0,1,1] neg_lo:[1,0,0]
    v_cvt_pk_bf16_f32 v190, v128, -v129
    v_pk_mul_f32 v[108:109], v[110:111], v[104:105] op_sel:[0,0] op_sel_hi:[1,0]
    v_pk_fma_f32 v[110:111], v[110:111], v[104:105], v[108:109] op_sel:[1,1,0] op_sel_hi:[0,1,1] neg_lo:[1,0,0]
    v_cvt_pk_bf16_f32 v237, v110, v111
    v_pk_mul_f32 v[108:109], v[128:129], v[102:103] op_sel:[0,0] op_sel_hi:[1,0]
    v_pk_fma_f32 v[112:113], v[128:129], v[102:103], v[108:109] op_sel:[1,1,0] op_sel_hi:[0,1,1] neg_lo:[1,0,0]
    v_cvt_pk_bf16_f32 v191, v112, -v113
    v_pk_mul_f32 v[108:109], v[110:111], v[104:105] op_sel:[0,0] op_sel_hi:[1,0]
    v_pk_fma_f32 v[110:111], v[110:111], v[104:105], v[108:109] op_sel:[1,1,0] op_sel_hi:[0,1,1] neg_lo:[1,0,0]
    v_cvt_pk_bf16_f32 v238, v110, v111
    v_pk_mul_f32 v[108:109], v[112:113], v[102:103] op_sel:[0,0] op_sel_hi:[1,0]
    v_pk_fma_f32 v[130:131], v[112:113], v[102:103], v[108:109] op_sel:[1,1,0] op_sel_hi:[0,1,1] neg_lo:[1,0,0]
    v_pk_mul_f32 v[108:109], v[114:115], v[106:107] op_sel:[0,0] op_sel_hi:[1,0]
    v_pk_fma_f32 v[114:115], v[114:115], v[106:107], v[108:109] op_sel:[1,1,0] op_sel_hi:[0,1,1] neg_lo:[1,0,0]
    v_cvt_pk_bf16_f32 v203, v114, -v115
    v_pk_mul_f32 v[108:109], v[116:117], v[106:107] op_sel:[0,0] op_sel_hi:[1,0]
    v_pk_fma_f32 v[116:117], v[116:117], v[106:107], v[108:109] op_sel:[1,1,0] op_sel_hi:[0,1,1] neg_lo:[1,0,0]
    v_cvt_pk_bf16_f32 v193, v116, -v117
    buffer_load_dwordx4 v255, s[56:59], s33 offen offset:3072 lds
    v_pk_mul_f32 v[108:109], v[118:119], v[106:107] op_sel:[0,0] op_sel_hi:[1,0]
    v_pk_fma_f32 v[118:119], v[118:119], v[106:107], v[108:109] op_sel:[1,1,0] op_sel_hi:[0,1,1] neg_lo:[1,0,0]
    v_cvt_pk_bf16_f32 v194, v118, -v119
    v_pk_mul_f32 v[108:109], v[120:121], v[106:107] op_sel:[0,0] op_sel_hi:[1,0]
    v_pk_fma_f32 v[120:121], v[120:121], v[106:107], v[108:109] op_sel:[1,1,0] op_sel_hi:[0,1,1] neg_lo:[1,0,0]
    v_cvt_pk_bf16_f32 v195, v120, -v121
    v_pk_mul_f32 v[108:109], v[122:123], v[106:107] op_sel:[0,0] op_sel_hi:[1,0]
    v_pk_fma_f32 v[122:123], v[122:123], v[106:107], v[108:109] op_sel:[1,1,0] op_sel_hi:[0,1,1] neg_lo:[1,0,0]
    v_cvt_pk_bf16_f32 v192, v122, -v123
    v_pk_mul_f32 v[108:109], v[124:125], v[106:107] op_sel:[0,0] op_sel_hi:[1,0]
    v_pk_fma_f32 v[124:125], v[124:125], v[106:107], v[108:109] op_sel:[1,1,0] op_sel_hi:[0,1,1] neg_lo:[1,0,0]
    v_cvt_pk_bf16_f32 v196, v124, -v125
    v_pk_mul_f32 v[108:109], v[126:127], v[106:107] op_sel:[0,0] op_sel_hi:[1,0]
    v_pk_fma_f32 v[126:127], v[126:127], v[106:107], v[108:109] op_sel:[1,1,0] op_sel_hi:[0,1,1] neg_lo:[1,0,0]
    v_cvt_pk_bf16_f32 v199, v126, -v127
    v_pk_mul_f32 v[108:109], v[128:129], v[106:107] op_sel:[0,0] op_sel_hi:[1,0]
    v_pk_fma_f32 v[128:129], v[128:129], v[106:107], v[108:109] op_sel:[1,1,0] op_sel_hi:[0,1,1] neg_lo:[1,0,0]
    v_cvt_pk_bf16_f32 v197, v128, -v129
    v_pk_mul_f32 v[108:109], v[130:131], v[106:107] op_sel:[0,0] op_sel_hi:[1,0]
    v_pk_fma_f32 v[130:131], v[130:131], v[106:107], v[108:109] op_sel:[1,1,0] op_sel_hi:[0,1,1] neg_lo:[1,0,0]
    v_cvt_pk_bf16_f32 v200, v130, -v131
    v_pk_mul_f32 v[108:109], v[114:115], v[106:107] op_sel:[0,0] op_sel_hi:[1,0]
    v_pk_fma_f32 v[114:115], v[114:115], v[106:107], v[108:109] op_sel:[1,1,0] op_sel_hi:[0,1,1] neg_lo:[1,0,0]
    v_cvt_pk_bf16_f32 v204, v114, -v115
    s_lshr_b32 s33, s84, 5
    s_add_u32 s33, s33, s27
    v_pk_mul_f32 v[108:109], v[118:119], v[106:107] op_sel:[0,0] op_sel_hi:[1,0]
    v_pk_fma_f32 v[118:119], v[118:119], v[106:107], v[108:109] op_sel:[1,1,0] op_sel_hi:[0,1,1] neg_lo:[1,0,0]
    v_cvt_pk_bf16_f32 v208, v118, -v119
    v_pk_mul_f32 v[108:109], v[122:123], v[106:107] op_sel:[0,0] op_sel_hi:[1,0]
    v_pk_fma_f32 v[122:123], v[122:123], v[106:107], v[108:109] op_sel:[1,1,0] op_sel_hi:[0,1,1] neg_lo:[1,0,0]
    v_cvt_pk_bf16_f32 v207, v122, -v123
    v_pk_mul_f32 v[108:109], v[126:127], v[106:107] op_sel:[0,0] op_sel_hi:[1,0]
    v_pk_fma_f32 v[126:127], v[126:127], v[106:107], v[108:109] op_sel:[1,1,0] op_sel_hi:[0,1,1] neg_lo:[1,0,0]
    v_cvt_pk_bf16_f32 v206, v126, -v127
    v_pk_mul_f32 v[108:109], v[130:131], v[106:107] op_sel:[0,0] op_sel_hi:[1,0]
    v_pk_fma_f32 v[130:131], v[130:131], v[106:107], v[108:109] op_sel:[1,1,0] op_sel_hi:[0,1,1] neg_lo:[1,0,0]
    v_cvt_pk_bf16_f32 v205, v130, -v131
    v_pk_mul_f32 v[108:109], v[114:115], v[106:107] op_sel:[0,0] op_sel_hi:[1,0]
    v_pk_fma_f32 v[114:115], v[114:115], v[106:107], v[108:109] op_sel:[1,1,0] op_sel_hi:[0,1,1] neg_lo:[1,0,0]
    v_cvt_pk_bf16_f32 v209, v114, -v115
    v_pk_mul_f32 v[108:109], v[118:119], v[106:107] op_sel:[0,0] op_sel_hi:[1,0]
    v_pk_fma_f32 v[118:119], v[118:119], v[106:107], v[108:109] op_sel:[1,1,0] op_sel_hi:[0,1,1] neg_lo:[1,0,0]
    v_cvt_pk_bf16_f32 v211, v118, -v119
    v_pk_mul_f32 v[108:109], v[122:123], v[106:107] op_sel:[0,0] op_sel_hi:[1,0]
    v_pk_fma_f32 v[122:123], v[122:123], v[106:107], v[108:109] op_sel:[1,1,0] op_sel_hi:[0,1,1] neg_lo:[1,0,0]
    v_cvt_pk_bf16_f32 v202, v122, -v123
    v_pk_mul_f32 v[108:109], v[126:127], v[106:107] op_sel:[0,0] op_sel_hi:[1,0]
    v_pk_fma_f32 v[126:127], v[126:127], v[106:107], v[108:109] op_sel:[1,1,0] op_sel_hi:[0,1,1] neg_lo:[1,0,0]
    v_cvt_pk_bf16_f32 v198, v126, -v127
    s_add_u32 m0, s96, 49152
    v_pk_mul_f32 v[108:109], v[130:131], v[106:107] op_sel:[0,0] op_sel_hi:[1,0]
    v_pk_fma_f32 v[130:131], v[130:131], v[106:107], v[108:109] op_sel:[1,1,0] op_sel_hi:[0,1,1] neg_lo:[1,0,0]
    v_cvt_pk_bf16_f32 v201, v130, -v131
    v_pk_mul_f32 v[108:109], v[114:115], v[106:107] op_sel:[0,0] op_sel_hi:[1,0]
    v_pk_fma_f32 v[114:115], v[114:115], v[106:107], v[108:109] op_sel:[1,1,0] op_sel_hi:[0,1,1] neg_lo:[1,0,0]
    v_cvt_pk_bf16_f32 v217, v114, -v115
    v_pk_mul_f32 v[108:109], v[122:123], v[106:107] op_sel:[0,0] op_sel_hi:[1,0]
    v_pk_fma_f32 v[122:123], v[122:123], v[106:107], v[108:109] op_sel:[1,1,0] op_sel_hi:[0,1,1] neg_lo:[1,0,0]
    v_cvt_pk_bf16_f32 v219, v122, -v123
    v_pk_mul_f32 v[108:109], v[130:131], v[106:107] op_sel:[0,0] op_sel_hi:[1,0]
    v_pk_fma_f32 v[130:131], v[130:131], v[106:107], v[108:109] op_sel:[1,1,0] op_sel_hi:[0,1,1] neg_lo:[1,0,0]
    v_cvt_pk_bf16_f32 v210, v130, -v131
    v_pk_mul_f32 v[108:109], v[114:115], v[106:107] op_sel:[0,0] op_sel_hi:[1,0]
    v_pk_fma_f32 v[114:115], v[114:115], v[106:107], v[108:109] op_sel:[1,1,0] op_sel_hi:[0,1,1] neg_lo:[1,0,0]
    v_cvt_pk_bf16_f32 v221, v114, -v115
    v_pk_mul_f32 v[108:109], v[122:123], v[106:107] op_sel:[0,0] op_sel_hi:[1,0]
    v_pk_fma_f32 v[122:123], v[122:123], v[106:107], v[108:109] op_sel:[1,1,0] op_sel_hi:[0,1,1] neg_lo:[1,0,0]
    v_cvt_pk_bf16_f32 v216, v122, -v123
    v_pk_mul_f32 v[108:109], v[130:131], v[106:107] op_sel:[0,0] op_sel_hi:[1,0]
    v_pk_fma_f32 v[130:131], v[130:131], v[106:107], v[108:109] op_sel:[1,1,0] op_sel_hi:[0,1,1] neg_lo:[1,0,0]
    v_cvt_pk_bf16_f32 v215, v130, -v131
    v_pk_mul_f32 v[108:109], v[114:115], v[106:107] op_sel:[0,0] op_sel_hi:[1,0]
    v_pk_fma_f32 v[114:115], v[114:115], v[106:107], v[108:109] op_sel:[1,1,0] op_sel_hi:[0,1,1] neg_lo:[1,0,0]
    v_cvt_pk_bf16_f32 v220, v114, -v115
    buffer_load_dwordx4 v252, s[56:59], s33 offen offset:0 lds
    v_pk_mul_f32 v[108:109], v[122:123], v[106:107] op_sel:[0,0] op_sel_hi:[1,0]
    v_pk_fma_f32 v[122:123], v[122:123], v[106:107], v[108:109] op_sel:[1,1,0] op_sel_hi:[0,1,1] neg_lo:[1,0,0]
    v_cvt_pk_bf16_f32 v218, v122, -v123
    v_pk_mul_f32 v[108:109], v[130:131], v[106:107] op_sel:[0,0] op_sel_hi:[1,0]
    v_pk_fma_f32 v[130:131], v[130:131], v[106:107], v[108:109] op_sel:[1,1,0] op_sel_hi:[0,1,1] neg_lo:[1,0,0]
    v_cvt_pk_bf16_f32 v214, v130, -v131
    v_pk_mul_f32 v[108:109], v[114:115], v[106:107] op_sel:[0,0] op_sel_hi:[1,0]
    v_pk_fma_f32 v[114:115], v[114:115], v[106:107], v[108:109] op_sel:[1,1,0] op_sel_hi:[0,1,1] neg_lo:[1,0,0]
    v_cvt_pk_bf16_f32 v222, v114, -v115
    v_pk_mul_f32 v[108:109], v[122:123], v[106:107] op_sel:[0,0] op_sel_hi:[1,0]
    v_pk_fma_f32 v[122:123], v[122:123], v[106:107], v[108:109] op_sel:[1,1,0] op_sel_hi:[0,1,1] neg_lo:[1,0,0]
    v_cvt_pk_bf16_f32 v213, v122, -v123
    v_pk_mul_f32 v[108:109], v[130:131], v[106:107] op_sel:[0,0] op_sel_hi:[1,0]
    v_pk_fma_f32 v[130:131], v[130:131], v[106:107], v[108:109] op_sel:[1,1,0] op_sel_hi:[0,1,1] neg_lo:[1,0,0]
    v_cvt_pk_bf16_f32 v212, v130, -v131
    v_lshrrev_b32_e64 v96, 5, v1
    v_bfe_u32 v34, v1, 2, 2
    v_lshl_add_u32 v33, v96, 3, v34
    v_lshlrev_b32 v33, 8, v33
    v_xor_b32 v34, s64, v34
    v_lshl_add_u32 v33, v34, 6, v33
    v_and_b32_e64 v97, 3, v1
    v_lshl_add_u32 v33, v97, 3, v33
    v_bfe_u32 v97, v1, 4, 1
    buffer_load_dwordx4 v253, s[56:59], s33 offen offset:1024 lds
    v_lshl_add_u32 v33, v97, 5, v33
    v_add_u32 v33, 65536, v33
    v_xor_b32_e64 v34, 64, v33
    v_xor_b32 v35, 128, v33
    v_xor_b32 v36, 192, v33
    v_xor_b32 v97, v97, v1
    v_and_b32 v97, 1, v97
    v_add_u32_e64 v97, -1, v97
    v_and_b32 v97, 0x3f803f80, v97
    v_accvgpr_write_b32 a140, v97
    v_accvgpr_write_b32 a141, v97
    v_accvgpr_write_b32 a142, v97
    v_accvgpr_write_b32 a143, v97
    v_bfe_u32 v97, v1, 1, 3
    v_xor_b32 v97, v97, v96
    v_and_b32 v96, 31, v1
    v_lshlrev_b32_e64 v96, 7, v96
    v_lshl_add_u32 v96, v97, 4, v96
    s_add_u32 s77, s96, 32768
    v_add_u32 v32, s77, v96
    v_xor_b32 v38, 32, v32
    v_xor_b32_e64 v27, 64, v32
    v_xor_b32 v239, 96, v32
    s_lshr_b32 s79, s64, 1
    buffer_load_dwordx4 v254, s[56:59], s33 offen offset:2048 lds
    s_and_b32 s80, s64, 1
    v_lshrrev_b32 v48, 4, v1
    v_and_b32 v49, 15, v1
    s_lshl_b32 s78, s80, 11
    v_lshrrev_b32 v50, 5, v1
    s_lshl_b32 s77, s67, 2
    s_add_u32 s95, s77, s64
    s_mul_i32 s92, s95, 110592
    s_lshl_b32 s78, s68, 12
    s_add_u32 s92, s92, s78
    s_add_u32 s92, s92, 11272192
    s_mul_i32 s93, s95, 14
    s_add_u32 s93, s93, s68
    s_lshl_b32 s93, s93, 7
    s_add_u32 s93, s93, 40960
    s_lshl_b32 s77, s95, 7
    s_add_u32 s77, s77, 1048576
    v_and_b32_e64 v51, 31, v1
    v_lshl_add_u32 v52, v51, 2, s77
    s_lshl_b32 s77, s64, 7
    s_add_u32 s77, s77, 68608
    v_lshl_add_u32 v53, v49, 2, s77
    s_lshl_b32 s77, s68, 8
    v_lshl_add_u32 v37, v51, 1, s77
    buffer_load_dwordx4 v255, s[56:59], s33 offen offset:3072 lds
    v_and_b32_e64 v51, 1, v48
    v_mul_u32_u24 v46, 55296, v51
    v_lshl_add_u32 v46, v49, 4, v46
    v_lshl_add_u32 v46, v50, 8, v46
    s_cmp_eq_u32 s68, 13
    s_cselect_b32 s77, 0x70000000, 0
    s_cmp_ge_u32 s64, 2
    s_cselect_b32 s78, s77, 0
    s_sub_u32 s77, s77, s78
    v_or_b32 v54, s77, v46
    v_or_b32_e64 v46, s78, v46
    s_xor_b32 s77, s64, 0
    s_lshl_b32 s8, s77, 6
    s_lshl_b32 s77, s77, 10
    s_add_u32 s4, s92, s77
    s_xor_b32 s77, s64, 1
    s_lshl_b32 s9, s77, 6
    s_lshl_b32 s77, s77, 10
    s_add_u32 s5, s92, s77
    s_xor_b32 s77, s64, 2
    s_lshl_b32 s10, s77, 6
    s_lshl_b32 s77, s77, 10
    s_add_u32 s6, s92, s77
    s_xor_b32 s77, s64, 3
    s_lshl_b32 s11, s77, 6
    s_lshl_b32 s77, s77, 10
    s_add_u32 s7, s92, s77
    s_waitcnt vmcnt(18)
    ds_read_b128 a[72:75], v32 offset:49152
    ds_read_b128 a[76:79], v38 offset:49152
    ds_read_b128 a[80:83], v27 offset:49152
    ds_read_b128 a[84:87], v239 offset:49152
L_back_m:
    s_barrier
    ds_read_b64_tr_b16 v[128:129], v33 offset:49152
    ds_read_b64_tr_b16 v[130:131], v33 offset:50176
    ds_read_b64_tr_b16 v[132:133], v34 offset:49152
    ds_read_b64_tr_b16 v[134:135], v34 offset:50176
    ds_read_b64_tr_b16 v[136:137], v35 offset:49152
    ds_read_b64_tr_b16 v[138:139], v35 offset:50176
    ds_read_b64_tr_b16 v[140:141], v36 offset:49152
    ds_read_b64_tr_b16 v[142:143], v36 offset:50176
    ds_read_b64_tr_b16 v[144:145], v33 offset:53248
    ds_read_b64_tr_b16 v[146:147], v33 offset:54272
    ds_read_b64_tr_b16 v[148:149], v34 offset:53248
    ds_read_b64_tr_b16 v[150:151], v34 offset:54272
    s_waitcnt lgkmcnt(12)
    s_waitcnt lgkmcnt(8)
    v_mfma_f32_32x32x16_bf16 v[64:79], v[128:131], a[72:75], 0
    ds_read_b64_tr_b16 v[152:153], v35 offset:53248
    ds_read_b64_tr_b16 v[154:155], v35 offset:54272
    s_mul_i32 s33, s84, 54
    s_add_u32 s33, s33, s72
    s_add_u32 m0, s96, 147456
    s_nop 0
    buffer_load_dwordx4 v4, s[44:47], s33 offen offset:0 lds
    v_mfma_f32_32x32x16_bf16 v[80:95], v[132:135], a[72:75], 0
    ds_read_b64_tr_b16 v[156:157], v36 offset:53248
    ds_read_b64_tr_b16 v[158:159], v36 offset:54272
    buffer_load_dwordx4 v5, s[44:47], s33 offen offset:1024 lds
    v_accvgpr_write_b32 a122, 0
    v_accvgpr_write_b32 a123, 0
    v_mfma_f32_16x16x32_bf16 v[248:251], a[140:143], v[128:131], 0
    v_accvgpr_write_b32 a126, 0
    s_waitcnt lgkmcnt(8)
    v_mfma_f32_32x32x16_bf16 v[96:111], v[136:139], a[72:75], 0
    ds_read_b64_tr_b16 v[160:161], v33 offset:57344
    ds_read_b64_tr_b16 v[162:163], v33 offset:58368
    buffer_load_dwordx4 v6, s[44:47], s33 offen offset:2048 lds
    v_accvgpr_write_b32 a127, 0
    v_accvgpr_write_b32 a130, 0
    v_mfma_f32_32x32x16_bf16 v[112:127], v[140:143], a[72:75], 0
    ds_read_b64_tr_b16 v[164:165], v34 offset:57344
    ds_read_b64_tr_b16 v[166:167], v34 offset:58368
    buffer_load_dwordx4 v7, s[44:47], s33 offen offset:3072 lds
    v_accvgpr_write_b32 a131, 0
    v_accvgpr_write_b32 a134, 0
    s_waitcnt lgkmcnt(8)
    v_mfma_f32_32x32x16_bf16 v[64:79], v[144:147], a[76:79], v[64:79]
    ds_read_b64_tr_b16 v[168:169], v35 offset:57344
    ds_read_b64_tr_b16 v[170:171], v35 offset:58368
    s_lshr_b32 s33, s85, 5
    s_add_u32 s33, s33, s27
    s_add_u32 m0, s96, 81920
    v_accvgpr_write_b32 a135, 0
    v_mfma_f32_32x32x16_bf16 v[80:95], v[148:151], a[76:79], v[80:95]
    ds_read_b64_tr_b16 v[172:173], v36 offset:57344
    ds_read_b64_tr_b16 v[174:175], v36 offset:58368
    buffer_load_dwordx4 v252, s[56:59], s33 offen offset:0 lds
    v_accvgpr_write_b32 a138, 0
    v_accvgpr_write_b32 a139, 0
    v_mfma_f32_16x16x32_bf16 v[248:251], a[140:143], v[144:147], v[248:251]
    v_and_b32 v48, 16, v1
    s_waitcnt lgkmcnt(8)
    v_mfma_f32_32x32x16_bf16 v[96:111], v[152:155], a[76:79], v[96:111]
    ds_read_b64_tr_b16 v[128:129], v33 offset:61440
    ds_read_b64_tr_b16 v[130:131], v33 offset:62464
    buffer_load_dwordx4 v253, s[56:59], s33 offen offset:1024 lds
    v_lshl_add_u32 v48, v48, 2, v53
    v_xor_b32 v49, 128, v48
    v_mfma_f32_32x32x16_bf16 v[112:127], v[156:159], a[76:79], v[112:127]
    ds_read_b64_tr_b16 v[132:133], v34 offset:61440
    ds_read_b64_tr_b16 v[134:135], v34 offset:62464
    buffer_load_dwordx4 v254, s[56:59], s33 offen offset:2048 lds
    v_xor_b32 v50, 256, v48
    v_add_u32 v33, 0x00010000, v33
    s_waitcnt lgkmcnt(8)
    v_mfma_f32_32x32x16_bf16 v[64:79], v[160:163], a[80:83], v[64:79]
    ds_read_b64_tr_b16 v[136:137], v35 offset:61440
    ds_read_b64_tr_b16 v[138:139], v35 offset:62464
    s_waitcnt vmcnt(11)
    ds_read_b128 a[88:91], v32 offset:0
    v_xor_b32 v51, 384, v48
    v_add_u32 v34, 0x00010000, v34
    v_mfma_f32_32x32x16_bf16 v[80:95], v[164:167], a[80:83], v[80:95]
    ds_read_b64_tr_b16 v[140:141], v36 offset:61440
    ds_read_b64_tr_b16 v[142:143], v36 offset:62464
    s_barrier
    s_cmp_lg_u32 s64, 0
    s_cbranch_scc1 L_fs_1
    s_mov_b64 exec, 1
    buffer_store_dwordx2 v[22:23], v2, s[40:43], s28 offen sc1
    s_mov_b64 exec, -1
L_fs_1:
    v_mfma_f32_16x16x32_bf16 v[248:251], a[140:143], v[160:163], v[248:251]
    v_add_u32 v35, 0x00010000, v35
    s_waitcnt lgkmcnt(9)
    v_mfma_f32_32x32x16_bf16 v[96:111], v[168:171], a[80:83], v[96:111]
    ds_read_b64_tr_b16 v[144:145], v33 offset:0
    ds_read_b64_tr_b16 v[146:147], v33 offset:1024
    ds_read_b128 a[92:95], v38 offset:0
    buffer_load_dwordx4 v255, s[56:59], s33 offen offset:3072 lds
    v_add_u32 v36, 0x00010000, v36
    v_mfma_f32_32x32x16_bf16 v[112:127], v[172:175], a[80:83], v[112:127]
    ds_read_b64_tr_b16 v[148:149], v34 offset:0
    ds_read_b64_tr_b16 v[150:151], v34 offset:1024
    ds_read_b128 a[96:99], v27 offset:0
    s_mul_i32 s33, s85, 54
    s_add_u32 s33, s33, s72
    s_waitcnt lgkmcnt(11)
    v_mfma_f32_32x32x16_bf16 v[64:79], v[128:131], a[84:87], v[64:79]
    ds_read_b64_tr_b16 v[152:153], v35 offset:0
    ds_read_b64_tr_b16 v[154:155], v35 offset:1024
    ds_read_b128 a[100:103], v239 offset:0
    s_add_u32 m0, s96, 0
    s_nop 0
    buffer_load_dwordx4 v4, s[44:47], s33 offen offset:0 lds
    v_mfma_f32_32x32x16_bf16 v[80:95], v[132:135], a[84:87], v[80:95]
    ds_read_b64_tr_b16 v[156:157], v36 offset:0
    ds_read_b64_tr_b16 v[158:159], v36 offset:1024
    buffer_load_dwordx4 v5, s[44:47], s33 offen offset:1024 lds
    buffer_load_dwordx4 v6, s[44:47], s33 offen offset:2048 lds
    v_mfma_f32_16x16x32_bf16 v[248:251], a[140:143], v[128:131], v[248:251]
    s_waitcnt lgkmcnt(11)
    v_mfma_f32_32x32x16_bf16 v[96:111], v[136:139], a[84:87], v[96:111]
    ds_read_b64_tr_b16 v[160:161], v33 offset:4096
    ds_read_b64_tr_b16 v[162:163], v33 offset:5120
    buffer_load_dwordx4 v7, s[44:47], s33 offen offset:3072 lds
    s_mul_i32 s33, s86, 54
    s_add_u32 s33, s33, s72
    s_add_u32 m0, s96, 16384
    v_mfma_f32_32x32x16_bf16 v[112:127], v[140:143], a[84:87], v[112:127]
    ds_read_b64_tr_b16 v[164:165], v34 offset:4096
    ds_read_b64_tr_b16 v[166:167], v34 offset:5120
    buffer_load_dwordx4 v4, s[44:47], s33 offen offset:0 lds
    s_waitcnt lgkmcnt(6)
    v_mfma_f32_32x32x16_bf16 v[64:79], v[144:147], a[88:91], v[64:79]
    ds_read_b64_tr_b16 v[168:169], v35 offset:4096
    ds_read_b64_tr_b16 v[170:171], v35 offset:5120
    buffer_load_dwordx4 v5, s[44:47], s33 offen offset:1024 lds
    v_mfma_f32_32x32x16_bf16 v[80:95], v[148:151], a[88:91], v[80:95]
    ds_read_b64_tr_b16 v[172:173], v36 offset:4096
    ds_read_b64_tr_b16 v[174:175], v36 offset:5120
    v_mfma_f32_16x16x32_bf16 v[248:251], a[140:143], v[144:147], v[248:251]
    s_waitcnt lgkmcnt(8)
    v_mfma_f32_32x32x16_bf16 v[96:111], v[152:155], a[88:91], v[96:111]
    ds_read_b64_tr_b16 v[128:129], v33 offset:8192
    ds_read_b64_tr_b16 v[130:131], v33 offset:9216
    buffer_load_dwordx4 v6, s[44:47], s33 offen offset:2048 lds
    v_mfma_f32_32x32x16_bf16 v[112:127], v[156:159], a[88:91], v[112:127]
    ds_read_b64_tr_b16 v[132:133], v34 offset:8192
    ds_read_b64_tr_b16 v[134:135], v34 offset:9216
    buffer_load_dwordx4 v7, s[44:47], s33 offen offset:3072 lds
    s_lshr_b32 s33, s86, 5
    s_add_u32 s33, s33, s27
    s_waitcnt lgkmcnt(8)
    v_mfma_f32_32x32x16_bf16 v[64:79], v[160:163], a[92:95], v[64:79]
    ds_read_b64_tr_b16 v[136:137], v35 offset:8192
    ds_read_b64_tr_b16 v[138:139], v35 offset:9216
    s_add_u32 m0, s96, 32768
    s_nop 0
    buffer_load_dwordx4 v252, s[56:59], s33 offen offset:0 lds
    v_mfma_f32_32x32x16_bf16 v[80:95], v[164:167], a[92:95], v[80:95]
    ds_read_b64_tr_b16 v[140:141], v36 offset:8192
    ds_read_b64_tr_b16 v[142:143], v36 offset:9216
    v_mfma_f32_16x16x32_bf16 v[248:251], a[140:143], v[160:163], v[248:251]
    s_waitcnt lgkmcnt(8)
    v_mfma_f32_32x32x16_bf16 v[96:111], v[168:171], a[92:95], v[96:111]
    ds_read_b64_tr_b16 v[144:145], v33 offset:12288
    ds_read_b64_tr_b16 v[146:147], v33 offset:13312
    buffer_load_dwordx4 v253, s[56:59], s33 offen offset:1024 lds
    buffer_load_dwordx4 v254, s[56:59], s33 offen offset:2048 lds
    v_mfma_f32_32x32x16_bf16 v[112:127], v[172:175], a[92:95], v[112:127]
    ds_read_b64_tr_b16 v[148:149], v34 offset:12288
    ds_read_b64_tr_b16 v[150:151], v34 offset:13312
    s_waitcnt lgkmcnt(8)
    v_mfma_f32_32x32x16_bf16 v[64:79], v[128:131], a[96:99], v[64:79]
    ds_read_b64_tr_b16 v[152:153], v35 offset:12288
    ds_read_b64_tr_b16 v[154:155], v35 offset:13312
    s_waitcnt vmcnt(19)
    buffer_load_dwordx4 v255, s[56:59], s33 offen offset:3072 lds
    ds_read_b128 a[104:107], v32 offset:16384
    v_mfma_f32_32x32x16_bf16 v[80:95], v[132:135], a[96:99], v[80:95]
    ds_read_b64_tr_b16 v[156:157], v36 offset:12288
    ds_read_b64_tr_b16 v[158:159], v36 offset:13312
    s_waitcnt vmcnt(16)
    s_barrier
    ds_read_b128 a[108:111], v38 offset:16384
    v_mfma_f32_16x16x32_bf16 v[248:251], a[140:143], v[128:131], v[248:251]
    s_waitcnt lgkmcnt(10)
    v_mfma_f32_32x32x16_bf16 v[96:111], v[136:139], a[96:99], v[96:111]
    ds_read_b64_tr_b16 v[160:161], v33 offset:16384
    ds_read_b64_tr_b16 v[162:163], v33 offset:17408
    ds_read_b128 a[112:115], v27 offset:16384
    s_mul_i32 s33, s87, 54
    s_add_u32 s33, s33, s72
    s_add_u32 m0, s96, 65536
    v_mfma_f32_32x32x16_bf16 v[112:127], v[140:143], a[96:99], v[112:127]
    ds_read_b64_tr_b16 v[164:165], v34 offset:16384
    ds_read_b64_tr_b16 v[166:167], v34 offset:17408
    ds_read_b128 a[116:119], v239 offset:16384
    buffer_load_dwordx4 v4, s[44:47], s33 offen offset:0 lds
    s_waitcnt lgkmcnt(12)
    v_mfma_f32_32x32x16_bf16 v[64:79], v[144:147], a[100:103], v[64:79]
    ds_read_b64_tr_b16 v[168:169], v35 offset:16384
    ds_read_b64_tr_b16 v[170:171], v35 offset:17408
    buffer_load_dwordx4 v5, s[44:47], s33 offen offset:1024 lds
    v_mfma_f32_32x32x16_bf16 v[80:95], v[148:151], a[100:103], v[80:95]
    ds_read_b64_tr_b16 v[172:173], v36 offset:16384
    ds_read_b64_tr_b16 v[174:175], v36 offset:17408
    v_mfma_f32_16x16x32_bf16 v[248:251], a[140:143], v[144:147], v[248:251]
    s_waitcnt lgkmcnt(11)
    v_mfma_f32_32x32x16_bf16 v[96:111], v[152:155], a[100:103], v[96:111]
    ds_read_b64_tr_b16 v[128:129], v33 offset:20480
    ds_read_b64_tr_b16 v[130:131], v33 offset:21504
    buffer_load_dwordx4 v6, s[44:47], s33 offen offset:2048 lds
    v_mfma_f32_32x32x16_bf16 v[112:127], v[156:159], a[100:103], v[112:127]
    ds_read_b64_tr_b16 v[132:133], v34 offset:20480
    ds_read_b64_tr_b16 v[134:135], v34 offset:21504
    s_waitcnt lgkmcnt(8)
    v_mfma_f32_32x32x16_bf16 v[64:79], v[160:163], a[104:107], v[64:79]
    ds_read_b64_tr_b16 v[136:137], v35 offset:20480
    ds_read_b64_tr_b16 v[138:139], v35 offset:21504
    buffer_load_dwordx4 v7, s[44:47], s33 offen offset:3072 lds
    v_mfma_f32_32x32x16_bf16 v[80:95], v[164:167], a[104:107], v[80:95]
    ds_read_b64_tr_b16 v[140:141], v36 offset:20480
    ds_read_b64_tr_b16 v[142:143], v36 offset:21504
    s_lshr_b32 s33, s87, 5
    s_add_u32 s33, s33, s27
    s_add_u32 m0, s96, 49152
    v_mfma_f32_16x16x32_bf16 v[248:251], a[140:143], v[160:163], v[248:251]
    s_waitcnt lgkmcnt(8)
    v_mfma_f32_32x32x16_bf16 v[96:111], v[168:171], a[104:107], v[96:111]
    ds_read_b64_tr_b16 v[144:145], v33 offset:24576
    ds_read_b64_tr_b16 v[146:147], v33 offset:25600
    buffer_load_dwordx4 v252, s[56:59], s33 offen offset:0 lds
    v_mfma_f32_32x32x16_bf16 v[112:127], v[172:175], a[104:107], v[112:127]
    ds_read_b64_tr_b16 v[148:149], v34 offset:24576
    ds_read_b64_tr_b16 v[150:151], v34 offset:25600
    buffer_load_dwordx4 v253, s[56:59], s33 offen offset:1024 lds
    s_waitcnt lgkmcnt(8)
    v_mfma_f32_32x32x16_bf16 v[64:79], v[128:131], a[108:111], v[64:79]
    ds_read_b64_tr_b16 v[152:153], v35 offset:24576
    ds_read_b64_tr_b16 v[154:155], v35 offset:25600
    v_mfma_f32_32x32x16_bf16 v[80:95], v[132:135], a[108:111], v[80:95]
    ds_read_b64_tr_b16 v[156:157], v36 offset:24576
    ds_read_b64_tr_b16 v[158:159], v36 offset:25600
    v_mfma_f32_16x16x32_bf16 v[248:251], a[140:143], v[128:131], v[248:251]
    s_waitcnt lgkmcnt(8)
    v_mfma_f32_32x32x16_bf16 v[96:111], v[136:139], a[108:111], v[96:111]
    ds_read_b64_tr_b16 v[160:161], v33 offset:28672
    ds_read_b64_tr_b16 v[162:163], v33 offset:29696
    buffer_load_dwordx4 v254, s[56:59], s33 offen offset:2048 lds
    v_mfma_f32_32x32x16_bf16 v[112:127], v[140:143], a[108:111], v[112:127]
    ds_read_b64_tr_b16 v[164:165], v34 offset:28672
    ds_read_b64_tr_b16 v[166:167], v34 offset:29696
    buffer_load_dwordx4 v255, s[56:59], s33 offen offset:3072 lds
    v_add_u32 v33, 0xfffe0000, v33
    s_waitcnt lgkmcnt(8)
    v_mfma_f32_32x32x16_bf16 v[64:79], v[144:147], a[112:115], v[64:79]
    ds_read_b64_tr_b16 v[168:169], v35 offset:28672
    ds_read_b64_tr_b16 v[170:171], v35 offset:29696
    s_waitcnt vmcnt(20)
    ds_read_b128 a[72:75], v32 offset:49152
    v_add_u32 v34, 0xfffe0000, v34
    v_mfma_f32_32x32x16_bf16 v[80:95], v[148:151], a[112:115], v[80:95]
    ds_read_b64_tr_b16 v[172:173], v36 offset:28672
    ds_read_b64_tr_b16 v[174:175], v36 offset:29696
    s_waitcnt vmcnt(16)
    s_barrier
    ds_read_b128 a[76:79], v38 offset:49152
    v_mfma_f32_16x16x32_bf16 v[248:251], a[140:143], v[144:147], v[248:251]
    v_add_u32 v35, 0xfffe0000, v35
    s_waitcnt lgkmcnt(10)
    v_mfma_f32_32x32x16_bf16 v[96:111], v[152:155], a[112:115], v[96:111]
    ds_read_b64_tr_b16 v[128:129], v33 offset:0
    ds_read_b64_tr_b16 v[130:131], v33 offset:1024
    ds_read_b128 a[80:83], v27 offset:49152
    s_mul_i32 s33, s88, 54
    s_add_u32 s33, s33, s72
    v_add_u32 v36, 0xfffe0000, v36
    v_mfma_f32_32x32x16_bf16 v[112:127], v[156:159], a[112:115], v[112:127]
    ds_read_b64_tr_b16 v[132:133], v34 offset:0
    ds_read_b64_tr_b16 v[134:135], v34 offset:1024
    ds_read_b128 a[84:87], v239 offset:49152
    s_add_u32 m0, s96, 98304
    s_waitcnt lgkmcnt(12)
    v_mfma_f32_32x32x16_bf16 v[64:79], v[160:163], a[116:119], v[64:79]
    ds_read_b64_tr_b16 v[136:137], v35 offset:0
    ds_read_b64_tr_b16 v[138:139], v35 offset:1024
    buffer_load_dwordx4 v4, s[44:47], s33 offen offset:0 lds
    buffer_load_dwordx4 v5, s[44:47], s33 offen offset:1024 lds
    v_mfma_f32_32x32x16_bf16 v[80:95], v[164:167], a[116:119], v[80:95]
    ds_read_b64_tr_b16 v[140:141], v36 offset:0
    ds_read_b64_tr_b16 v[142:143], v36 offset:1024
    buffer_load_dwordx4 v6, s[44:47], s33 offen offset:2048 lds
    v_mfma_f32_16x16x32_bf16 v[248:251], a[140:143], v[160:163], v[248:251]
    s_waitcnt lgkmcnt(11)
    v_mfma_f32_32x32x16_bf16 v[96:111], v[168:171], a[116:119], v[96:111]
    ds_read_b64_tr_b16 v[144:145], v33 offset:4096
    ds_read_b64_tr_b16 v[146:147], v33 offset:5120
    v_mfma_f32_32x32x16_bf16 v[112:127], v[172:175], a[116:119], v[112:127]
    ds_read_b64_tr_b16 v[148:149], v34 offset:4096
    ds_read_b64_tr_b16 v[150:151], v34 offset:5120
    buffer_load_dwordx4 v7, s[44:47], s33 offen offset:3072 lds
    s_waitcnt lgkmcnt(8)
    v_mfma_f32_32x32x16_bf16 v[64:79], v[128:131], a[72:75], v[64:79]
    ds_read_b64_tr_b16 v[152:153], v35 offset:4096
    ds_read_b64_tr_b16 v[154:155], v35 offset:5120
    v_mfma_f32_32x32x16_bf16 v[80:95], v[132:135], a[72:75], v[80:95]
    ds_read_b64_tr_b16 v[156:157], v36 offset:4096
    ds_read_b64_tr_b16 v[158:159], v36 offset:5120
    buffer_load_ushort a121, v37, s[52:55], s8 offen
    buffer_load_ushort a125, v37, s[52:55], s9 offen
    buffer_load_ushort a129, v37, s[52:55], s10 offen
    buffer_load_ushort a133, v37, s[52:55], s11 offen
    v_mfma_f32_16x16x32_bf16 v[248:251], a[140:143], v[128:131], v[248:251]
    s_waitcnt lgkmcnt(8)
    v_mfma_f32_32x32x16_bf16 v[96:111], v[136:139], a[72:75], v[96:111]
    ds_read_b64_tr_b16 v[160:161], v33 offset:8192
    ds_read_b64_tr_b16 v[162:163], v33 offset:9216
    s_lshr_b32 s33, s88, 5
    s_add_u32 s33, s33, s27
    s_add_u32 m0, s96, 81920
    v_mfma_f32_32x32x16_bf16 v[112:127], v[140:143], a[72:75], v[112:127]
    ds_read_b64_tr_b16 v[164:165], v34 offset:8192
    ds_read_b64_tr_b16 v[166:167], v34 offset:9216
    buffer_load_dwordx4 v252, s[56:59], s33 offen offset:0 lds
    s_waitcnt lgkmcnt(8)
    v_mfma_f32_32x32x16_bf16 v[64:79], v[144:147], a[76:79], v[64:79]
    ds_read_b64_tr_b16 v[168:169], v35 offset:8192
    ds_read_b64_tr_b16 v[170:171], v35 offset:9216
    v_mfma_f32_32x32x16_bf16 v[80:95], v[148:151], a[76:79], v[80:95]
    ds_read_b64_tr_b16 v[172:173], v36 offset:8192
    ds_read_b64_tr_b16 v[174:175], v36 offset:9216
    buffer_load_dwordx4 v253, s[56:59], s33 offen offset:1024 lds
    v_mfma_f32_16x16x32_bf16 v[248:251], a[140:143], v[144:147], v[248:251]
    s_waitcnt lgkmcnt(8)
    v_mfma_f32_32x32x16_bf16 v[96:111], v[152:155], a[76:79], v[96:111]
    ds_read_b64_tr_b16 v[128:129], v33 offset:12288
    ds_read_b64_tr_b16 v[130:131], v33 offset:13312
    buffer_load_dwordx4 v254, s[56:59], s33 offen offset:2048 lds
    v_mfma_f32_32x32x16_bf16 v[112:127], v[156:159], a[76:79], v[112:127]
    ds_read_b64_tr_b16 v[132:133], v34 offset:12288
    ds_read_b64_tr_b16 v[134:135], v34 offset:13312
    s_waitcnt lgkmcnt(8)
    v_mfma_f32_32x32x16_bf16 v[64:79], v[160:163], a[80:83], v[64:79]
    ds_read_b64_tr_b16 v[136:137], v35 offset:12288
    ds_read_b64_tr_b16 v[138:139], v35 offset:13312
    s_waitcnt vmcnt(19)
    ds_read_b128 a[88:91], v32 offset:0
    ds_read_b128 a[92:95], v38 offset:0
    v_mfma_f32_32x32x16_bf16 v[80:95], v[164:167], a[80:83], v[80:95]
    ds_read_b64_tr_b16 v[140:141], v36 offset:12288
    ds_read_b64_tr_b16 v[142:143], v36 offset:13312
    s_waitcnt vmcnt(15)
    s_barrier
    ds_read_b128 a[96:99], v27 offset:0
    v_mfma_f32_16x16x32_bf16 v[248:251], a[140:143], v[160:163], v[248:251]
    s_waitcnt lgkmcnt(11)
    v_mfma_f32_32x32x16_bf16 v[96:111], v[168:171], a[80:83], v[96:111]
    ds_read_b64_tr_b16 v[144:145], v33 offset:16384
    ds_read_b64_tr_b16 v[146:147], v33 offset:17408
    ds_read_b128 a[100:103], v239 offset:0
    buffer_load_dwordx4 v255, s[56:59], s33 offen offset:3072 lds
    v_mfma_f32_32x32x16_bf16 v[112:127], v[172:175], a[80:83], v[112:127]
    ds_read_b64_tr_b16 v[148:149], v34 offset:16384
    ds_read_b64_tr_b16 v[150:151], v34 offset:17408
    s_mul_i32 s33, s89, 54
    s_add_u32 s33, s33, s72
    s_add_u32 m0, s96, 114688
    s_waitcnt lgkmcnt(12)
    v_mfma_f32_32x32x16_bf16 v[64:79], v[128:131], a[84:87], v[64:79]
    ds_read_b64_tr_b16 v[152:153], v35 offset:16384
    ds_read_b64_tr_b16 v[154:155], v35 offset:17408
    buffer_load_dwordx4 v4, s[44:47], s33 offen offset:0 lds
    v_mfma_f32_32x32x16_bf16 v[80:95], v[132:135], a[84:87], v[80:95]
    ds_read_b64_tr_b16 v[156:157], v36 offset:16384
    ds_read_b64_tr_b16 v[158:159], v36 offset:17408
    buffer_load_dwordx4 v5, s[44:47], s33 offen offset:1024 lds
    v_mfma_f32_16x16x32_bf16 v[248:251], a[140:143], v[128:131], v[248:251]
    s_waitcnt lgkmcnt(10)
    v_mfma_f32_32x32x16_bf16 v[96:111], v[136:139], a[84:87], v[96:111]
    ds_read_b64_tr_b16 v[160:161], v33 offset:20480
    ds_read_b64_tr_b16 v[162:163], v33 offset:21504
    buffer_load_dwordx4 v6, s[44:47], s33 offen offset:2048 lds
    v_mfma_f32_32x32x16_bf16 v[112:127], v[140:143], a[84:87], v[112:127]
    ds_read_b64_tr_b16 v[164:165], v34 offset:20480
    ds_read_b64_tr_b16 v[166:167], v34 offset:21504
    s_waitcnt lgkmcnt(10)
    s_waitcnt lgkmcnt(8)
    v_mfma_f32_32x32x16_bf16 v[64:79], v[144:147], a[88:91], v[64:79]
    ds_read_b64_tr_b16 v[168:169], v35 offset:20480
    ds_read_b64_tr_b16 v[170:171], v35 offset:21504
    buffer_load_dwordx4 v7, s[44:47], s33 offen offset:3072 lds
    v_mfma_f32_32x32x16_bf16 v[80:95], v[148:151], a[88:91], v[80:95]
    ds_read_b64_tr_b16 v[172:173], v36 offset:20480
    ds_read_b64_tr_b16 v[174:175], v36 offset:21504
    v_mfma_f32_16x16x32_bf16 v[248:251], a[140:143], v[144:147], v[248:251]
    s_waitcnt lgkmcnt(8)
    v_mfma_f32_32x32x16_bf16 v[96:111], v[152:155], a[88:91], v[96:111]
    ds_read_b64_tr_b16 v[128:129], v33 offset:24576
    ds_read_b64_tr_b16 v[130:131], v33 offset:25600
    buffer_load_dwordx2 v[20:21], v47, s[40:43], 0 offen sc1
    v_mfma_f32_32x32x16_bf16 v[112:127], v[156:159], a[88:91], v[112:127]
    ds_read_b64_tr_b16 v[132:133], v34 offset:24576
    ds_read_b64_tr_b16 v[134:135], v34 offset:25600
    s_lshr_b32 s33, s89, 5
    s_add_u32 s33, s33, s27
    s_add_u32 m0, s96, 32768
    s_waitcnt lgkmcnt(8)
    v_mfma_f32_32x32x16_bf16 v[64:79], v[160:163], a[92:95], v[64:79]
    ds_read_b64_tr_b16 v[136:137], v35 offset:24576
    ds_read_b64_tr_b16 v[138:139], v35 offset:25600
    buffer_load_dwordx4 v252, s[56:59], s33 offen offset:0 lds
    v_mfma_f32_32x32x16_bf16 v[80:95], v[164:167], a[92:95], v[80:95]
    ds_read_b64_tr_b16 v[140:141], v36 offset:24576
    ds_read_b64_tr_b16 v[142:143], v36 offset:25600
    v_mfma_f32_16x16x32_bf16 v[248:251], a[140:143], v[160:163], v[248:251]
    s_waitcnt lgkmcnt(8)
    v_mfma_f32_32x32x16_bf16 v[96:111], v[168:171], a[92:95], v[96:111]
    ds_read_b64_tr_b16 v[144:145], v33 offset:28672
    ds_read_b64_tr_b16 v[146:147], v33 offset:29696
    buffer_load_dwordx4 v253, s[56:59], s33 offen offset:1024 lds
    v_mfma_f32_32x32x16_bf16 v[112:127], v[172:175], a[92:95], v[112:127]
    ds_read_b64_tr_b16 v[148:149], v34 offset:28672
    ds_read_b64_tr_b16 v[150:151], v34 offset:29696
    v_add_u32 v33, 0x00010000, v33
    s_waitcnt lgkmcnt(8)
    v_mfma_f32_32x32x16_bf16 v[64:79], v[128:131], a[96:99], v[64:79]
    ds_read_b64_tr_b16 v[152:153], v35 offset:28672
    ds_read_b64_tr_b16 v[154:155], v35 offset:29696
    s_waitcnt vmcnt(19)
    buffer_load_dwordx4 v254, s[56:59], s33 offen offset:2048 lds
    v_add_u32 v34, 0x00010000, v34
    v_mfma_f32_32x32x16_bf16 v[80:95], v[132:135], a[96:99], v[80:95]
    ds_read_b64_tr_b16 v[156:157], v36 offset:28672
    ds_read_b64_tr_b16 v[158:159], v36 offset:29696
    ds_read_b128 a[104:107], v32 offset:16384
    ds_read_b128 a[108:111], v38 offset:16384
    v_mfma_f32_16x16x32_bf16 v[248:251], a[140:143], v[128:131], v[248:251]
    v_add_u32 v35, 0x00010000, v35
    s_waitcnt lgkmcnt(10)
    v_mfma_f32_32x32x16_bf16 v[96:111], v[136:139], a[96:99], v[96:111]
    ds_read_b64_tr_b16 v[160:161], v33 offset:0
    ds_read_b64_tr_b16 v[162:163], v33 offset:1024
    ds_read_b128 a[112:115], v27 offset:16384
    v_add_u32 v36, 0x00010000, v36
    v_mfma_f32_32x32x16_bf16 v[112:127], v[140:143], a[96:99], v[112:127]
    ds_read_b64_tr_b16 v[164:165], v34 offset:0
    ds_read_b64_tr_b16 v[166:167], v34 offset:1024
    ds_read_b128 a[116:119], v239 offset:16384
    buffer_load_dwordx4 v255, s[56:59], s33 offen offset:3072 lds
    s_waitcnt lgkmcnt(12)
    v_mfma_f32_32x32x16_bf16 v[64:79], v[144:147], a[100:103], v[64:79]
    ds_read_b64_tr_b16 v[168:169], v35 offset:0
    ds_read_b64_tr_b16 v[170:171], v35 offset:1024
    s_mul_i32 s33, s90, 54
    s_add_u32 s33, s33, s72
    s_add_u32 m0, s96, 131072
    s_nop 0
    buffer_load_dwordx4 v4, s[44:47], s33 offen offset:0 lds
    v_mfma_f32_32x32x16_bf16 v[80:95], v[148:151], a[100:103], v[80:95]
    ds_read_b64_tr_b16 v[172:173], v36 offset:0
    ds_read_b64_tr_b16 v[174:175], v36 offset:1024
    v_mfma_f32_16x16x32_bf16 v[248:251], a[140:143], v[144:147], v[248:251]
    s_waitcnt lgkmcnt(12)
    v_mfma_f32_32x32x16_bf16 v[96:111], v[152:155], a[100:103], v[96:111]
    ds_read_b64_tr_b16 v[128:129], v33 offset:4096
    ds_read_b64_tr_b16 v[130:131], v33 offset:5120
    buffer_load_dwordx4 v5, s[44:47], s33 offen offset:1024 lds
    v_mfma_f32_32x32x16_bf16 v[112:127], v[156:159], a[100:103], v[112:127]
    ds_read_b64_tr_b16 v[132:133], v34 offset:4096
    ds_read_b64_tr_b16 v[134:135], v34 offset:5120
    s_waitcnt lgkmcnt(8)
    v_mfma_f32_32x32x16_bf16 v[64:79], v[160:163], a[104:107], v[64:79]
    ds_read_b64_tr_b16 v[136:137], v35 offset:4096
    ds_read_b64_tr_b16 v[138:139], v35 offset:5120
    buffer_load_dwordx4 v6, s[44:47], s33 offen offset:2048 lds
    v_mfma_f32_32x32x16_bf16 v[80:95], v[164:167], a[104:107], v[80:95]
    ds_read_b64_tr_b16 v[140:141], v36 offset:4096
    ds_read_b64_tr_b16 v[142:143], v36 offset:5120
    v_mfma_f32_16x16x32_bf16 v[248:251], a[140:143], v[160:163], v[248:251]
    s_waitcnt lgkmcnt(8)
    v_mfma_f32_32x32x16_bf16 v[96:111], v[168:171], a[104:107], v[96:111]
    ds_read_b64_tr_b16 v[144:145], v33 offset:8192
    ds_read_b64_tr_b16 v[146:147], v33 offset:9216
    buffer_load_dwordx4 v7, s[44:47], s33 offen offset:3072 lds
    s_lshr_b32 s33, s90, 5
    s_add_u32 s33, s33, s27
    v_mfma_f32_32x32x16_bf16 v[112:127], v[172:175], a[104:107], v[112:127]
    ds_read_b64_tr_b16 v[148:149], v34 offset:8192
    ds_read_b64_tr_b16 v[150:151], v34 offset:9216
    s_waitcnt lgkmcnt(8)
    v_mfma_f32_32x32x16_bf16 v[64:79], v[128:131], a[108:111], v[64:79]
    ds_read_b64_tr_b16 v[152:153], v35 offset:8192
    ds_read_b64_tr_b16 v[154:155], v35 offset:9216
    s_add_u32 m0, s96, 49152
    s_nop 0
    buffer_load_dwordx4 v252, s[56:59], s33 offen offset:0 lds
    s_mov_b32 m0, s73
    v_mfma_f32_32x32x16_bf16 v[80:95], v[132:135], a[108:111], v[80:95]
    ds_read_b64_tr_b16 v[156:157], v36 offset:8192
    ds_read_b64_tr_b16 v[158:159], v36 offset:9216
    v_mfma_f32_16x16x32_bf16 v[248:251], a[140:143], v[128:131], v[248:251]
    s_add_u32 m0, s96, 49152
    s_nop 0
    buffer_load_dwordx4 v253, s[56:59], s33 offen offset:1024 lds
    s_mov_b32 m0, s73
    s_waitcnt lgkmcnt(8)
    v_mfma_f32_32x32x16_bf16 v[96:111], v[136:139], a[108:111], v[96:111]
    ds_read_b64_tr_b16 v[160:161], v33 offset:12288
    ds_read_b64_tr_b16 v[162:163], v33 offset:13312
    v_mfma_f32_32x32x16_bf16 v[112:127], v[140:143], a[108:111], v[112:127]
    ds_read_b64_tr_b16 v[164:165], v34 offset:12288
    ds_read_b64_tr_b16 v[166:167], v34 offset:13312
    s_add_u32 m0, s96, 49152
    s_nop 0
    buffer_load_dwordx4 v254, s[56:59], s33 offen offset:2048 lds
    s_mov_b32 m0, s73
    s_waitcnt lgkmcnt(8)
    v_mfma_f32_32x32x16_bf16 v[64:79], v[144:147], a[112:115], v[64:79]
    ds_read_b64_tr_b16 v[168:169], v35 offset:12288
    ds_read_b64_tr_b16 v[170:171], v35 offset:13312
    s_waitcnt vmcnt(16)
    ds_read_b128 a[72:75], v32 offset:49152
    ds_read_b128 a[76:79], v38 offset:49152
    v_mfma_f32_32x32x16_bf16 v[80:95], v[148:151], a[112:115], v[80:95]
    ds_read_b64_tr_b16 v[172:173], v36 offset:12288
    ds_read_b64_tr_b16 v[174:175], v36 offset:13312
    s_waitcnt vmcnt(11)
    v_cmp_ne_u64_e64 vcc, s[70:71], v[20:21]
    s_cbranch_vccnz L_poll_3
L_ok_2:
    s_barrier
    v_mfma_f32_16x16x32_bf16 v[248:251], a[140:143], v[144:147], v[248:251]
    s_add_u32 m0, s96, 49152
    s_nop 0
    buffer_load_dwordx4 v255, s[56:59], s33 offen offset:3072 lds
    s_mov_b32 m0, s73
    s_waitcnt lgkmcnt(10)
    v_mfma_f32_32x32x16_bf16 v[96:111], v[152:155], a[112:115], v[96:111]
    ds_read_b64_tr_b16 v[128:129], v33 offset:32768
    ds_read_b64_tr_b16 v[130:131], v33 offset:33792
    ds_read_b128 a[80:83], v27 offset:49152
    s_mul_i32 s33, s91, 54
    s_add_u32 s33, s33, s72
    s_add_u32 m0, s96, 147456
    v_mfma_f32_32x32x16_bf16 v[112:127], v[156:159], a[112:115], v[112:127]
    ds_read_b64_tr_b16 v[132:133], v34 offset:32768
    ds_read_b64_tr_b16 v[134:135], v34 offset:33792
    ds_read_b128 a[84:87], v239 offset:49152
    buffer_load_dwordx4 v4, s[44:47], s33 offen offset:0 lds
    s_waitcnt lgkmcnt(12)
    v_mfma_f32_32x32x16_bf16 v[64:79], v[160:163], a[116:119], v[64:79]
    ds_read_b64_tr_b16 v[136:137], v35 offset:32768
    ds_read_b64_tr_b16 v[138:139], v35 offset:33792
    buffer_load_dword v57, v52, s[40:43], 0 offen sc1
    v_mfma_f32_32x32x16_bf16 v[80:95], v[164:167], a[116:119], v[80:95]
    ds_read_b64_tr_b16 v[140:141], v36 offset:32768
    ds_read_b64_tr_b16 v[142:143], v36 offset:33792
    buffer_load_dwordx4 v5, s[44:47], s33 offen offset:1024 lds
    v_mfma_f32_16x16x32_bf16 v[248:251], a[140:143], v[160:163], v[248:251]
    s_waitcnt lgkmcnt(10)
    v_mfma_f32_32x32x16_bf16 v[96:111], v[168:171], a[116:119], v[96:111]
    ds_read_b64_tr_b16 v[144:145], v33 offset:36864
    ds_read_b64_tr_b16 v[146:147], v33 offset:37888
    v_mfma_f32_32x32x16_bf16 v[112:127], v[172:175], a[116:119], v[112:127]
    ds_read_b64_tr_b16 v[148:149], v34 offset:36864
    ds_read_b64_tr_b16 v[150:151], v34 offset:37888
    buffer_load_dwordx4 v6, s[44:47], s33 offen offset:2048 lds
    s_waitcnt lgkmcnt(8)
    v_mfma_f32_32x32x16_bf16 v[64:79], v[128:131], a[72:75], v[64:79]
    ds_read_b64_tr_b16 v[152:153], v35 offset:36864
    ds_read_b64_tr_b16 v[154:155], v35 offset:37888
    v_mfma_f32_32x32x16_bf16 v[80:95], v[132:135], a[72:75], v[80:95]
    ds_read_b64_tr_b16 v[156:157], v36 offset:36864
    ds_read_b64_tr_b16 v[158:159], v36 offset:37888
    buffer_load_dwordx4 v7, s[44:47], s33 offen offset:3072 lds
    v_mfma_f32_16x16x32_bf16 v[248:251], a[140:143], v[128:131], v[248:251]
    s_waitcnt lgkmcnt(8)
    v_mfma_f32_32x32x16_bf16 v[96:111], v[136:139], a[72:75], v[96:111]
    ds_read_b64_tr_b16 v[160:161], v33 offset:40960
    ds_read_b64_tr_b16 v[162:163], v33 offset:41984
    s_lshr_b32 s33, s91, 5
    s_add_u32 s33, s33, s27
    v_mfma_f32_32x32x16_bf16 v[112:127], v[140:143], a[72:75], v[112:127]
    ds_read_b64_tr_b16 v[164:165], v34 offset:40960
    ds_read_b64_tr_b16 v[166:167], v34 offset:41984
    s_or_b32 m0, s73, 0
    s_nop 0
    ds_write_addtid_b32 v176 offset:0
    s_waitcnt lgkmcnt(9)
    v_mfma_f32_32x32x16_bf16 v[64:79], v[144:147], a[76:79], v[64:79]
    ds_read_b64_tr_b16 v[168:169], v35 offset:40960
    ds_read_b64_tr_b16 v[170:171], v35 offset:41984
    s_add_u32 m0, s96, 81920
    s_nop 0
    buffer_load_dwordx4 v252, s[56:59], s33 offen offset:0 lds
    s_mov_b32 m0, s73
    v_mfma_f32_32x32x16_bf16 v[80:95], v[148:151], a[76:79], v[80:95]
    ds_read_b64_tr_b16 v[172:173], v36 offset:40960
    ds_read_b64_tr_b16 v[174:175], v36 offset:41984
    s_add_u32 m0, s96, 81920
    s_nop 0
    buffer_load_dwordx4 v253, s[56:59], s33 offen offset:1024 lds
    s_mov_b32 m0, s73
    v_mfma_f32_16x16x32_bf16 v[248:251], a[140:143], v[144:147], v[248:251]
    s_waitcnt lgkmcnt(9)
    v_mfma_f32_32x32x16_bf16 v[96:111], v[152:155], a[76:79], v[96:111]
    ds_read_b64_tr_b16 v[128:129], v33 offset:45056
    ds_read_b64_tr_b16 v[130:131], v33 offset:46080
    s_add_u32 m0, s96, 81920
    s_nop 0
    buffer_load_dwordx4 v254, s[56:59], s33 offen offset:2048 lds
    s_mov_b32 m0, s73
    v_mfma_f32_32x32x16_bf16 v[112:127], v[156:159], a[76:79], v[112:127]
    ds_read_b64_tr_b16 v[132:133], v34 offset:45056
    ds_read_b64_tr_b16 v[134:135], v34 offset:46080
    ds_write_addtid_b32 v177 offset:1056
    s_waitcnt lgkmcnt(10)
    v_mfma_f32_32x32x16_bf16 v[64:79], v[160:163], a[80:83], v[64:79]
    ds_read_b64_tr_b16 v[136:137], v35 offset:45056
    ds_read_b64_tr_b16 v[138:139], v35 offset:46080
    s_waitcnt vmcnt(16)
    ds_write_addtid_b32 v178 offset:2112
    v_mfma_f32_32x32x16_bf16 v[80:95], v[164:167], a[80:83], v[80:95]
    ds_read_b64_tr_b16 v[140:141], v36 offset:45056
    ds_read_b64_tr_b16 v[142:143], v36 offset:46080
    ds_read_b128 a[88:91], v32 offset:0
    ds_write_addtid_b32 v179 offset:3168
    v_mfma_f32_16x16x32_bf16 v[248:251], a[140:143], v[160:163], v[248:251]
    s_add_u32 m0, s96, 81920
    s_nop 0
    buffer_load_dwordx4 v255, s[56:59], s33 offen offset:3072 lds
    s_mov_b32 m0, s73
    s_waitcnt lgkmcnt(12)
    v_mfma_f32_32x32x16_bf16 v[96:111], v[168:171], a[80:83], v[96:111]
    ds_read_b64_tr_b16 v[144:145], v33 offset:49152
    ds_read_b64_tr_b16 v[146:147], v33 offset:50176
    ds_read_b128 a[92:95], v38 offset:0
    ds_write_addtid_b32 v180 offset:4224
    v_mfma_f32_32x32x16_bf16 v[112:127], v[172:175], a[80:83], v[112:127]
    ds_read_b64_tr_b16 v[148:149], v34 offset:49152
    ds_read_b64_tr_b16 v[150:151], v34 offset:50176
    ds_read_b128 a[96:99], v27 offset:0
    s_mov_b32 s26, 327680
    s_waitcnt lgkmcnt(15)
    v_mfma_f32_32x32x16_bf16 v[64:79], v[128:131], a[84:87], v[64:79]
    ds_read_b64_tr_b16 v[152:153], v35 offset:49152
    ds_read_b64_tr_b16 v[154:155], v35 offset:50176
    ds_read_b128 a[100:103], v239 offset:0
    buffer_load_dwordx4 v[240:243], v39, s[40:43], 0 offen offset:0 sc1
    v_mfma_f32_32x32x16_bf16 v[80:95], v[132:135], a[84:87], v[80:95]
    ds_read_b64_tr_b16 v[156:157], v36 offset:49152
    ds_read_b64_tr_b16 v[158:159], v36 offset:50176
    ds_write_addtid_b32 v181 offset:5280
    ds_write_addtid_b32 v182 offset:6336
    v_mfma_f32_16x16x32_bf16 v[248:251], a[140:143], v[128:131], v[248:251]
    s_waitcnt lgkmcnt(15)
    v_mfma_f32_32x32x16_bf16 v[96:111], v[136:139], a[84:87], v[96:111]
    ds_read_b64_tr_b16 v[160:161], v33 offset:53248
    ds_read_b64_tr_b16 v[162:163], v33 offset:54272
    s_waitcnt vmcnt(10)
    ds_write_addtid_b32 v183 offset:7392
    v_mfma_f32_32x32x16_bf16 v[112:127], v[140:143], a[84:87], v[112:127]
    ds_read_b64_tr_b16 v[164:165], v34 offset:53248
    ds_read_b64_tr_b16 v[166:167], v34 offset:54272
    ds_read_b128 a[104:107], v32 offset:16384
    ds_read_b128 a[108:111], v38 offset:16384
    s_waitcnt lgkmcnt(11)
    v_mfma_f32_32x32x16_bf16 v[64:79], v[144:147], a[88:91], v[64:79]
    ds_read_b64_tr_b16 v[168:169], v35 offset:53248
    ds_read_b64_tr_b16 v[170:171], v35 offset:54272
    ds_read_b128 a[112:115], v27 offset:16384
    buffer_load_dwordx4 v[244:247], v39, s[40:43], s26 offen offset:0 sc1
    v_mfma_f32_32x32x16_bf16 v[80:95], v[148:151], a[88:91], v[80:95]
    ds_read_b64_tr_b16 v[172:173], v36 offset:53248
    ds_read_b64_tr_b16 v[174:175], v36 offset:54272
    ds_read_b128 a[116:119], v239 offset:16384
    ds_write_addtid_b32 v184 offset:8448
    v_mfma_f32_16x16x32_bf16 v[248:251], a[140:143], v[144:147], v[248:251]
    s_waitcnt lgkmcnt(15)
    v_mfma_f32_32x32x16_bf16 v[96:111], v[152:155], a[88:91], v[96:111]
    ds_read_b64_tr_b16 v[128:129], v33 offset:57344
    ds_read_b64_tr_b16 v[130:131], v33 offset:58368
    ds_write_addtid_b32 v185 offset:9504
    ds_write_addtid_b32 v186 offset:10560
    v_mfma_f32_32x32x16_bf16 v[112:127], v[156:159], a[88:91], v[112:127]
    ds_read_b64_tr_b16 v[132:133], v34 offset:57344
    ds_read_b64_tr_b16 v[134:135], v34 offset:58368
    ds_write_addtid_b32 v187 offset:11616
    s_waitcnt lgkmcnt(15)
    v_mfma_f32_32x32x16_bf16 v[64:79], v[160:163], a[92:95], v[64:79]
    ds_read_b64_tr_b16 v[136:137], v35 offset:57344
    ds_read_b64_tr_b16 v[138:139], v35 offset:58368
    ds_write_addtid_b32 v188 offset:12672
    ds_write_addtid_b32 v189 offset:13728
    v_mfma_f32_32x32x16_bf16 v[80:95], v[164:167], a[92:95], v[80:95]
    ds_read_b64_tr_b16 v[140:141], v36 offset:57344
    ds_read_b64_tr_b16 v[142:143], v36 offset:58368
    s_mov_b32 s25, 0
    ds_write_addtid_b32 v190 offset:14784
    v_mfma_f32_16x16x32_bf16 v[248:251], a[140:143], v[160:163], v[248:251]
    s_waitcnt lgkmcnt(15)
    v_mfma_f32_32x32x16_bf16 v[96:111], v[168:171], a[92:95], v[96:111]
    ds_read_b64_tr_b16 v[144:145], v33 offset:61440
    ds_read_b64_tr_b16 v[146:147], v33 offset:62464
    buffer_load_dwordx4 a[160:163], v8, s[40:43], s25 offen offset:0 sc1
    ds_write_addtid_b32 v191 offset:15840
    v_mfma_f32_32x32x16_bf16 v[112:127], v[172:175], a[92:95], v[112:127]
    ds_read_b64_tr_b16 v[148:149], v34 offset:61440
    ds_read_b64_tr_b16 v[150:151], v34 offset:62464
    buffer_load_dwordx4 a[164:167], v8, s[40:43], s25 offen offset:1024 sc1
    v_add_u32 v33, 0x00010000, v33
    s_waitcnt lgkmcnt(13)
    v_mfma_f32_32x32x16_bf16 v[64:79], v[128:131], a[96:99], v[64:79]
    ds_read_b64_tr_b16 v[152:153], v35 offset:61440
    ds_read_b64_tr_b16 v[154:155], v35 offset:62464
    ds_write_addtid_b32 v192 offset:16896
    v_add_u32 v34, 0x00010000, v34
    v_mfma_f32_32x32x16_bf16 v[80:95], v[132:135], a[96:99], v[80:95]
    ds_read_b64_tr_b16 v[156:157], v36 offset:61440
    ds_read_b64_tr_b16 v[158:159], v36 offset:62464
    s_waitcnt vmcnt(8)
    s_barrier
    buffer_load_dwordx4 a[168:171], v8, s[40:43], s25 offen offset:2048 sc1
    v_mfma_f32_16x16x32_bf16 v[248:251], a[140:143], v[128:131], v[248:251]
    v_add_u32 v35, 0x00010000, v35
    s_waitcnt lgkmcnt(11)
    v_mfma_f32_32x32x16_bf16 v[96:111], v[136:139], a[96:99], v[96:111]
    ds_read_b64_tr_b16 v[160:161], v33 offset:0
    ds_read_b64_tr_b16 v[162:163], v33 offset:1024
    buffer_load_dwordx4 a[172:175], v8, s[40:43], s25 offen offset:3072 sc1
    v_add_u32 v36, 0x00010000, v36
    v_mfma_f32_32x32x16_bf16 v[112:127], v[140:143], a[96:99], v[112:127]
    ds_read_b64_tr_b16 v[164:165], v34 offset:0
    ds_read_b64_tr_b16 v[166:167], v34 offset:1024
    ds_write_addtid_b32 v193 offset:17952
    s_waitcnt lgkmcnt(10)
    v_mfma_f32_32x32x16_bf16 v[64:79], v[144:147], a[100:103], v[64:79]
    ds_read_b64_tr_b16 v[168:169], v35 offset:0
    ds_read_b64_tr_b16 v[170:171], v35 offset:1024
    ds_write_addtid_b32 v194 offset:19008
    ds_write_addtid_b32 v195 offset:20064
    v_mfma_f32_32x32x16_bf16 v[80:95], v[148:151], a[100:103], v[80:95]
    ds_read_b64_tr_b16 v[172:173], v36 offset:0
    ds_read_b64_tr_b16 v[174:175], v36 offset:1024
    buffer_load_dwordx4 a[176:179], v9, s[40:43], s25 offen offset:0 sc1
    ds_write_addtid_b32 v196 offset:21120
    v_mfma_f32_16x16x32_bf16 v[248:251], a[140:143], v[144:147], v[248:251]
    s_mov_b32 s25, 40960
    s_waitcnt lgkmcnt(12)
    v_mfma_f32_32x32x16_bf16 v[96:111], v[152:155], a[100:103], v[96:111]
    ds_read_b64_tr_b16 v[128:129], v33 offset:4096
    ds_read_b64_tr_b16 v[130:131], v33 offset:5120
    buffer_load_dwordx4 a[180:183], v8, s[40:43], s25 offen offset:0 sc1
    ds_write_addtid_b32 v197 offset:22176
    v_mfma_f32_32x32x16_bf16 v[112:127], v[156:159], a[100:103], v[112:127]
    ds_read_b64_tr_b16 v[132:133], v34 offset:4096
    ds_read_b64_tr_b16 v[134:135], v34 offset:5120
    ds_write_addtid_b32 v198 offset:23232
    s_waitcnt lgkmcnt(14)
    v_mfma_f32_32x32x16_bf16 v[64:79], v[160:163], a[104:107], v[64:79]
    ds_read_b64_tr_b16 v[136:137], v35 offset:4096
    ds_read_b64_tr_b16 v[138:139], v35 offset:5120
    ds_write_addtid_b32 v199 offset:24288
    ds_write_addtid_b32 v200 offset:25344
    v_mfma_f32_32x32x16_bf16 v[80:95], v[164:167], a[104:107], v[80:95]
    ds_read_b64_tr_b16 v[140:141], v36 offset:4096
    ds_read_b64_tr_b16 v[142:143], v36 offset:5120
    buffer_load_dwordx4 a[184:187], v8, s[40:43], s25 offen offset:1024 sc1
    ds_write_addtid_b32 v201 offset:26400
    v_mfma_f32_16x16x32_bf16 v[248:251], a[140:143], v[160:163], v[248:251]
    s_waitcnt lgkmcnt(14)
    v_mfma_f32_32x32x16_bf16 v[96:111], v[168:171], a[104:107], v[96:111]
    ds_read_b64_tr_b16 v[144:145], v33 offset:8192
    ds_read_b64_tr_b16 v[146:147], v33 offset:9216
    ds_write_addtid_b32 v202 offset:27456
    ds_write_addtid_b32 v203 offset:28512
    v_mfma_f32_32x32x16_bf16 v[112:127], v[172:175], a[104:107], v[112:127]
    ds_read_b64_tr_b16 v[148:149], v34 offset:8192
    ds_read_b64_tr_b16 v[150:151], v34 offset:9216
    buffer_load_dwordx4 a[188:191], v8, s[40:43], s25 offen offset:2048 sc1
    s_waitcnt lgkmcnt(14)
    v_mfma_f32_32x32x16_bf16 v[64:79], v[128:131], a[108:111], v[64:79]
    ds_read_b64_tr_b16 v[152:153], v35 offset:8192
    ds_read_b64_tr_b16 v[154:155], v35 offset:9216
    ds_write_addtid_b32 v204 offset:29568
    ds_write_addtid_b32 v205 offset:30624
    v_mfma_f32_32x32x16_bf16 v[80:95], v[132:135], a[108:111], v[80:95]
    ds_read_b64_tr_b16 v[156:157], v36 offset:8192
    ds_read_b64_tr_b16 v[158:159], v36 offset:9216
    buffer_load_dwordx4 a[192:195], v8, s[40:43], s25 offen offset:3072 sc1
    ds_write_addtid_b32 v206 offset:31680
    v_mfma_f32_16x16x32_bf16 v[248:251], a[140:143], v[128:131], v[248:251]
    s_waitcnt lgkmcnt(14)
    v_mfma_f32_32x32x16_bf16 v[96:111], v[136:139], a[108:111], v[96:111]
    ds_read_b64_tr_b16 v[160:161], v33 offset:12288
    ds_read_b64_tr_b16 v[162:163], v33 offset:13312
    ds_write_addtid_b32 v207 offset:32736
    ds_write_addtid_b32 v208 offset:33792
    v_mfma_f32_32x32x16_bf16 v[112:127], v[140:143], a[108:111], v[112:127]
    ds_read_b64_tr_b16 v[164:165], v34 offset:12288
    ds_read_b64_tr_b16 v[166:167], v34 offset:13312
    buffer_load_dwordx4 a[196:199], v9, s[40:43], s25 offen offset:0 sc1
    s_waitcnt lgkmcnt(13)
    v_mfma_f32_32x32x16_bf16 v[64:79], v[144:147], a[112:115], v[64:79]
    ds_read_b64_tr_b16 v[168:169], v35 offset:12288
    ds_read_b64_tr_b16 v[170:171], v35 offset:13312
    s_waitcnt vmcnt(12)
    s_mov_b32 s25, 81920
    ds_write_addtid_b32 v209 offset:34848
    v_mfma_f32_32x32x16_bf16 v[80:95], v[148:151], a[112:115], v[80:95]
    ds_read_b64_tr_b16 v[172:173], v36 offset:12288
    ds_read_b64_tr_b16 v[174:175], v36 offset:13312
    ds_read_b128 a[72:75], v32 offset:49152
    buffer_load_dwordx4 a[200:203], v8, s[40:43], s25 offen offset:0 sc1
    v_mfma_f32_16x16x32_bf16 v[248:251], a[140:143], v[144:147], v[248:251]
    ds_read_b64_tr_b16 v[176:177], v33 offset:16384
    ds_read_b64_tr_b16 v[178:179], v33 offset:17408
    ds_read_b64_tr_b16 v[180:181], v33 offset:20480
    ds_read_b64_tr_b16 v[182:183], v33 offset:21504
    ds_read_b64_tr_b16 v[184:185], v33 offset:24576
    ds_read_b64_tr_b16 v[186:187], v33 offset:25600
    ds_read_b64_tr_b16 v[188:189], v33 offset:28672
    ds_read_b64_tr_b16 v[190:191], v33 offset:29696
    s_waitcnt lgkmcnt(15)
    v_mfma_f32_32x32x16_bf16 v[96:111], v[152:155], a[112:115], v[96:111]
    ds_read_b64_tr_b16 v[128:129], v33 offset:16384
    ds_read_b64_tr_b16 v[130:131], v33 offset:17408
    ds_read_b128 a[76:79], v38 offset:49152
    ds_write_addtid_b32 v210 offset:35904
    v_mfma_f32_32x32x16_bf16 v[112:127], v[156:159], a[112:115], v[112:127]
    ds_read_b64_tr_b16 v[132:133], v34 offset:16384
    ds_read_b64_tr_b16 v[134:135], v34 offset:17408
    ds_read_b128 a[80:83], v27 offset:49152
    buffer_load_dwordx4 a[204:207], v8, s[40:43], s25 offen offset:1024 sc1
    s_waitcnt lgkmcnt(15)
    v_mfma_f32_32x32x16_bf16 v[64:79], v[160:163], a[116:119], v[64:79]
    ds_read_b64_tr_b16 v[136:137], v35 offset:16384
    ds_read_b64_tr_b16 v[138:139], v35 offset:17408
    ds_read_b128 a[84:87], v239 offset:49152
    ds_write_addtid_b32 v211 offset:36960
    v_mfma_f32_32x32x16_bf16 v[80:95], v[164:167], a[116:119], v[80:95]
    ds_read_b64_tr_b16 v[140:141], v36 offset:16384
    ds_read_b64_tr_b16 v[142:143], v36 offset:17408
    ds_write_addtid_b32 v212 offset:38016
    v_and_b32 v60, 0xffff0000, v57
    v_mfma_f32_16x16x32_bf16 v[248:251], a[140:143], v[160:163], v[248:251]
    s_waitcnt lgkmcnt(14)
    v_mfma_f32_16x16x32_bf16 v[248:251], a[140:143], v[176:179], v[248:251]
    buffer_load_dwordx4 a[208:211], v8, s[40:43], s25 offen offset:2048 sc1
    v_mfma_f32_16x16x32_bf16 v[248:251], a[140:143], v[180:183], v[248:251]
    buffer_load_dwordx4 a[212:215], v8, s[40:43], s25 offen offset:3072 sc1
    v_mfma_f32_16x16x32_bf16 v[248:251], a[140:143], v[184:187], v[248:251]
    ds_write_addtid_b32 v213 offset:39072
    v_mfma_f32_16x16x32_bf16 v[248:251], a[140:143], v[188:191], v[248:251]
    v_mfma_f32_32x32x16_bf16 v[96:111], v[168:171], a[116:119], v[96:111]
    ds_read_b64_tr_b16 v[144:145], v33 offset:20480
    ds_read_b64_tr_b16 v[146:147], v33 offset:21504
    buffer_load_dwordx4 a[216:219], v9, s[40:43], s25 offen offset:0 sc1
    ds_write_addtid_b32 v214 offset:40128
    v_mfma_f32_32x32x16_bf16 v[112:127], v[172:175], a[116:119], v[112:127]
    ds_read_b64_tr_b16 v[148:149], v34 offset:20480
    ds_read_b64_tr_b16 v[150:151], v34 offset:21504
    s_mov_b32 s25, 122880
    ds_write_addtid_b32 v215 offset:41184
    s_waitcnt lgkmcnt(11)
    v_mfma_f32_32x32x16_bf16 v[64:79], v[128:131], a[72:75], v[64:79]
    ds_read_b64_tr_b16 v[152:153], v35 offset:20480
    ds_read_b64_tr_b16 v[154:155], v35 offset:21504
    v_cvt_pk_bf16_f32 v250, v248, v248
    v_lshlrev_b32 v250, 16, v250
    v_sub_f32 v250, v248, v250
    v_mfma_f32_32x32x16_bf16 v[80:95], v[132:135], a[72:75], v[80:95]
    ds_read_b64_tr_b16 v[156:157], v36 offset:20480
    ds_read_b64_tr_b16 v[158:159], v36 offset:21504
    v_cvt_pk_bf16_f32 v248, v248, v250
    v_cvt_pk_bf16_f32 v250, v249, v249
    v_lshlrev_b32 v250, 16, v250
    s_waitcnt lgkmcnt(12)
    v_mfma_f32_32x32x16_bf16 v[96:111], v[136:139], a[72:75], v[96:111]
    ds_read_b64_tr_b16 v[160:161], v33 offset:24576
    ds_read_b64_tr_b16 v[162:163], v33 offset:25600
    buffer_load_dwordx4 a[220:223], v8, s[40:43], s25 offen offset:0 sc1
    v_sub_f32_e64 v250, v249, v250
    v_cvt_pk_bf16_f32 v249, v249, v250
    v_mfma_f32_32x32x16_bf16 v[112:127], v[140:143], a[72:75], v[112:127]
    ds_read_b64_tr_b16 v[164:165], v34 offset:24576
    ds_read_b64_tr_b16 v[166:167], v34 offset:25600
    ds_write2_b32 v53, v248, v249 offset0:0 offset1:16
    buffer_load_dwordx4 a[224:227], v8, s[40:43], s25 offen offset:1024 sc1
    s_waitcnt lgkmcnt(10)
    v_mfma_f32_32x32x16_bf16 v[64:79], v[144:147], a[76:79], v[64:79]
    ds_read_b64_tr_b16 v[168:169], v35 offset:24576
    ds_read_b64_tr_b16 v[170:171], v35 offset:25600
    ds_write_addtid_b32 v216 offset:42240
    ds_write_addtid_b32 v217 offset:43296
    v_mfma_f32_32x32x16_bf16 v[80:95], v[148:151], a[76:79], v[80:95]
    ds_read_b64_tr_b16 v[172:173], v36 offset:24576
    ds_read_b64_tr_b16 v[174:175], v36 offset:25600
    ds_write_addtid_b32 v218 offset:44352
    s_waitcnt lgkmcnt(12)
    v_mfma_f32_32x32x16_bf16 v[96:111], v[152:155], a[76:79], v[96:111]
    ds_read_b64_tr_b16 v[128:129], v33 offset:28672
    ds_read_b64_tr_b16 v[130:131], v33 offset:29696
    s_waitcnt lgkmcnt(9)
    s_barrier
    buffer_load_dwordx4 a[228:231], v8, s[40:43], s25 offen offset:2048 sc1
    v_mfma_f32_32x32x16_bf16 v[112:127], v[156:159], a[76:79], v[112:127]
    ds_read_b64_tr_b16 v[132:133], v34 offset:28672
    ds_read_b64_tr_b16 v[134:135], v34 offset:29696
    ds_read_b32 a120, v48
    ds_read_b32 a124, v49
    v_mfma_f32_32x32x16_bf16 v[64:79], v[160:163], a[80:83], v[64:79]
    ds_read_b64_tr_b16 v[136:137], v35 offset:28672
    ds_read_b64_tr_b16 v[138:139], v35 offset:29696
    ds_read_b32 a128, v50
    ds_read_b32 a132, v51
    buffer_load_dwordx4 a[232:235], v8, s[40:43], s25 offen offset:3072 sc1
    v_mfma_f32_32x32x16_bf16 v[80:95], v[164:167], a[80:83], v[80:95]
    ds_read_b64_tr_b16 v[140:141], v36 offset:28672
    ds_read_b64_tr_b16 v[142:143], v36 offset:29696
    ds_write_addtid_b32 v219 offset:45408
    s_waitcnt lgkmcnt(14)
    v_mfma_f32_32x32x16_bf16 v[96:111], v[168:171], a[80:83], v[96:111]
    ds_write_addtid_b32 v220 offset:46464
    ds_write_addtid_b32 v221 offset:47520
    ds_write_addtid_b32 v222 offset:48576
    v_mfma_f32_32x32x16_bf16 v[112:127], v[172:175], a[80:83], v[112:127]
    buffer_load_dwordx4 a[236:239], v9, s[40:43], s25 offen offset:0 sc1
    ds_write_addtid_b32 v223 offset:49632
    ds_write_addtid_b32 v224 offset:50688
    s_waitcnt lgkmcnt(14)
    v_mfma_f32_32x32x16_bf16 v[64:79], v[128:131], a[84:87], v[64:79]
    s_mov_b32 s25, 163840
    ds_write_addtid_b32 v225 offset:51744
    ds_write_addtid_b32 v226 offset:52800
    ds_write_addtid_b32 v227 offset:53856
    v_mfma_f32_32x32x16_bf16 v[80:95], v[132:135], a[84:87], v[80:95]
    buffer_load_dwordx4 a[240:243], v8, s[40:43], s25 offen offset:0 sc1
    ds_write_addtid_b32 v228 offset:54912
    ds_write_addtid_b32 v229 offset:55968
    s_waitcnt lgkmcnt(11)
    v_mfma_f32_32x32x16_bf16 v[96:111], v[136:139], a[84:87], v[96:111]
    ds_write_addtid_b32 v230 offset:57024
    ds_write_addtid_b32 v231 offset:58080
    ds_write_addtid_b32 v232 offset:59136
    v_mfma_f32_32x32x16_bf16 v[112:127], v[140:143], a[84:87], v[112:127]
    ds_write_addtid_b32 v233 offset:60192
    ds_write_addtid_b32 v234 offset:61248
    ds_write_addtid_b32 v235 offset:62304
    v_rcp_f32 v58, v60
    v_lshrrev_b32 v59, 5, v1
    v_add_u32 v59, -1, v59
    v_and_b32_e64 v57, v57, v59
    v_mul_f32 v56, 0xc0135761, v58
    v_mul_f32 v58, v58, v58
    v_lshrrev_b32 v59, 16, v57
    v_mul_f32_e64 v58, v58, v56
    v_accvgpr_write_b32 a137, v59
    v_and_b32 v57, 0xffff, v57
    v_mul_f32 v58, 0x3d372713, v58
    v_lshl_or_b32 v57, v57, 16, v57
    v_accvgpr_write_b32 a136, v57
    s_nop 1
    v_mfma_f32_32x32x16_bf16 v[64:79], a[120:123], a[136:139], v[64:79]
    ds_write_addtid_b32 v236 offset:63360
    ds_write_addtid_b32 v237 offset:64416
    ds_write_addtid_b32 v238 offset:65472
    v_mfma_f32_32x32x16_bf16 v[80:95], a[124:127], a[136:139], v[80:95]
    v_mfma_f32_32x32x16_bf16 v[96:111], a[128:131], a[136:139], v[96:111]
    v_mfma_f32_32x32x16_bf16 v[112:127], a[132:135], a[136:139], v[112:127]
    s_mov_b32 s25, 163840
    buffer_load_dwordx4 a[244:247], v8, s[40:43], s25 offen offset:1024 sc1
    buffer_load_dwordx4 a[248:251], v8, s[40:43], s25 offen offset:2048 sc1
    s_nop 2
    v_pk_mul_f32 v[128:129], v[64:65], v[64:65]
    v_pk_fma_f32 v[128:129], v[128:129], v[58:59], v[56:57] op_sel_hi:[1,0,0]
    v_pk_mul_f32 v[128:129], v[128:129], v[64:65]
    v_pk_mul_f32 v[130:131], v[66:67], v[66:67]
    v_pk_fma_f32 v[130:131], v[130:131], v[58:59], v[56:57] op_sel_hi:[1,0,0]
    v_pk_mul_f32 v[130:131], v[130:131], v[66:67]
    v_exp_f32 v128, v128
    v_exp_f32 v129, v129
    v_exp_f32 v130, v130
    v_exp_f32 v131, v131
    v_pk_fma_f32 v[128:129], v[128:129], v[60:61], v[60:61] op_sel_hi:[1,0,0]
    v_pk_fma_f32 v[130:131], v[130:131], v[60:61], v[60:61] op_sel_hi:[1,0,0]
    v_rcp_f32 v128, v128
    v_rcp_f32 v129, v129
    v_rcp_f32 v130, v130
    v_rcp_f32 v131, v131
    v_pk_mul_f32 v[128:129], v[128:129], v[64:65]
    v_pk_mul_f32 v[130:131], v[130:131], v[66:67]
    v_cvt_pk_bf16_f32 v176, v128, v129
    v_cvt_pk_bf16_f32 v177, v130, v131
    v_pk_mul_f32 v[128:129], v[68:69], v[68:69]
    v_pk_fma_f32 v[128:129], v[128:129], v[58:59], v[56:57] op_sel_hi:[1,0,0]
    v_pk_mul_f32 v[128:129], v[128:129], v[68:69]
    v_pk_mul_f32 v[130:131], v[70:71], v[70:71]
    buffer_load_dwordx4 a[252:255], v8, s[40:43], s25 offen offset:3072 sc1
    s_mov_b32 s25, 245760
    buffer_load_dwordx4 a[0:3], v8, s[40:43], s25 offen offset:0 sc1
    v_pk_fma_f32 v[130:131], v[130:131], v[58:59], v[56:57] op_sel_hi:[1,0,0]
    v_pk_mul_f32 v[130:131], v[130:131], v[70:71]
    v_exp_f32 v128, v128
    v_exp_f32 v129, v129
    v_exp_f32 v130, v130
    v_exp_f32 v131, v131
    v_pk_fma_f32 v[128:129], v[128:129], v[60:61], v[60:61] op_sel_hi:[1,0,0]
    v_pk_fma_f32 v[130:131], v[130:131], v[60:61], v[60:61] op_sel_hi:[1,0,0]
    v_rcp_f32 v128, v128
    v_rcp_f32 v129, v129
    v_rcp_f32 v130, v130
    v_rcp_f32 v131, v131
    v_pk_mul_f32 v[128:129], v[128:129], v[68:69]
    v_pk_mul_f32 v[130:131], v[130:131], v[70:71]
    v_cvt_pk_bf16_f32 v178, v128, v129
    v_cvt_pk_bf16_f32 v179, v130, v131
    v_pk_mul_f32 v[128:129], v[72:73], v[72:73]
    v_pk_fma_f32 v[128:129], v[128:129], v[58:59], v[56:57] op_sel_hi:[1,0,0]
    v_pk_mul_f32 v[128:129], v[128:129], v[72:73]
    v_pk_mul_f32 v[130:131], v[74:75], v[74:75]
    v_pk_fma_f32 v[130:131], v[130:131], v[58:59], v[56:57] op_sel_hi:[1,0,0]
    v_pk_mul_f32 v[130:131], v[130:131], v[74:75]
    v_exp_f32 v128, v128
    v_exp_f32 v129, v129
    buffer_load_dwordx4 a[4:7], v8, s[40:43], s25 offen offset:1024 sc1
    buffer_load_dwordx4 a[8:11], v8, s[40:43], s25 offen offset:2048 sc1
    v_exp_f32 v130, v130
    v_exp_f32 v131, v131
    v_pk_fma_f32 v[128:129], v[128:129], v[60:61], v[60:61] op_sel_hi:[1,0,0]
    v_pk_fma_f32 v[130:131], v[130:131], v[60:61], v[60:61] op_sel_hi:[1,0,0]
    v_rcp_f32 v128, v128
    v_rcp_f32 v129, v129
    v_rcp_f32 v130, v130
    v_rcp_f32 v131, v131
    v_pk_mul_f32 v[128:129], v[128:129], v[72:73]
    v_pk_mul_f32 v[130:131], v[130:131], v[74:75]
    v_cvt_pk_bf16_f32 v180, v128, v129
    v_cvt_pk_bf16_f32 v181, v130, v131
    v_pk_mul_f32 v[128:129], v[76:77], v[76:77]
    v_pk_fma_f32 v[128:129], v[128:129], v[58:59], v[56:57] op_sel_hi:[1,0,0]
    v_pk_mul_f32 v[128:129], v[128:129], v[76:77]
    v_pk_mul_f32 v[130:131], v[78:79], v[78:79]
    v_pk_fma_f32 v[130:131], v[130:131], v[58:59], v[56:57] op_sel_hi:[1,0,0]
    v_pk_mul_f32 v[130:131], v[130:131], v[78:79]
    v_exp_f32 v128, v128
    v_exp_f32 v129, v129
    v_exp_f32 v130, v130
    v_exp_f32 v131, v131
    v_pk_fma_f32 v[128:129], v[128:129], v[60:61], v[60:61] op_sel_hi:[1,0,0]
    v_pk_fma_f32 v[130:131], v[130:131], v[60:61], v[60:61] op_sel_hi:[1,0,0]
    buffer_load_dwordx4 a[12:15], v8, s[40:43], s25 offen offset:3072 sc1
    buffer_load_dwordx4 a[16:19], v9, s[40:43], s25 offen offset:0 sc1
    v_rcp_f32 v128, v128
    v_rcp_f32 v129, v129
    v_rcp_f32 v130, v130
    v_rcp_f32 v131, v131
    v_pk_mul_f32 v[128:129], v[128:129], v[76:77]
    v_pk_mul_f32 v[130:131], v[130:131], v[78:79]
    v_cvt_pk_bf16_f32 v182, v128, v129
    v_cvt_pk_bf16_f32 v183, v130, v131
    v_pk_mul_f32 v[128:129], v[80:81], v[80:81]
    v_pk_fma_f32 v[128:129], v[128:129], v[58:59], v[56:57] op_sel_hi:[1,0,0]
    v_pk_mul_f32 v[128:129], v[128:129], v[80:81]
    v_pk_mul_f32 v[130:131], v[82:83], v[82:83]
    v_pk_fma_f32 v[130:131], v[130:131], v[58:59], v[56:57] op_sel_hi:[1,0,0]
    v_pk_mul_f32 v[130:131], v[130:131], v[82:83]
    v_exp_f32 v128, v128
    v_exp_f32 v129, v129
    v_exp_f32 v130, v130
    v_exp_f32 v131, v131
    v_pk_fma_f32 v[128:129], v[128:129], v[60:61], v[60:61] op_sel_hi:[1,0,0]
    v_pk_fma_f32 v[130:131], v[130:131], v[60:61], v[60:61] op_sel_hi:[1,0,0]
    v_rcp_f32 v128, v128
    v_rcp_f32 v129, v129
    v_rcp_f32 v130, v130
    v_rcp_f32 v131, v131
    s_mov_b32 s25, 286720
    buffer_load_dwordx4 a[20:23], v8, s[40:43], s25 offen offset:0 sc1
    buffer_load_dwordx4 a[24:27], v8, s[40:43], s25 offen offset:1024 sc1
    v_pk_mul_f32 v[128:129], v[128:129], v[80:81]
    v_pk_mul_f32 v[130:131], v[130:131], v[82:83]
    v_cvt_pk_bf16_f32 v184, v128, v129
    v_cvt_pk_bf16_f32 v185, v130, v131
    v_pk_mul_f32 v[128:129], v[84:85], v[84:85]
    v_pk_fma_f32 v[128:129], v[128:129], v[58:59], v[56:57] op_sel_hi:[1,0,0]
    v_pk_mul_f32 v[128:129], v[128:129], v[84:85]
    v_pk_mul_f32 v[130:131], v[86:87], v[86:87]
    v_pk_fma_f32 v[130:131], v[130:131], v[58:59], v[56:57] op_sel_hi:[1,0,0]
    v_pk_mul_f32 v[130:131], v[130:131], v[86:87]
    v_exp_f32 v128, v128
    v_exp_f32 v129, v129
    v_exp_f32 v130, v130
    v_exp_f32 v131, v131
    v_pk_fma_f32 v[128:129], v[128:129], v[60:61], v[60:61] op_sel_hi:[1,0,0]
    v_pk_fma_f32 v[130:131], v[130:131], v[60:61], v[60:61] op_sel_hi:[1,0,0]
    v_rcp_f32 v128, v128
    v_rcp_f32 v129, v129
    v_rcp_f32 v130, v130
    v_rcp_f32 v131, v131
    v_pk_mul_f32 v[128:129], v[128:129], v[84:85]
    v_pk_mul_f32 v[130:131], v[130:131], v[86:87]
    v_cvt_pk_bf16_f32 v186, v128, v129
    v_cvt_pk_bf16_f32 v187, v130, v131
    buffer_load_dwordx4 a[28:31], v8, s[40:43], s25 offen offset:2048 sc1
    buffer_load_dwordx4 a[32:35], v8, s[40:43], s25 offen offset:3072 sc1
    v_pk_mul_f32 v[128:129], v[88:89], v[88:89]
    v_pk_fma_f32 v[128:129], v[128:129], v[58:59], v[56:57] op_sel_hi:[1,0,0]
    v_pk_mul_f32 v[128:129], v[128:129], v[88:89]
    v_pk_mul_f32 v[130:131], v[90:91], v[90:91]
    v_pk_fma_f32 v[130:131], v[130:131], v[58:59], v[56:57] op_sel_hi:[1,0,0]
    v_pk_mul_f32 v[130:131], v[130:131], v[90:91]
    v_exp_f32 v128, v128
    v_exp_f32 v129, v129
    v_exp_f32 v130, v130
    v_exp_f32 v131, v131
    v_pk_fma_f32 v[128:129], v[128:129], v[60:61], v[60:61] op_sel_hi:[1,0,0]
    v_pk_fma_f32 v[130:131], v[130:131], v[60:61], v[60:61] op_sel_hi:[1,0,0]
    v_rcp_f32 v128, v128
    v_rcp_f32 v129, v129
    v_rcp_f32 v130, v130
    v_rcp_f32 v131, v131
    v_pk_mul_f32 v[128:129], v[128:129], v[88:89]
    v_pk_mul_f32 v[130:131], v[130:131], v[90:91]
    v_cvt_pk_bf16_f32 v188, v128, v129
    v_cvt_pk_bf16_f32 v189, v130, v131
    v_pk_mul_f32 v[128:129], v[92:93], v[92:93]
    v_pk_fma_f32 v[128:129], v[128:129], v[58:59], v[56:57] op_sel_hi:[1,0,0]
    v_pk_mul_f32 v[128:129], v[128:129], v[92:93]
    v_pk_mul_f32 v[130:131], v[94:95], v[94:95]
    buffer_load_dwordx4 a[36:39], v9, s[40:43], s25 offen offset:0 sc1
    s_mov_b32 s25, 327680
    buffer_load_dwordx4 a[40:43], v8, s[40:43], s25 offen offset:0 sc1
    v_pk_fma_f32 v[130:131], v[130:131], v[58:59], v[56:57] op_sel_hi:[1,0,0]
    v_pk_mul_f32 v[130:131], v[130:131], v[94:95]
    v_exp_f32 v128, v128
    v_exp_f32 v129, v129
    v_exp_f32 v130, v130
    v_exp_f32 v131, v131
    v_pk_fma_f32 v[128:129], v[128:129], v[60:61], v[60:61] op_sel_hi:[1,0,0]
    v_pk_fma_f32 v[130:131], v[130:131], v[60:61], v[60:61] op_sel_hi:[1,0,0]
    v_rcp_f32 v128, v128
    v_rcp_f32 v129, v129
    v_rcp_f32 v130, v130
    v_rcp_f32 v131, v131
    v_pk_mul_f32 v[128:129], v[128:129], v[92:93]
    v_pk_mul_f32 v[130:131], v[130:131], v[94:95]
    v_cvt_pk_bf16_f32 v190, v128, v129
    v_cvt_pk_bf16_f32 v191, v130, v131
    v_pk_mul_f32 v[128:129], v[96:97], v[96:97]
    v_pk_fma_f32 v[128:129], v[128:129], v[58:59], v[56:57] op_sel_hi:[1,0,0]
    v_pk_mul_f32 v[128:129], v[128:129], v[96:97]
    v_pk_mul_f32 v[130:131], v[98:99], v[98:99]
    v_pk_fma_f32 v[130:131], v[130:131], v[58:59], v[56:57] op_sel_hi:[1,0,0]
    v_pk_mul_f32 v[130:131], v[130:131], v[98:99]
    v_exp_f32 v128, v128
    v_exp_f32 v129, v129
    buffer_load_dwordx4 a[44:47], v8, s[40:43], s25 offen offset:1024 sc1
    buffer_load_dwordx4 a[48:51], v8, s[40:43], s25 offen offset:2048 sc1
    v_exp_f32 v130, v130
    v_exp_f32 v131, v131
    v_pk_fma_f32 v[128:129], v[128:129], v[60:61], v[60:61] op_sel_hi:[1,0,0]
    v_pk_fma_f32 v[130:131], v[130:131], v[60:61], v[60:61] op_sel_hi:[1,0,0]
    v_rcp_f32 v128, v128
    v_rcp_f32 v129, v129
    v_rcp_f32 v130, v130
    v_rcp_f32 v131, v131
    v_pk_mul_f32 v[128:129], v[128:129], v[96:97]
    v_pk_mul_f32 v[130:131], v[130:131], v[98:99]
    v_cvt_pk_bf16_f32 v192, v128, v129
    v_cvt_pk_bf16_f32 v193, v130, v131
    v_pk_mul_f32 v[128:129], v[100:101], v[100:101]
    v_pk_fma_f32 v[128:129], v[128:129], v[58:59], v[56:57] op_sel_hi:[1,0,0]
    v_pk_mul_f32 v[128:129], v[128:129], v[100:101]
    v_pk_mul_f32 v[130:131], v[102:103], v[102:103]
    v_pk_fma_f32 v[130:131], v[130:131], v[58:59], v[56:57] op_sel_hi:[1,0,0]
    v_pk_mul_f32 v[130:131], v[130:131], v[102:103]
    v_exp_f32 v128, v128
    v_exp_f32 v129, v129
    v_exp_f32 v130, v130
    v_exp_f32 v131, v131
    v_pk_fma_f32 v[128:129], v[128:129], v[60:61], v[60:61] op_sel_hi:[1,0,0]
    v_pk_fma_f32 v[130:131], v[130:131], v[60:61], v[60:61] op_sel_hi:[1,0,0]
    buffer_load_dwordx4 a[52:55], v8, s[40:43], s25 offen offset:3072 sc1
    buffer_load_dwordx4 a[56:59], v9, s[40:43], s25 offen offset:0 sc1
    v_rcp_f32 v128, v128
    v_rcp_f32 v129, v129
    v_rcp_f32 v130, v130
    v_rcp_f32 v131, v131
    v_pk_mul_f32 v[128:129], v[128:129], v[100:101]
    v_pk_mul_f32 v[130:131], v[130:131], v[102:103]
    v_cvt_pk_bf16_f32 v194, v128, v129
    v_cvt_pk_bf16_f32 v195, v130, v131
    v_pk_mul_f32 v[128:129], v[104:105], v[104:105]
    v_pk_fma_f32 v[128:129], v[128:129], v[58:59], v[56:57] op_sel_hi:[1,0,0]
    v_pk_mul_f32 v[128:129], v[128:129], v[104:105]
    v_pk_mul_f32 v[130:131], v[106:107], v[106:107]
    v_pk_fma_f32 v[130:131], v[130:131], v[58:59], v[56:57] op_sel_hi:[1,0,0]
    v_pk_mul_f32 v[130:131], v[130:131], v[106:107]
    v_exp_f32 v128, v128
    v_exp_f32 v129, v129
    v_exp_f32 v130, v130
    v_exp_f32 v131, v131
    v_pk_fma_f32 v[128:129], v[128:129], v[60:61], v[60:61] op_sel_hi:[1,0,0]
    v_pk_fma_f32 v[130:131], v[130:131], v[60:61], v[60:61] op_sel_hi:[1,0,0]
    v_rcp_f32 v128, v128
    v_rcp_f32 v129, v129
    v_rcp_f32 v130, v130
    v_rcp_f32 v131, v131
    s_mov_b32 s25, 368640
    buffer_load_dwordx4 a[60:63], v8, s[40:43], s25 offen offset:0 sc1
    buffer_load_dwordx4 a[64:67], v8, s[40:43], s25 offen offset:1024 sc1
    v_pk_mul_f32 v[128:129], v[128:129], v[104:105]
    v_pk_mul_f32 v[130:131], v[130:131], v[106:107]
    v_cvt_pk_bf16_f32 v196, v128, v129
    v_cvt_pk_bf16_f32 v197, v130, v131
    v_pk_mul_f32 v[128:129], v[108:109], v[108:109]
    v_pk_fma_f32 v[128:129], v[128:129], v[58:59], v[56:57] op_sel_hi:[1,0,0]
    v_pk_mul_f32 v[128:129], v[128:129], v[108:109]
    v_pk_mul_f32 v[130:131], v[110:111], v[110:111]
    v_pk_fma_f32 v[130:131], v[130:131], v[58:59], v[56:57] op_sel_hi:[1,0,0]
    v_pk_mul_f32 v[130:131], v[130:131], v[110:111]
    v_exp_f32 v128, v128
    v_exp_f32 v129, v129
    v_exp_f32 v130, v130
    v_exp_f32 v131, v131
    v_pk_fma_f32 v[128:129], v[128:129], v[60:61], v[60:61] op_sel_hi:[1,0,0]
    v_pk_fma_f32 v[130:131], v[130:131], v[60:61], v[60:61] op_sel_hi:[1,0,0]
    v_rcp_f32 v128, v128
    v_rcp_f32 v129, v129
    v_rcp_f32 v130, v130
    v_rcp_f32 v131, v131
    v_pk_mul_f32 v[128:129], v[128:129], v[108:109]
    v_pk_mul_f32 v[130:131], v[130:131], v[110:111]
    v_cvt_pk_bf16_f32 v198, v128, v129
    v_cvt_pk_bf16_f32 v199, v130, v131
    buffer_store_dwordx4 v[176:179], v46, s[40:43], s4 offen offset:0 sc1
    v_pk_mul_f32 v[128:129], v[112:113], v[112:113]
    v_pk_fma_f32 v[128:129], v[128:129], v[58:59], v[56:57] op_sel_hi:[1,0,0]
    v_pk_mul_f32 v[128:129], v[128:129], v[112:113]
    v_pk_mul_f32 v[130:131], v[114:115], v[114:115]
    v_pk_fma_f32 v[130:131], v[130:131], v[58:59], v[56:57] op_sel_hi:[1,0,0]
    v_pk_mul_f32 v[130:131], v[130:131], v[114:115]
    v_exp_f32 v128, v128
    v_exp_f32 v129, v129
    v_exp_f32 v130, v130
    v_exp_f32 v131, v131
    v_pk_fma_f32 v[128:129], v[128:129], v[60:61], v[60:61] op_sel_hi:[1,0,0]
    v_pk_fma_f32 v[130:131], v[130:131], v[60:61], v[60:61] op_sel_hi:[1,0,0]
    buffer_store_dwordx4 v[180:183], v46, s[40:43], s4 offen offset:512 sc1
    v_rcp_f32 v128, v128
    v_rcp_f32 v129, v129
    v_rcp_f32 v130, v130
    v_rcp_f32 v131, v131
    v_pk_mul_f32 v[128:129], v[128:129], v[112:113]
    v_pk_mul_f32 v[130:131], v[130:131], v[114:115]
    v_cvt_pk_bf16_f32 v200, v128, v129
    v_cvt_pk_bf16_f32 v201, v130, v131
    v_pk_mul_f32 v[128:129], v[116:117], v[116:117]
    v_pk_fma_f32 v[128:129], v[128:129], v[58:59], v[56:57] op_sel_hi:[1,0,0]
    v_pk_mul_f32 v[128:129], v[128:129], v[116:117]
    v_pk_mul_f32 v[130:131], v[118:119], v[118:119]
    buffer_store_dwordx4 v[184:187], v46, s[40:43], s5 offen offset:0 sc1
    v_pk_fma_f32 v[130:131], v[130:131], v[58:59], v[56:57] op_sel_hi:[1,0,0]
    v_pk_mul_f32 v[130:131], v[130:131], v[118:119]
    v_exp_f32 v128, v128
    v_exp_f32 v129, v129
    v_exp_f32 v130, v130
    v_exp_f32 v131, v131
    v_pk_fma_f32 v[128:129], v[128:129], v[60:61], v[60:61] op_sel_hi:[1,0,0]
    v_pk_fma_f32 v[130:131], v[130:131], v[60:61], v[60:61] op_sel_hi:[1,0,0]
    v_rcp_f32 v128, v128
    v_rcp_f32 v129, v129
    v_rcp_f32 v130, v130
    v_rcp_f32 v131, v131
    buffer_store_dwordx4 v[188:191], v46, s[40:43], s5 offen offset:512 sc1
    v_pk_mul_f32 v[128:129], v[128:129], v[116:117]
    v_pk_mul_f32 v[130:131], v[130:131], v[118:119]
    v_cvt_pk_bf16_f32 v202, v128, v129
    v_cvt_pk_bf16_f32 v203, v130, v131
    v_pk_mul_f32 v[128:129], v[120:121], v[120:121]
    v_pk_fma_f32 v[128:129], v[128:129], v[58:59], v[56:57] op_sel_hi:[1,0,0]
    v_pk_mul_f32 v[128:129], v[128:129], v[120:121]
    v_pk_mul_f32 v[130:131], v[122:123], v[122:123]
    v_pk_fma_f32 v[130:131], v[130:131], v[58:59], v[56:57] op_sel_hi:[1,0,0]
    v_pk_mul_f32 v[130:131], v[130:131], v[122:123]
    v_exp_f32 v128, v128
    v_exp_f32 v129, v129
    buffer_store_dwordx4 v[192:195], v54, s[40:43], s6 offen offset:0 sc1
    v_exp_f32 v130, v130
    v_exp_f32 v131, v131
    v_pk_fma_f32 v[128:129], v[128:129], v[60:61], v[60:61] op_sel_hi:[1,0,0]
    v_pk_fma_f32 v[130:131], v[130:131], v[60:61], v[60:61] op_sel_hi:[1,0,0]
    v_rcp_f32 v128, v128
    v_rcp_f32 v129, v129
    v_rcp_f32 v130, v130
    v_rcp_f32 v131, v131
    v_pk_mul_f32 v[128:129], v[128:129], v[120:121]
    v_pk_mul_f32 v[130:131], v[130:131], v[122:123]
    v_cvt_pk_bf16_f32 v204, v128, v129
    v_cvt_pk_bf16_f32 v205, v130, v131
    buffer_store_dwordx4 v[196:199], v54, s[40:43], s6 offen offset:512 sc1
    v_pk_mul_f32 v[128:129], v[124:125], v[124:125]
    v_pk_fma_f32 v[128:129], v[128:129], v[58:59], v[56:57] op_sel_hi:[1,0,0]
    v_pk_mul_f32 v[128:129], v[128:129], v[124:125]
    v_pk_mul_f32 v[130:131], v[126:127], v[126:127]
    v_pk_fma_f32 v[130:131], v[130:131], v[58:59], v[56:57] op_sel_hi:[1,0,0]
    v_pk_mul_f32 v[130:131], v[130:131], v[126:127]
    v_exp_f32 v128, v128
    v_exp_f32 v129, v129
    v_exp_f32 v130, v130
    v_exp_f32 v131, v131
    v_pk_fma_f32 v[128:129], v[128:129], v[60:61], v[60:61] op_sel_hi:[1,0,0]
    v_pk_fma_f32 v[130:131], v[130:131], v[60:61], v[60:61] op_sel_hi:[1,0,0]
    v_rcp_f32 v128, v128
    v_rcp_f32 v129, v129
    v_rcp_f32 v130, v130
    v_rcp_f32 v131, v131
    v_pk_mul_f32 v[128:129], v[128:129], v[124:125]
    v_pk_mul_f32 v[130:131], v[130:131], v[126:127]
    v_cvt_pk_bf16_f32 v206, v128, v129
    v_cvt_pk_bf16_f32 v207, v130, v131
    buffer_store_dwordx4 v[200:203], v54, s[40:43], s7 offen offset:0 sc1
    buffer_store_dwordx4 v[204:207], v54, s[40:43], s7 offen offset:512 sc1
    s_waitcnt lgkmcnt(0)
    s_barrier
    ds_read_b128 v[132:135], v28 offset:0
    ds_read_b128 v[136:139], v24 offset:0
    ds_read_b128 v[140:143], v25 offset:0
    ds_read_b128 v[144:147], v28 offset:64
    ds_read_b128 v[148:151], v24 offset:64
    ds_read_b128 v[152:155], v25 offset:64
    ds_read_b128 v[156:159], v28 offset:128
    ds_read_b128 v[160:163], v24 offset:128
    ds_read_b128 v[164:167], v25 offset:128
    ds_read_b128 v[168:171], v28 offset:192
    ds_read_b128 v[172:175], v24 offset:192
    ds_read_b128 v[208:211], v25 offset:192
    s_lshr_b32 s77, s64, 1
    s_mul_i32 s77, s77, 4112
    s_add_u32 s77, s77, 126976
    v_mov_b32 v252, s77
    v_mov_b32_e64 v253, 0
    ds_write_b32 v252, v253
    ds_write_b32 v42, v62 offset:35840
    ds_write_b64 v41, v[62:63] offset:0
    s_waitcnt vmcnt(49)
    ds_write_b128 v40, v[240:243] offset:464
    ds_write_b64 v40, v[240:241] offset:5112
    ds_write_b64 v40, v[242:243] offset:5120
    ds_write_b128 v40, v[244:247] offset:976
    ds_write_b64 v40, v[244:245] offset:5624
    ds_write_b64 v40, v[246:247] offset:5632
    s_mov_b32 s25, 368640
    buffer_load_dwordx4 a[68:71], v8, s[40:43], s25 offen offset:2048 sc1
    buffer_load_dwordx4 a[72:75], v8, s[40:43], s25 offen offset:3072 sc1
    buffer_load_dwordx4 a[76:79], v9, s[40:43], s25 offen offset:0 sc1
    s_mov_b32 s25, 409600
    buffer_load_dwordx4 a[80:83], v8, s[40:43], s25 offen offset:0 sc1
    buffer_load_dwordx4 a[84:87], v8, s[40:43], s25 offen offset:1024 sc1
    buffer_load_dwordx4 a[88:91], v8, s[40:43], s25 offen offset:2048 sc1
    s_waitcnt lgkmcnt(15)
    v_mfma_f32_16x16x32_bf16 v[64:67], v[136:139], v[132:135], 0
    ds_read_b128 v[212:215], v28 offset:256
    v_mfma_f32_16x16x32_bf16 v[68:71], v[140:143], v[132:135], 0
    ds_read_b128 v[216:219], v24 offset:256
    s_waitcnt lgkmcnt(15)
    v_mfma_f32_16x16x32_bf16 v[64:67], v[148:151], v[144:147], v[64:67]
    ds_read_b128 v[220:223], v25 offset:256
    v_mfma_f32_16x16x32_bf16 v[68:71], v[152:155], v[144:147], v[68:71]
    ds_read_b128 v[224:227], v28 offset:320
    s_waitcnt lgkmcnt(15)
    v_mfma_f32_16x16x32_bf16 v[64:67], v[160:163], v[156:159], v[64:67]
    ds_read_b128 v[228:231], v24 offset:320
    v_mfma_f32_16x16x32_bf16 v[68:71], v[164:167], v[156:159], v[68:71]
    ds_read_b128 v[232:235], v25 offset:320
    s_waitcnt lgkmcnt(15)
    v_mfma_f32_16x16x32_bf16 v[64:67], v[172:175], v[168:171], v[64:67]
    ds_read_b128 v[84:87], v28 offset:384
    v_mfma_f32_16x16x32_bf16 v[68:71], v[208:211], v[168:171], v[68:71]
    ds_read_b128 v[88:91], v24 offset:384
    s_waitcnt lgkmcnt(5)
    v_mfma_f32_16x16x32_bf16 v[64:67], v[216:219], v[212:215], v[64:67]
    ds_read_b128 v[92:95], v25 offset:384
    v_mfma_f32_16x16x32_bf16 v[68:71], v[220:223], v[212:215], v[68:71]
    ds_read_b128 v[96:99], v28 offset:448
    s_waitcnt lgkmcnt(4)
    v_mfma_f32_16x16x32_bf16 v[64:67], v[228:231], v[224:227], v[64:67]
    ds_read_b128 v[100:103], v24 offset:448
    v_mfma_f32_16x16x32_bf16 v[68:71], v[232:235], v[224:227], v[68:71]
    ds_read_b128 v[104:107], v25 offset:448
    s_waitcnt lgkmcnt(3)
    v_mfma_f32_16x16x32_bf16 v[64:67], v[88:91], v[84:87], v[64:67]
    v_mfma_f32_16x16x32_bf16 v[68:71], v[92:95], v[84:87], v[68:71]
    s_waitcnt lgkmcnt(0)
    v_mfma_f32_16x16x32_bf16 v[64:67], v[100:103], v[96:99], v[64:67]
    v_mfma_f32_16x16x32_bf16 v[68:71], v[104:107], v[96:99], v[68:71]
    s_bitcmp1_b32 s64, 0
    s_cbranch_scc1 L_kh_5
    s_nop 5
    v_add_f32_e64 v67, v67, v55
    v_cvt_pk_bf16_f32 v72, v64, v65
    v_cvt_pk_bf16_f32 v73, v66, v67
    v_cvt_pk_bf16_f32 v74, v68, v69
    v_cvt_pk_bf16_f32 v75, v70, v71
    ds_write_b64 v29, v[72:73] offset:512
    ds_write_b64 v29, v[74:75] offset:0
    s_branch L_kj_6
L_kh_5:
    s_nop 5
    v_cvt_pk_bf16_f32 v72, v66, v66
    v_cvt_pk_bf16_f32 v73, v65, v65
    v_cvt_pk_bf16_f32 v74, v65, v64
    v_cvt_pk_bf16_f32 v75, v64, v64
    v_cvt_pk_bf16_f32 v76, v70, v70
    v_cvt_pk_bf16_f32 v77, v70, v70
    v_cvt_pk_bf16_f32 v78, v69, v69
    v_cvt_pk_bf16_f32 v79, v69, v69
    v_cvt_pk_bf16_f32 v80, v69, v69
    v_cvt_pk_bf16_f32 v81, v69, v68
    v_cvt_pk_bf16_f32 v82, v68, v68
    v_cvt_pk_bf16_f32 v83, v68, v68
    ds_write_b128 v29, v[72:75]
    ds_write_b128 v26, v[76:79]
    ds_write_b128 v26, v[80:83] offset:16
L_kj_6:
    s_waitcnt lgkmcnt(0) vmcnt(6)
    s_mov_b64 exec, 1
    buffer_store_dwordx2 v[22:23], v2, s[40:43], s93 offen sc1
    s_mov_b64 exec, -1
    s_barrier
    v_add_u32_e64 v88, 4, v30
    ds_read2st64_b32 v[208:209], v30 offset0:0 offset1:1
    ds_read2st64_b32 v[210:211], v30 offset0:2 offset1:3
    ds_read2st64_b32 v[212:213], v30 offset0:4 offset1:5
    ds_read2st64_b32 v[214:215], v30 offset0:6 offset1:7
    ds_read2st64_b32 v[216:217], v88 offset0:0 offset1:1
    ds_read2st64_b32 v[218:219], v88 offset0:2 offset1:3
    ds_read2st64_b32 v[220:221], v88 offset0:4 offset1:5
    ds_read2st64_b32 v[222:223], v88 offset0:6 offset1:7
    s_mov_b32 s25, 409600
    s_waitcnt lgkmcnt(0)
    v_alignbit_b32 v216, v216, v208, 16
    v_alignbit_b32 v217, v217, v209, 16
    buffer_load_dwordx4 a[92:95], v8, s[40:43], s25 offen offset:3072 sc1
    v_alignbit_b32 v218, v218, v210, 16
    v_alignbit_b32 v219, v219, v211, 16
    v_alignbit_b32 v220, v220, v212, 16
    v_alignbit_b32 v221, v221, v213, 16
    buffer_load_dwordx4 a[96:99], v9, s[40:43], s25 offen offset:0 sc1
    v_alignbit_b32 v222, v222, v214, 16
    v_alignbit_b32 v223, v223, v215, 16
    s_mov_b32 m0, s74
    s_nop 0
    ds_write_addtid_b32 v208 offset:35840
    s_mov_b32 s25, 450560
    ds_write_addtid_b32 v209 offset:36096
    ds_write_addtid_b32 v210 offset:36352
    ds_write_addtid_b32 v211 offset:36608
    ds_write_addtid_b32 v212 offset:36864
    buffer_load_dwordx4 a[100:103], v8, s[40:43], s25 offen offset:0 sc1
    ds_write_addtid_b32 v213 offset:37120
    ds_write_addtid_b32 v214 offset:37376
    ds_write_addtid_b32 v215 offset:37632
    ds_write_addtid_b32 v216 offset:40000
    buffer_load_dwordx4 a[104:107], v8, s[40:43], s25 offen offset:1024 sc1
    ds_write_addtid_b32 v217 offset:40256
    ds_write_addtid_b32 v218 offset:40512
    ds_write_addtid_b32 v219 offset:40768
    buffer_load_dwordx4 a[108:111], v8, s[40:43], s25 offen offset:2048 sc1
    ds_write_addtid_b32 v220 offset:41024
    ds_write_addtid_b32 v221 offset:41280
    ds_write_addtid_b32 v222 offset:41536
    ds_write_addtid_b32 v223 offset:41792
    buffer_load_dwordx4 a[112:115], v8, s[40:43], s25 offen offset:3072 sc1
    ds_write_addtid_b32 v208 offset:44156
    ds_write_addtid_b32 v209 offset:44412
    ds_write_addtid_b32 v210 offset:44668
    ds_write_addtid_b32 v211 offset:44924
    buffer_load_dwordx4 a[116:119], v9, s[40:43], s25 offen offset:0 sc1
    ds_write_addtid_b32 v212 offset:45180
    ds_write_addtid_b32 v213 offset:45436
    ds_write_addtid_b32 v214 offset:45692
    ds_write_addtid_b32 v215 offset:45948
    s_mov_b32 s25, 163840
    ds_write_addtid_b32 v216 offset:48316
    ds_write_addtid_b32 v217 offset:48572
    ds_write_addtid_b32 v218 offset:48828
    ds_write_addtid_b32 v219 offset:49084
    buffer_load_dwordx4 v[232:235], v9, s[40:43], s25 offen offset:0 sc1
    ds_write_addtid_b32 v220 offset:49340
    ds_write_addtid_b32 v221 offset:49596
    ds_write_addtid_b32 v222 offset:49852
    ds_write_addtid_b32 v223 offset:50108
    s_waitcnt lgkmcnt(0)
    s_barrier
    ds_read_b128 v[96:99], v43 offset:39616
    ds_read_b128 v[128:131], v44 offset:192
    ds_read_b128 v[100:103], v43 offset:39104
    ds_read_b128 v[132:135], v44 offset:704
    ds_read_b128 v[104:107], v43 offset:38592
    ds_read_b128 v[136:139], v44 offset:1216
    ds_read_b128 v[108:111], v43 offset:38080
    ds_read_b128 v[140:143], v44 offset:1728
    s_waitcnt lgkmcnt(6)
    v_mfma_f32_16x16x32_bf16 v[64:67], v[96:99], v[128:131], 0
    ds_read_b128 v[112:115], v43 offset:37568
    s_waitcnt lgkmcnt(5)
    v_mfma_f32_16x16x32_bf16 v[68:71], v[96:99], v[132:135], 0
    ds_read_b128 v[144:147], v44 offset:2240
    v_mfma_f32_16x16x32_bf16 v[68:71], v[100:103], v[128:131], v[68:71]
    ds_read_b128 v[116:119], v43 offset:37056
    s_mov_b32 s25, 204800
    v_mfma_f32_16x16x32_bf16 v[72:75], v[100:103], v[132:135], 0
    ds_read_b128 v[148:151], v44 offset:2752
    s_waitcnt lgkmcnt(6)
    v_mfma_f32_16x16x32_bf16 v[72:75], v[96:99], v[136:139], v[72:75]
    ds_read_b128 v[120:123], v43 offset:36544
    buffer_load_dwordx4 v[236:239], v8, s[40:43], s25 offen offset:0 sc1
    v_mfma_f32_16x16x32_bf16 v[72:75], v[104:107], v[128:131], v[72:75]
    ds_read_b128 v[152:155], v44 offset:3264
    v_mfma_f32_16x16x32_bf16 v[76:79], v[100:103], v[136:139], 0
    ds_read_b128 v[124:127], v43 offset:36032
    v_mfma_f32_16x16x32_bf16 v[76:79], v[104:107], v[132:135], v[76:79]
    ds_read_b128 v[156:159], v44 offset:3776
    buffer_load_dwordx4 v[240:243], v8, s[40:43], s25 offen offset:1024 sc1
    v_mfma_f32_16x16x32_bf16 v[80:83], v[104:107], v[136:139], 0
    s_waitcnt lgkmcnt(8)
    v_mfma_f32_16x16x32_bf16 v[76:79], v[96:99], v[140:143], v[76:79]
    v_mfma_f32_16x16x32_bf16 v[76:79], v[108:111], v[128:131], v[76:79]
    ds_read_b128 v[160:163], v43 offset:39552
    v_mfma_f32_16x16x32_bf16 v[80:83], v[100:103], v[140:143], v[80:83]
    v_mfma_f32_16x16x32_bf16 v[80:83], v[108:111], v[132:135], v[80:83]
    ds_read_b128 v[192:195], v44 offset:128
    v_mfma_f32_16x16x32_bf16 v[84:87], v[104:107], v[140:143], 0
    ds_read_b128 v[164:167], v43 offset:39040
    buffer_load_dwordx4 v[244:247], v8, s[40:43], s25 offen offset:2048 sc1
    v_mfma_f32_16x16x32_bf16 v[84:87], v[108:111], v[136:139], v[84:87]
    v_mfma_f32_16x16x32_bf16 v[88:91], v[108:111], v[140:143], 0
    ds_read_b128 v[196:199], v44 offset:640
    s_waitcnt lgkmcnt(10)
    v_mfma_f32_16x16x32_bf16 v[80:83], v[96:99], v[144:147], v[80:83]
    ds_read_b128 v[168:171], v43 offset:38528
    v_mfma_f32_16x16x32_bf16 v[80:83], v[112:115], v[128:131], v[80:83]
    v_mfma_f32_16x16x32_bf16 v[84:87], v[100:103], v[144:147], v[84:87]
    ds_read_b128 v[200:203], v44 offset:1152
    v_mfma_f32_16x16x32_bf16 v[84:87], v[112:115], v[132:135], v[84:87]
    ds_read_b128 v[172:175], v43 offset:38016
    buffer_load_dwordx4 v[248:251], v8, s[40:43], s25 offen offset:3072 sc1
    v_mfma_f32_16x16x32_bf16 v[88:91], v[104:107], v[144:147], v[88:91]
    v_mfma_f32_16x16x32_bf16 v[88:91], v[112:115], v[136:139], v[88:91]
    ds_read_b128 v[204:207], v44 offset:1664
    v_mfma_f32_16x16x32_bf16 v[92:95], v[108:111], v[144:147], 0
    ds_read_b128 v[176:179], v43 offset:37504
    v_mfma_f32_16x16x32_bf16 v[92:95], v[112:115], v[140:143], v[92:95]
    s_waitcnt lgkmcnt(13)
    v_mfma_f32_16x16x32_bf16 v[84:87], v[96:99], v[148:151], v[84:87]
    ds_read_b128 v[208:211], v44 offset:2176
    v_mfma_f32_16x16x32_bf16 v[84:87], v[116:119], v[128:131], v[84:87]
    ds_read_b128 v[180:183], v43 offset:36992
    buffer_load_dwordx4 v[252:255], v9, s[40:43], s25 offen offset:0 sc1
    v_mfma_f32_16x16x32_bf16 v[88:91], v[100:103], v[148:151], v[88:91]
    v_mfma_f32_16x16x32_bf16 v[88:91], v[116:119], v[132:135], v[88:91]
    ds_read_b128 v[212:215], v44 offset:2688
    v_mfma_f32_16x16x32_bf16 v[92:95], v[104:107], v[148:151], v[92:95]
    ds_read_b128 v[184:187], v43 offset:36480
    v_mfma_f32_16x16x32_bf16 v[92:95], v[116:119], v[136:139], v[92:95]
    s_mov_b32 s25, 491520
    s_waitcnt lgkmcnt(15)
    v_mfma_f32_16x16x32_bf16 v[88:91], v[96:99], v[152:155], v[88:91]
    ds_read_b128 v[216:219], v44 offset:3200
    v_mfma_f32_16x16x32_bf16 v[88:91], v[120:123], v[128:131], v[88:91]
    ds_read_b128 v[188:191], v43 offset:35968
    v_mfma_f32_16x16x32_bf16 v[92:95], v[100:103], v[152:155], v[92:95]
    v_or_b32 v8, s94, v8
    v_or_b32 v9, s94, v9
    v_mfma_f32_16x16x32_bf16 v[92:95], v[120:123], v[132:135], v[92:95]
    ds_read_b128 v[220:223], v44 offset:3712
    s_waitcnt lgkmcnt(15)
    v_mfma_f32_16x16x32_bf16 v[92:95], v[96:99], v[156:159], v[92:95]
    buffer_load_dwordx4 a[120:123], v8, s[40:43], s25 offen offset:0 sc1
    v_mfma_f32_16x16x32_bf16 v[92:95], v[124:127], v[128:131], v[92:95]
    s_waitcnt lgkmcnt(8)
    v_mfma_f32_16x16x32_bf16 v[64:67], v[160:163], v[192:195], v[64:67]
    buffer_load_dwordx4 a[124:127], v8, s[40:43], s25 offen offset:1024 sc1
    v_mfma_f32_16x16x32_bf16 v[68:71], v[160:163], v[196:199], v[68:71]
    ds_read_b128 v[96:99], v43 offset:39488
    v_mfma_f32_16x16x32_bf16 v[68:71], v[164:167], v[192:195], v[68:71]
    v_mfma_f32_16x16x32_bf16 v[72:75], v[164:167], v[196:199], v[72:75]
    ds_read_b128 v[128:131], v44 offset:64
    v_mfma_f32_16x16x32_bf16 v[72:75], v[160:163], v[200:203], v[72:75]
    v_mfma_f32_16x16x32_bf16 v[72:75], v[168:171], v[192:195], v[72:75]
    ds_read_b128 v[100:103], v43 offset:38976
    v_mfma_f32_16x16x32_bf16 v[76:79], v[164:167], v[200:203], v[76:79]
    buffer_load_dwordx4 a[128:131], v8, s[40:43], s25 offen offset:2048 sc1
    v_mfma_f32_16x16x32_bf16 v[76:79], v[168:171], v[196:199], v[76:79]
    ds_read_b128 v[132:135], v44 offset:576
    v_mfma_f32_16x16x32_bf16 v[80:83], v[168:171], v[200:203], v[80:83]
    v_mfma_f32_16x16x32_bf16 v[76:79], v[160:163], v[204:207], v[76:79]
    ds_read_b128 v[104:107], v43 offset:38464
    v_mfma_f32_16x16x32_bf16 v[76:79], v[172:175], v[192:195], v[76:79]
    v_mfma_f32_16x16x32_bf16 v[80:83], v[164:167], v[204:207], v[80:83]
    ds_read_b128 v[136:139], v44 offset:1088
    v_mfma_f32_16x16x32_bf16 v[80:83], v[172:175], v[196:199], v[80:83]
    buffer_load_dwordx4 a[132:135], v8, s[40:43], s25 offen offset:3072 sc1
    v_mfma_f32_16x16x32_bf16 v[84:87], v[168:171], v[204:207], v[84:87]
    ds_read_b128 v[108:111], v43 offset:37952
    v_mfma_f32_16x16x32_bf16 v[84:87], v[172:175], v[200:203], v[84:87]
    v_mfma_f32_16x16x32_bf16 v[88:91], v[172:175], v[204:207], v[88:91]
    ds_read_b128 v[140:143], v44 offset:1600
    s_waitcnt lgkmcnt(8)
    v_mfma_f32_16x16x32_bf16 v[80:83], v[160:163], v[208:211], v[80:83]
    v_mfma_f32_16x16x32_bf16 v[80:83], v[176:179], v[192:195], v[80:83]
    ds_read_b128 v[112:115], v43 offset:37440
    buffer_load_dwordx4 a[136:139], v9, s[40:43], s25 offen offset:0 sc1
    v_mfma_f32_16x16x32_bf16 v[84:87], v[164:167], v[208:211], v[84:87]
    v_mfma_f32_16x16x32_bf16 v[84:87], v[176:179], v[196:199], v[84:87]
    ds_read_b128 v[144:147], v44 offset:2112
    v_mfma_f32_16x16x32_bf16 v[88:91], v[168:171], v[208:211], v[88:91]
    v_mfma_f32_16x16x32_bf16 v[88:91], v[176:179], v[200:203], v[88:91]
    ds_read_b128 v[116:119], v43 offset:36928
    v_mfma_f32_16x16x32_bf16 v[92:95], v[172:175], v[208:211], v[92:95]
    s_mov_b32 s25, 532480
    v_mfma_f32_16x16x32_bf16 v[92:95], v[176:179], v[204:207], v[92:95]
    ds_read_b128 v[148:151], v44 offset:2624
    buffer_load_dwordx2 v[20:21], v18, s[40:43], 0 offen sc1
    v_mfma_f32_16x16x32_bf16 v[84:87], v[160:163], v[212:215], v[84:87]
    v_mfma_f32_16x16x32_bf16 v[84:87], v[180:183], v[192:195], v[84:87]
    ds_read_b128 v[120:123], v43 offset:36416
    buffer_load_dwordx4 a[140:143], v8, s[40:43], s25 offen offset:0 sc1
    v_mfma_f32_16x16x32_bf16 v[88:91], v[164:167], v[212:215], v[88:91]
    v_mfma_f32_16x16x32_bf16 v[88:91], v[180:183], v[196:199], v[88:91]
    ds_read_b128 v[152:155], v44 offset:3136
    v_mfma_f32_16x16x32_bf16 v[92:95], v[168:171], v[212:215], v[92:95]
    v_mfma_f32_16x16x32_bf16 v[92:95], v[180:183], v[200:203], v[92:95]
    ds_read_b128 v[124:127], v43 offset:35904
    v_mfma_f32_16x16x32_bf16 v[88:91], v[160:163], v[216:219], v[88:91]
    buffer_load_dwordx4 a[144:147], v8, s[40:43], s25 offen offset:1024 sc1
    v_mfma_f32_16x16x32_bf16 v[88:91], v[184:187], v[192:195], v[88:91]
    ds_read_b128 v[156:159], v44 offset:3648
    v_mfma_f32_16x16x32_bf16 v[92:95], v[164:167], v[216:219], v[92:95]
    v_mfma_f32_16x16x32_bf16 v[92:95], v[184:187], v[196:199], v[92:95]
    v_mfma_f32_16x16x32_bf16 v[92:95], v[160:163], v[220:223], v[92:95]
    v_mfma_f32_16x16x32_bf16 v[92:95], v[188:191], v[192:195], v[92:95]
    s_waitcnt lgkmcnt(8)
    v_mfma_f32_16x16x32_bf16 v[64:67], v[96:99], v[128:131], v[64:67]
    buffer_load_dwordx4 a[148:151], v8, s[40:43], s25 offen offset:2048 sc1
    v_mfma_f32_16x16x32_bf16 v[68:71], v[96:99], v[132:135], v[68:71]
    ds_read_b128 v[160:163], v43 offset:39424
    v_mfma_f32_16x16x32_bf16 v[68:71], v[100:103], v[128:131], v[68:71]
    v_mfma_f32_16x16x32_bf16 v[72:75], v[100:103], v[132:135], v[72:75]
    ds_read_b128 v[192:195], v44 offset:0
    v_mfma_f32_16x16x32_bf16 v[72:75], v[96:99], v[136:139], v[72:75]
    v_mfma_f32_16x16x32_bf16 v[72:75], v[104:107], v[128:131], v[72:75]
    ds_read_b128 v[164:167], v43 offset:38912
    v_mfma_f32_16x16x32_bf16 v[76:79], v[100:103], v[136:139], v[76:79]
    buffer_load_dwordx4 a[152:155], v8, s[40:43], s25 offen offset:3072 sc1
    v_mfma_f32_16x16x32_bf16 v[76:79], v[104:107], v[132:135], v[76:79]
    ds_read_b128 v[196:199], v44 offset:512
    v_mfma_f32_16x16x32_bf16 v[80:83], v[104:107], v[136:139], v[80:83]
    v_mfma_f32_16x16x32_bf16 v[76:79], v[96:99], v[140:143], v[76:79]
    ds_read_b128 v[168:171], v43 offset:38400
    v_mfma_f32_16x16x32_bf16 v[76:79], v[108:111], v[128:131], v[76:79]
    v_mfma_f32_16x16x32_bf16 v[80:83], v[100:103], v[140:143], v[80:83]
    ds_read_b128 v[200:203], v44 offset:1024
    v_mfma_f32_16x16x32_bf16 v[80:83], v[108:111], v[132:135], v[80:83]
    buffer_load_dwordx4 a[156:159], v9, s[40:43], s25 offen offset:0 sc1
    v_mfma_f32_16x16x32_bf16 v[84:87], v[104:107], v[140:143], v[84:87]
    ds_read_b128 v[172:175], v43 offset:37888
    v_mfma_f32_16x16x32_bf16 v[84:87], v[108:111], v[136:139], v[84:87]
    v_mfma_f32_16x16x32_bf16 v[88:91], v[108:111], v[140:143], v[88:91]
    ds_read_b128 v[204:207], v44 offset:1536
    s_waitcnt lgkmcnt(8)
    v_mfma_f32_16x16x32_bf16 v[80:83], v[96:99], v[144:147], v[80:83]
    v_mfma_f32_16x16x32_bf16 v[80:83], v[112:115], v[128:131], v[80:83]
    ds_read_b128 v[176:179], v43 offset:37376
    v_mfma_f32_16x16x32_bf16 v[84:87], v[100:103], v[144:147], v[84:87]
    v_mfma_f32_16x16x32_bf16 v[84:87], v[112:115], v[132:135], v[84:87]
    ds_read_b128 v[208:211], v44 offset:2048
    v_mfma_f32_16x16x32_bf16 v[88:91], v[104:107], v[144:147], v[88:91]
    v_mfma_f32_16x16x32_bf16 v[88:91], v[112:115], v[136:139], v[88:91]
    ds_read_b128 v[180:183], v43 offset:36864
    v_mfma_f32_16x16x32_bf16 v[92:95], v[108:111], v[144:147], v[92:95]
    v_mfma_f32_16x16x32_bf16 v[92:95], v[112:115], v[140:143], v[92:95]
    ds_read_b128 v[212:215], v44 offset:2560
    v_mfma_f32_16x16x32_bf16 v[84:87], v[96:99], v[148:151], v[84:87]
    v_mfma_f32_16x16x32_bf16 v[84:87], v[116:119], v[128:131], v[84:87]
    ds_read_b128 v[184:187], v43 offset:36352
    v_mfma_f32_16x16x32_bf16 v[88:91], v[100:103], v[148:151], v[88:91]
    v_mfma_f32_16x16x32_bf16 v[88:91], v[116:119], v[132:135], v[88:91]
    ds_read_b128 v[216:219], v44 offset:3072
    v_mfma_f32_16x16x32_bf16 v[92:95], v[104:107], v[148:151], v[92:95]
    v_mfma_f32_16x16x32_bf16 v[92:95], v[116:119], v[136:139], v[92:95]
    ds_read_b128 v[188:191], v43 offset:35840
    v_mfma_f32_16x16x32_bf16 v[88:91], v[96:99], v[152:155], v[88:91]
    v_mfma_f32_16x16x32_bf16 v[88:91], v[120:123], v[128:131], v[88:91]
    ds_read_b128 v[220:223], v44 offset:3584
    v_mfma_f32_16x16x32_bf16 v[92:95], v[100:103], v[152:155], v[92:95]
    v_mfma_f32_16x16x32_bf16 v[92:95], v[120:123], v[132:135], v[92:95]
    v_mfma_f32_16x16x32_bf16 v[92:95], v[96:99], v[156:159], v[92:95]
    v_mfma_f32_16x16x32_bf16 v[92:95], v[124:127], v[128:131], v[92:95]
    s_waitcnt lgkmcnt(8)
    v_mfma_f32_16x16x32_bf16 v[64:67], v[160:163], v[192:195], v[64:67]
    s_mul_i32 m0, s64, 8448
    v_mfma_f32_16x16x32_bf16 v[68:71], v[160:163], v[196:199], v[68:71]
    s_waitcnt vmcnt(5)
    v_cmp_ne_u64_e64 vcc, s[70:71], v[20:21]
    s_cbranch_vccnz L_poll_9
L_ok_8:
    v_mfma_f32_16x16x32_bf16 v[68:71], v[164:167], v[192:195], v[68:71]
    s_mov_b32 s95, 0
    buffer_load_dwordx4 v[96:99], v10, s[40:43], s95 offen offset:0 sc1
    v_mfma_f32_16x16x32_bf16 v[72:75], v[160:163], v[200:203], v[72:75]
    v_mfma_f32_16x16x32_bf16 v[72:75], v[164:167], v[196:199], v[72:75]
    ds_write_addtid_b32 v64 offset:0
    buffer_load_dwordx4 v[100:103], v10, s[40:43], s95 offen offset:1024 sc1
    v_mfma_f32_16x16x32_bf16 v[72:75], v[168:171], v[192:195], v[72:75]
    ds_write_addtid_b32 v65 offset:264
    v_mfma_f32_16x16x32_bf16 v[76:79], v[160:163], v[204:207], v[76:79]
    ds_write_addtid_b32 v66 offset:528
    v_mfma_f32_16x16x32_bf16 v[76:79], v[164:167], v[200:203], v[76:79]
    ds_write_addtid_b32 v67 offset:792
    buffer_load_dwordx4 v[104:107], v10, s[40:43], s95 offen offset:2048 sc1
    v_mfma_f32_16x16x32_bf16 v[76:79], v[168:171], v[196:199], v[76:79]
    ds_write_addtid_b32 v68 offset:1056
    v_mfma_f32_16x16x32_bf16 v[76:79], v[172:175], v[192:195], v[76:79]
    ds_write_addtid_b32 v69 offset:1320
    s_waitcnt lgkmcnt(6)
    v_mfma_f32_16x16x32_bf16 v[80:83], v[160:163], v[208:211], v[80:83]
    ds_write_addtid_b32 v70 offset:1584
    buffer_load_dwordx4 v[108:111], v10, s[40:43], s95 offen offset:3072 sc1
    v_mfma_f32_16x16x32_bf16 v[80:83], v[164:167], v[204:207], v[80:83]
    ds_write_addtid_b32 v71 offset:1848
    v_mfma_f32_16x16x32_bf16 v[80:83], v[168:171], v[200:203], v[80:83]
    ds_write_addtid_b32 v72 offset:2112
    v_mfma_f32_16x16x32_bf16 v[80:83], v[172:175], v[196:199], v[80:83]
    ds_write_addtid_b32 v73 offset:2376
    s_mov_b32 s95, 4096
    v_mfma_f32_16x16x32_bf16 v[80:83], v[176:179], v[192:195], v[80:83]
    ds_write_addtid_b32 v74 offset:2640
    buffer_load_dwordx4 v[112:115], v10, s[40:43], s95 offen offset:0 sc1
    v_mfma_f32_16x16x32_bf16 v[84:87], v[160:163], v[212:215], v[84:87]
    ds_write_addtid_b32 v75 offset:2904
    v_mfma_f32_16x16x32_bf16 v[84:87], v[164:167], v[208:211], v[84:87]
    ds_write_addtid_b32 v76 offset:3168
    v_mfma_f32_16x16x32_bf16 v[84:87], v[168:171], v[204:207], v[84:87]
    ds_write_addtid_b32 v77 offset:3432
    buffer_load_dwordx4 v[116:119], v10, s[40:43], s95 offen offset:1024 sc1
    v_mfma_f32_16x16x32_bf16 v[84:87], v[172:175], v[200:203], v[84:87]
    ds_write_addtid_b32 v78 offset:3696
    v_mfma_f32_16x16x32_bf16 v[84:87], v[176:179], v[196:199], v[84:87]
    ds_write_addtid_b32 v79 offset:3960
    v_mfma_f32_16x16x32_bf16 v[84:87], v[180:183], v[192:195], v[84:87]
    ds_write_addtid_b32 v80 offset:4224
    buffer_load_dwordx4 v[120:123], v10, s[40:43], s95 offen offset:2048 sc1
    v_mfma_f32_16x16x32_bf16 v[88:91], v[160:163], v[216:219], v[88:91]
    ds_write_addtid_b32 v81 offset:4488
    v_mfma_f32_16x16x32_bf16 v[88:91], v[164:167], v[212:215], v[88:91]
    ds_write_addtid_b32 v82 offset:4752
    v_mfma_f32_16x16x32_bf16 v[88:91], v[168:171], v[208:211], v[88:91]
    ds_write_addtid_b32 v83 offset:5016
    v_mfma_f32_16x16x32_bf16 v[88:91], v[172:175], v[204:207], v[88:91]
    ds_write_addtid_b32 v84 offset:5280
    buffer_load_dwordx4 v[124:127], v10, s[40:43], s95 offen offset:3072 sc1
    v_mfma_f32_16x16x32_bf16 v[88:91], v[176:179], v[200:203], v[88:91]
    ds_write_addtid_b32 v85 offset:5544
    v_mfma_f32_16x16x32_bf16 v[88:91], v[180:183], v[196:199], v[88:91]
    ds_write_addtid_b32 v86 offset:5808
    s_mov_b32 s95, 8192
    v_mfma_f32_16x16x32_bf16 v[88:91], v[184:187], v[192:195], v[88:91]
    ds_write_addtid_b32 v87 offset:6072
    buffer_load_dwordx4 v[128:131], v10, s[40:43], s95 offen offset:0 sc1
    v_mfma_f32_16x16x32_bf16 v[92:95], v[160:163], v[220:223], v[92:95]
    v_mfma_f32_16x16x32_bf16 v[92:95], v[164:167], v[216:219], v[92:95]
    v_mfma_f32_16x16x32_bf16 v[92:95], v[168:171], v[212:215], v[92:95]
    buffer_load_dwordx4 v[132:135], v10, s[40:43], s95 offen offset:1024 sc1
    v_mfma_f32_16x16x32_bf16 v[92:95], v[172:175], v[208:211], v[92:95]
    s_nop 0
    ds_write_addtid_b32 v88 offset:6336
    v_mfma_f32_16x16x32_bf16 v[92:95], v[176:179], v[204:207], v[92:95]
    ds_write_addtid_b32 v89 offset:6600
    v_mfma_f32_16x16x32_bf16 v[92:95], v[180:183], v[200:203], v[92:95]
    ds_write_addtid_b32 v90 offset:6864
    v_mfma_f32_16x16x32_bf16 v[92:95], v[184:187], v[196:199], v[92:95]
    ds_write_addtid_b32 v91 offset:7128
    v_mfma_f32_16x16x32_bf16 v[92:95], v[188:191], v[192:195], v[92:95]
    s_nop 7
    ds_write_addtid_b32 v92 offset:7392
    ds_write_addtid_b32 v93 offset:7656
    ds_write_addtid_b32 v94 offset:7920
    ds_write_addtid_b32 v95 offset:8184
L_join:
    s_waitcnt vmcnt(9)
    v_mfma_f32_16x16x32_bf16 v[192:195], v[96:99], a[160:163], 0
    v_mfma_f32_16x16x32_bf16 v[196:199], v[96:99], a[164:167], 0
    v_mfma_f32_16x16x32_bf16 v[200:203], v[96:99], a[168:171], 0
    v_mfma_f32_16x16x32_bf16 v[204:207], v[96:99], a[172:175], 0
    s_waitcnt lgkmcnt(0)
    s_barrier
    v_mfma_f32_16x16x32_bf16 v[208:211], v[96:99], a[176:179], 0
    ds_read_b64 v[136:137], v45 offset:0
    s_waitcnt vmcnt(8)
    v_mfma_f32_16x16x32_bf16 v[192:195], v[100:103], a[180:183], v[192:195]
    ds_read_b64 v[138:139], v45 offset:128
    v_mfma_f32_16x16x32_bf16 v[196:199], v[100:103], a[184:187], v[196:199]
    ds_read_b64 v[140:141], v45 offset:8
    v_mfma_f32_16x16x32_bf16 v[200:203], v[100:103], a[188:191], v[200:203]
    ds_read_b64 v[142:143], v45 offset:136
    v_mfma_f32_16x16x32_bf16 v[204:207], v[100:103], a[192:195], v[204:207]
    buffer_load_dwordx4 v[64:67], v10, s[40:43], s95 offen offset:2048 sc1
    v_mfma_f32_16x16x32_bf16 v[208:211], v[100:103], a[196:199], v[208:211]
    ds_read_b64 v[144:145], v45 offset:8448
    s_waitcnt vmcnt(8)
    v_mfma_f32_16x16x32_bf16 v[192:195], v[104:107], a[200:203], v[192:195]
    ds_read_b64 v[146:147], v45 offset:8576
    v_mfma_f32_16x16x32_bf16 v[196:199], v[104:107], a[204:207], v[196:199]
    ds_read_b64 v[148:149], v45 offset:8456
    v_mfma_f32_16x16x32_bf16 v[200:203], v[104:107], a[208:211], v[200:203]
    buffer_load_dwordx4 v[68:71], v10, s[40:43], s95 offen offset:3072 sc1
    v_mfma_f32_16x16x32_bf16 v[204:207], v[104:107], a[212:215], v[204:207]
    ds_read_b64 v[150:151], v45 offset:8584
    v_mfma_f32_16x16x32_bf16 v[208:211], v[104:107], a[216:219], v[208:211]
    ds_read_b64 v[152:153], v45 offset:2112
    s_waitcnt vmcnt(8)
    v_mfma_f32_16x16x32_bf16 v[192:195], v[108:111], a[220:223], v[192:195]
    s_mov_b32 s95, 12288
    ds_read_b64 v[154:155], v45 offset:2240
    v_mfma_f32_16x16x32_bf16 v[196:199], v[108:111], a[224:227], v[196:199]
    buffer_load_dwordx4 v[72:75], v11, s[40:43], s95 offen offset:0 sc1
    v_mfma_f32_16x16x32_bf16 v[200:203], v[108:111], a[228:231], v[200:203]
    ds_read_b64 v[156:157], v45 offset:2120
    v_mfma_f32_16x16x32_bf16 v[204:207], v[108:111], a[232:235], v[204:207]
    ds_read_b64 v[158:159], v45 offset:2248
    v_mfma_f32_16x16x32_bf16 v[208:211], v[108:111], a[236:239], v[208:211]
    ds_read_b64 v[160:161], v45 offset:10560
    s_waitcnt vmcnt(8)
    v_mfma_f32_16x16x32_bf16 v[192:195], v[112:115], a[240:243], v[192:195]
    ds_read_b64 v[162:163], v45 offset:10688
    v_mfma_f32_16x16x32_bf16 v[196:199], v[112:115], a[244:247], v[196:199]
    buffer_load_dwordx4 v[76:79], v11, s[40:43], s95 offen offset:1024 sc1
    v_mfma_f32_16x16x32_bf16 v[200:203], v[112:115], a[248:251], v[200:203]
    ds_read_b64 v[164:165], v45 offset:10568
    v_mfma_f32_16x16x32_bf16 v[204:207], v[112:115], a[252:255], v[204:207]
    ds_read_b64 v[166:167], v45 offset:10696
    s_lshl_b32 s24, s69, 2
    v_mfma_f32_16x16x32_bf16 v[208:211], v[112:115], v[232:235], v[208:211]
    s_mov_b32 s95, 55296
    s_add_u32 s24, s24, s64
    s_waitcnt vmcnt(8)
    v_mfma_f32_16x16x32_bf16 v[192:195], v[116:119], v[236:239], v[192:195]
    buffer_load_dwordx4 v[80:83], v10, s[40:43], s95 offen offset:0 sc1
    s_lshl_b32 s24, s24, 11
    v_mfma_f32_16x16x32_bf16 v[196:199], v[116:119], v[240:243], v[196:199]
    s_add_u32 s24, s24, 8650752
    v_mfma_f32_16x16x32_bf16 v[200:203], v[116:119], v[244:247], v[200:203]
    v_mfma_f32_16x16x32_bf16 v[204:207], v[116:119], v[248:251], v[204:207]
    v_mfma_f32_16x16x32_bf16 v[208:211], v[116:119], v[252:255], v[208:211]
    s_waitcnt vmcnt(8)
    v_mfma_f32_16x16x32_bf16 v[192:195], v[120:123], a[0:3], v[192:195]
    buffer_load_dwordx4 v[84:87], v10, s[40:43], s95 offen offset:1024 sc1
    v_mfma_f32_16x16x32_bf16 v[196:199], v[120:123], a[4:7], v[196:199]
    s_waitcnt lgkmcnt(8)
    v_add_f32 v136, v136, v144
    v_mfma_f32_16x16x32_bf16 v[200:203], v[120:123], a[8:11], v[200:203]
    v_add_f32 v137, v137, v145
    v_add_f32 v138, v138, v146
    v_mfma_f32_16x16x32_bf16 v[204:207], v[120:123], a[12:15], v[204:207]
    v_add_f32 v139, v139, v147
    v_add_f32 v140, v140, v148
    v_mfma_f32_16x16x32_bf16 v[208:211], v[120:123], a[16:19], v[208:211]
    buffer_load_dwordx4 v[88:91], v10, s[40:43], s95 offen offset:2048 sc1
    s_waitcnt vmcnt(9)
    v_mfma_f32_16x16x32_bf16 v[192:195], v[124:127], a[20:23], v[192:195]
    v_add_f32 v141, v141, v149
    v_add_f32_e64 v142, v142, v150
    v_mfma_f32_16x16x32_bf16 v[196:199], v[124:127], a[24:27], v[196:199]
    v_add_f32_e64 v143, v143, v151
    v_cvt_pk_bf16_f32 v168, v136, v138
    v_mfma_f32_16x16x32_bf16 v[200:203], v[124:127], a[28:31], v[200:203]
    v_cvt_pk_bf16_f32 v169, v140, v142
    v_cvt_pk_bf16_f32 v170, v137, v139
    v_mfma_f32_16x16x32_bf16 v[204:207], v[124:127], a[32:35], v[204:207]
    buffer_load_dwordx4 v[92:95], v10, s[40:43], s95 offen offset:3072 sc1
    v_cvt_pk_bf16_f32 v171, v141, v143
    v_mfma_f32_16x16x32_bf16 v[208:211], v[124:127], a[36:39], v[208:211]
    buffer_store_dwordx4 v[168:171], v2, s[40:43], s24 offen offset:0 sc1
    s_waitcnt vmcnt(10)
    v_mfma_f32_16x16x32_bf16 v[192:195], v[128:131], a[40:43], v[192:195]
    s_waitcnt lgkmcnt(0)
    v_add_f32_e64 v152, v152, v160
    v_mfma_f32_16x16x32_bf16 v[196:199], v[128:131], a[44:47], v[196:199]
    v_add_f32 v153, v153, v161
    v_add_f32 v154, v154, v162
    v_mfma_f32_16x16x32_bf16 v[200:203], v[128:131], a[48:51], v[200:203]
    s_mov_b32 s95, 59392
    v_add_f32_e64 v155, v155, v163
    v_mfma_f32_16x16x32_bf16 v[204:207], v[128:131], a[52:55], v[204:207]
    buffer_load_dwordx4 v[96:99], v10, s[40:43], s95 offen offset:0 sc1
    v_add_f32_e64 v156, v156, v164
    v_mfma_f32_16x16x32_bf16 v[208:211], v[128:131], a[56:59], v[208:211]
    v_add_f32 v157, v157, v165
    s_waitcnt vmcnt(10)
    v_mfma_f32_16x16x32_bf16 v[192:195], v[132:135], a[60:63], v[192:195]
    v_add_f32 v158, v158, v166
    v_add_f32 v159, v159, v167
    v_mfma_f32_16x16x32_bf16 v[196:199], v[132:135], a[64:67], v[196:199]
    v_cvt_pk_bf16_f32 v172, v152, v154
    v_cvt_pk_bf16_f32 v173, v156, v158
    v_mfma_f32_16x16x32_bf16 v[200:203], v[132:135], a[68:71], v[200:203]
    global_load_dwordx4 v[48:51], v17, s[30:31]
    v_cvt_pk_bf16_f32 v174, v153, v155
    v_mfma_f32_16x16x32_bf16 v[204:207], v[132:135], a[72:75], v[204:207]
    v_cvt_pk_bf16_f32 v175, v157, v159
    v_mfma_f32_16x16x32_bf16 v[208:211], v[132:135], a[76:79], v[208:211]
    buffer_store_dwordx4 v[172:175], v2, s[40:43], s24 offen offset:1024 sc1
    s_waitcnt vmcnt(11)
    v_mfma_f32_16x16x32_bf16 v[192:195], v[64:67], a[80:83], v[192:195]
    s_lshl_b32 s78, s69, 7
    s_add_u32 s78, s78, 163840
    s_mul_i32 s74, s64, 5200
    v_mfma_f32_16x16x32_bf16 v[196:199], v[64:67], a[84:87], v[196:199]
    buffer_load_dwordx4 v[100:103], v10, s[40:43], s95 offen offset:1024 sc1
    s_mov_b32 m0, s74
    v_mfma_f32_16x16x32_bf16 v[200:203], v[64:67], a[88:91], v[200:203]
    s_cmp_lt_u32 s64, 2
    s_cselect_b32 s79, 262144, 0
    s_mov_b32 s80, 131072
    v_mfma_f32_16x16x32_bf16 v[204:207], v[64:67], a[92:95], v[204:207]
    v_mov_b32 v52, 0xbfb8aa3b
    v_mov_b32_e64 v53, 1.0
    v_mfma_f32_16x16x32_bf16 v[208:211], v[64:67], a[96:99], v[208:211]
    s_mov_b32 s13, 20480
    s_mov_b32 s14, 40960
    s_waitcnt vmcnt(11)
    v_mfma_f32_16x16x32_bf16 v[192:195], v[68:71], a[100:103], v[192:195]
    s_mov_b32 s15, 61440
    v_mfma_f32_16x16x32_bf16 v[196:199], v[68:71], a[104:107], v[196:199]
    buffer_load_dwordx4 v[104:107], v10, s[40:43], s95 offen offset:2048 sc1
    v_mfma_f32_16x16x32_bf16 v[200:203], v[68:71], a[108:111], v[200:203]
    v_mfma_f32_16x16x32_bf16 v[204:207], v[68:71], a[112:115], v[204:207]
    v_mfma_f32_16x16x32_bf16 v[208:211], v[68:71], a[116:119], v[208:211]
    s_waitcnt vmcnt(11)
    v_mfma_f32_16x16x32_bf16 v[192:195], v[72:75], a[120:123], v[192:195]
    buffer_load_dwordx4 v[108:111], v10, s[40:43], s95 offen offset:3072 sc1
    v_mfma_f32_16x16x32_bf16 v[196:199], v[72:75], a[124:127], v[196:199]
    v_mfma_f32_16x16x32_bf16 v[200:203], v[72:75], a[128:131], v[200:203]
    v_mfma_f32_16x16x32_bf16 v[204:207], v[72:75], a[132:135], v[204:207]
    v_mfma_f32_16x16x32_bf16 v[208:211], v[72:75], a[136:139], v[208:211]
    s_mov_b32 s95, 63488
    s_waitcnt vmcnt(11)
    v_mfma_f32_16x16x32_bf16 v[192:195], v[76:79], a[140:143], v[192:195]
    buffer_load_dwordx4 v[112:115], v10, s[40:43], s95 offen offset:0 sc1
    v_mfma_f32_16x16x32_bf16 v[196:199], v[76:79], a[144:147], v[196:199]
    v_mfma_f32_16x16x32_bf16 v[200:203], v[76:79], a[148:151], v[200:203]
    v_mfma_f32_16x16x32_bf16 v[204:207], v[76:79], a[152:155], v[204:207]
    v_mfma_f32_16x16x32_bf16 v[208:211], v[76:79], a[156:159], v[208:211]
    buffer_load_dwordx4 v[116:119], v10, s[40:43], s95 offen offset:1024 sc1
    s_waitcnt vmcnt(12)
    v_mfma_f32_16x16x32_bf16 v[212:215], v[80:83], a[160:163], 0
    v_mfma_f32_16x16x32_bf16 v[216:219], v[80:83], a[164:167], 0
    v_mfma_f32_16x16x32_bf16 v[220:223], v[80:83], a[168:171], 0
    v_mfma_f32_16x16x32_bf16 v[224:227], v[80:83], a[172:175], 0
    ds_write_addtid_b32 v192 offset:33792
    ds_write_addtid_b32 v193 offset:34048
    v_mfma_f32_16x16x32_bf16 v[228:231], v[80:83], a[176:179], 0
    buffer_load_dwordx4 v[120:123], v10, s[40:43], s95 offen offset:2048 sc1
    s_waitcnt vmcnt(12)
    v_mfma_f32_16x16x32_bf16 v[212:215], v[84:87], a[180:183], v[212:215]
    ds_write_addtid_b32 v194 offset:34304
    ds_write_addtid_b32 v195 offset:34560
    v_mfma_f32_16x16x32_bf16 v[216:219], v[84:87], a[184:187], v[216:219]
    ds_write_addtid_b32 v196 offset:34832
    ds_write_addtid_b32 v197 offset:35088
    v_mfma_f32_16x16x32_bf16 v[220:223], v[84:87], a[188:191], v[220:223]
    ds_write_addtid_b32 v198 offset:35344
    ds_write_addtid_b32 v199 offset:35600
    v_mfma_f32_16x16x32_bf16 v[224:227], v[84:87], a[192:195], v[224:227]
    buffer_load_dwordx4 v[124:127], v10, s[40:43], s95 offen offset:3072 sc1
    ds_write_addtid_b32 v200 offset:35872
    v_mfma_f32_16x16x32_bf16 v[228:231], v[84:87], a[196:199], v[228:231]
    ds_write_addtid_b32 v201 offset:36128
    s_waitcnt vmcnt(12)
    v_mfma_f32_16x16x32_bf16 v[212:215], v[88:91], a[200:203], v[212:215]
    ds_write_addtid_b32 v202 offset:36384
    ds_write_addtid_b32 v203 offset:36640
    v_mfma_f32_16x16x32_bf16 v[216:219], v[88:91], a[204:207], v[216:219]
    s_mov_b32 s95, 67584
    ds_write_addtid_b32 v204 offset:36912
    v_mfma_f32_16x16x32_bf16 v[220:223], v[88:91], a[208:211], v[220:223]
    buffer_load_dwordx4 v[128:131], v11, s[40:43], s95 offen offset:0 sc1
    ds_write_addtid_b32 v205 offset:37168
    v_mfma_f32_16x16x32_bf16 v[224:227], v[88:91], a[212:215], v[224:227]
    ds_write_addtid_b32 v206 offset:37424
    ds_write_addtid_b32 v207 offset:37680
    v_mfma_f32_16x16x32_bf16 v[228:231], v[88:91], a[216:219], v[228:231]
    ds_write_addtid_b32 v208 offset:37952
    s_waitcnt vmcnt(12)
    v_mfma_f32_16x16x32_bf16 v[212:215], v[92:95], a[220:223], v[212:215]
    ds_write_addtid_b32 v209 offset:38208
    ds_write_addtid_b32 v210 offset:38464
    v_mfma_f32_16x16x32_bf16 v[216:219], v[92:95], a[224:227], v[216:219]
    ds_write_addtid_b32 v211 offset:38720
    s_waitcnt vmcnt(9)
    v_lshlrev_b32_e64 v24, 16, v48
    v_mfma_f32_16x16x32_bf16 v[220:223], v[92:95], a[228:231], v[220:223]
    buffer_load_dwordx4 v[132:135], v11, s[40:43], s95 offen offset:1024 sc1
    v_and_b32 v25, 0xffff0000, v48
    v_lshlrev_b32_e64 v26, 16, v49
    v_mfma_f32_16x16x32_bf16 v[224:227], v[92:95], a[232:235], v[224:227]
    v_and_b32 v27, 0xffff0000, v49
    v_lshlrev_b32_e64 v28, 16, v50
    v_and_b32 v29, 0xffff0000, v50
    v_mfma_f32_16x16x32_bf16 v[228:231], v[92:95], a[236:239], v[228:231]
    v_lshlrev_b32_e64 v30, 16, v51
    v_and_b32 v31, 0xffff0000, v51
    s_waitcnt vmcnt(9)
    v_mfma_f32_16x16x32_bf16 v[212:215], v[96:99], a[240:243], v[212:215]
    s_mov_b32 s95, 110592
    v_mfma_f32_16x16x32_bf16 v[216:219], v[96:99], a[244:247], v[216:219]
    buffer_load_dwordx4 v[64:67], v10, s[40:43], s95 offen offset:0 sc1
    v_mfma_f32_16x16x32_bf16 v[220:223], v[96:99], a[248:251], v[220:223]
    v_mfma_f32_16x16x32_bf16 v[224:227], v[96:99], a[252:255], v[224:227]
    s_waitcnt lgkmcnt(0)
    s_barrier
    v_mfma_f32_16x16x32_bf16 v[228:231], v[96:99], v[232:235], v[228:231]
    s_cmp_lg_u32 s64, 0
    s_cbranch_scc1 L_fs_13
    s_mov_b64 exec, 1
    buffer_store_dwordx2 v[22:23], v2, s[40:43], s78 offen sc1
    s_mov_b64 exec, -1
L_fs_13:
    s_waitcnt vmcnt(9)
    v_mfma_f32_16x16x32_bf16 v[212:215], v[100:103], v[236:239], v[212:215]
    ds_read_b128 v[136:139], v14 offset:0
    ds_read_b128 v[140:143], v14 offset:16
    v_mfma_f32_16x16x32_bf16 v[216:219], v[100:103], v[240:243], v[216:219]
    buffer_load_dwordx4 v[68:71], v10, s[40:43], s95 offen offset:1024 sc1
    ds_read_b128 v[144:147], v14 offset:5200
    v_mfma_f32_16x16x32_bf16 v[220:223], v[100:103], v[244:247], v[220:223]
    ds_read_b128 v[148:151], v14 offset:5216
    ds_read_b128 v[152:155], v14 offset:10400
    v_mfma_f32_16x16x32_bf16 v[224:227], v[100:103], v[248:251], v[224:227]
    ds_read_b128 v[156:159], v14 offset:10416
    ds_read_b128 v[160:163], v14 offset:15600
    v_mfma_f32_16x16x32_bf16 v[228:231], v[100:103], v[252:255], v[228:231]
    ds_read_b128 v[164:167], v14 offset:15616
    s_waitcnt vmcnt(9)
    v_mfma_f32_16x16x32_bf16 v[212:215], v[104:107], a[0:3], v[212:215]
    buffer_load_dwordx4 v[72:75], v10, s[40:43], s95 offen offset:2048 sc1
    v_mfma_f32_16x16x32_bf16 v[216:219], v[104:107], a[4:7], v[216:219]
    s_waitcnt lgkmcnt(6)
    v_add_f32 v136, v136, v24
    v_add_f32 v137, v137, v25
    v_mfma_f32_16x16x32_bf16 v[220:223], v[104:107], a[8:11], v[220:223]
    v_add_f32 v138, v138, v26
    v_add_f32 v139, v139, v27
    v_add_f32_e64 v140, v140, v28
    v_mfma_f32_16x16x32_bf16 v[224:227], v[104:107], a[12:15], v[224:227]
    v_add_f32 v141, v141, v29
    v_add_f32 v142, v142, v30
    v_add_f32_e64 v143, v143, v31
    v_mfma_f32_16x16x32_bf16 v[228:231], v[104:107], a[16:19], v[228:231]
    buffer_load_dwordx4 v[76:79], v10, s[40:43], s95 offen offset:3072 sc1
    s_waitcnt lgkmcnt(4) vmcnt(10)
    v_mfma_f32_16x16x32_bf16 v[212:215], v[108:111], a[20:23], v[212:215]
    v_add_f32 v136, v136, v144
    v_add_f32 v137, v137, v145
    v_add_f32 v138, v138, v146
    v_mfma_f32_16x16x32_bf16 v[216:219], v[108:111], a[24:27], v[216:219]
    v_add_f32 v139, v139, v147
    v_add_f32 v140, v140, v148
    v_add_f32_e64 v141, v141, v149
    v_mfma_f32_16x16x32_bf16 v[220:223], v[108:111], a[28:31], v[220:223]
    v_add_f32 v142, v142, v150
    v_add_f32_e64 v143, v143, v151
    s_waitcnt lgkmcnt(0)
    v_mfma_f32_16x16x32_bf16 v[224:227], v[108:111], a[32:35], v[224:227]
    s_mov_b32 s95, 114688
    v_add_f32 v152, v152, v160
    v_add_f32 v153, v153, v161
    v_mfma_f32_16x16x32_bf16 v[228:231], v[108:111], a[36:39], v[228:231]
    buffer_load_dwordx4 v[80:83], v10, s[40:43], s95 offen offset:0 sc1
    v_add_f32 v154, v154, v162
    s_waitcnt vmcnt(10)
    v_mfma_f32_16x16x32_bf16 v[212:215], v[112:115], a[40:43], v[212:215]
    v_add_f32 v155, v155, v163
    v_add_f32 v156, v156, v164
    v_add_f32_e64 v157, v157, v165
    v_mfma_f32_16x16x32_bf16 v[216:219], v[112:115], a[44:47], v[216:219]
    v_add_f32 v158, v158, v166
    v_add_f32 v159, v159, v167
    v_add_f32_e64 v136, v136, v152
    v_mfma_f32_16x16x32_bf16 v[220:223], v[112:115], a[48:51], v[220:223]
    v_add_f32 v137, v137, v153
    v_add_f32 v138, v138, v154
    v_add_f32_e64 v139, v139, v155
    v_mfma_f32_16x16x32_bf16 v[224:227], v[112:115], a[52:55], v[224:227]
    buffer_load_dwordx4 v[84:87], v10, s[40:43], s95 offen offset:1024 sc1
    v_add_f32 v140, v140, v156
    v_add_f32 v141, v141, v157
    v_mfma_f32_16x16x32_bf16 v[228:231], v[112:115], a[56:59], v[228:231]
    v_add_f32 v142, v142, v158
    v_add_f32_e64 v143, v143, v159
    s_waitcnt vmcnt(10)
    v_mfma_f32_16x16x32_bf16 v[212:215], v[116:119], a[60:63], v[212:215]
    v_mul_f32 v144, v52, v136
    v_mul_f32 v145, v52, v137
    v_mul_f32_e64 v146, v52, v138
    v_mfma_f32_16x16x32_bf16 v[216:219], v[116:119], a[64:67], v[216:219]
    v_mul_f32 v147, v52, v139
    v_mul_f32 v148, v52, v140
    v_mul_f32_e64 v149, v52, v141
    v_mfma_f32_16x16x32_bf16 v[220:223], v[116:119], a[68:71], v[220:223]
    v_mul_f32 v150, v52, v142
    v_mul_f32 v151, v52, v143
    v_mfma_f32_16x16x32_bf16 v[224:227], v[116:119], a[72:75], v[224:227]
    buffer_load_dwordx4 v[88:91], v10, s[40:43], s95 offen offset:2048 sc1
    v_exp_f32_e64 v144, v144
    v_mfma_f32_16x16x32_bf16 v[228:231], v[116:119], a[76:79], v[228:231]
    v_exp_f32 v145, v145
    s_waitcnt vmcnt(10)
    v_mfma_f32_16x16x32_bf16 v[212:215], v[120:123], a[80:83], v[212:215]
    v_exp_f32_e64 v146, v146
    v_mfma_f32_16x16x32_bf16 v[216:219], v[120:123], a[84:87], v[216:219]
    v_exp_f32_e64 v147, v147
    v_mfma_f32_16x16x32_bf16 v[220:223], v[120:123], a[88:91], v[220:223]
    buffer_load_dwordx4 v[92:95], v10, s[40:43], s95 offen offset:3072 sc1
    v_exp_f32_e64 v148, v148
    v_mfma_f32_16x16x32_bf16 v[224:227], v[120:123], a[92:95], v[224:227]
    v_exp_f32_e64 v149, v149
    v_mfma_f32_16x16x32_bf16 v[228:231], v[120:123], a[96:99], v[228:231]
    v_exp_f32 v150, v150
    s_waitcnt vmcnt(10)
    v_mfma_f32_16x16x32_bf16 v[212:215], v[124:127], a[100:103], v[212:215]
    s_mov_b32 s95, 118784
    v_exp_f32_e64 v151, v151
    v_mfma_f32_16x16x32_bf16 v[216:219], v[124:127], a[104:107], v[216:219]
    buffer_load_dwordx4 v[96:99], v10, s[40:43], s95 offen offset:0 sc1
    v_add_f32 v144, 1.0, v144
    v_add_f32 v145, 1.0, v145
    v_mfma_f32_16x16x32_bf16 v[220:223], v[124:127], a[108:111], v[220:223]
    v_add_f32 v146, 1.0, v146
    v_add_f32 v147, 1.0, v147
    v_add_f32_e64 v148, 1.0, v148
    v_mfma_f32_16x16x32_bf16 v[224:227], v[124:127], a[112:115], v[224:227]
    v_add_f32 v149, 1.0, v149
    v_add_f32 v150, 1.0, v150
    v_add_f32_e64 v151, 1.0, v151
    v_mfma_f32_16x16x32_bf16 v[228:231], v[124:127], a[116:119], v[228:231]
    v_rcp_f32 v144, v144
    s_waitcnt vmcnt(10)
    v_mfma_f32_16x16x32_bf16 v[212:215], v[128:131], a[120:123], v[212:215]
    v_rcp_f32_e64 v145, v145
    v_mfma_f32_16x16x32_bf16 v[216:219], v[128:131], a[124:127], v[216:219]
    buffer_load_dwordx4 v[100:103], v10, s[40:43], s95 offen offset:1024 sc1
    v_rcp_f32_e64 v146, v146
    v_mfma_f32_16x16x32_bf16 v[220:223], v[128:131], a[128:131], v[220:223]
    v_rcp_f32_e64 v147, v147
    v_mfma_f32_16x16x32_bf16 v[224:227], v[128:131], a[132:135], v[224:227]
    v_rcp_f32_e64 v148, v148
    v_mfma_f32_16x16x32_bf16 v[228:231], v[128:131], a[136:139], v[228:231]
    v_rcp_f32 v149, v149
    s_waitcnt vmcnt(10)
    v_mfma_f32_16x16x32_bf16 v[212:215], v[132:135], a[140:143], v[212:215]
    buffer_load_dwordx4 v[104:107], v10, s[40:43], s95 offen offset:2048 sc1
    v_rcp_f32_e64 v150, v150
    v_mfma_f32_16x16x32_bf16 v[216:219], v[132:135], a[144:147], v[216:219]
    v_rcp_f32 v151, v151
    v_mul_f32 v168, v136, v144
    v_mfma_f32_16x16x32_bf16 v[220:223], v[132:135], a[148:151], v[220:223]
    v_mul_f32 v169, v137, v145
    v_mul_f32 v170, v138, v146
    v_mul_f32_e64 v171, v139, v147
    v_mfma_f32_16x16x32_bf16 v[224:227], v[132:135], a[152:155], v[224:227]
    v_mul_f32 v172, v140, v148
    v_mul_f32 v173, v141, v149
    v_mul_f32_e64 v174, v142, v150
    v_mfma_f32_16x16x32_bf16 v[228:231], v[132:135], a[156:159], v[228:231]
    v_mul_f32 v175, v143, v151
    s_waitcnt vmcnt(10)
    v_mfma_f32_16x16x32_bf16 v[192:195], v[64:67], a[160:163], 0
    buffer_load_dwordx4 v[108:111], v10, s[40:43], s95 offen offset:3072 sc1
    v_mfma_f32_16x16x32_bf16 v[196:199], v[64:67], a[164:167], 0
    v_mfma_f32_16x16x32_bf16 v[200:203], v[64:67], a[168:171], 0
    v_mfma_f32_16x16x32_bf16 v[204:207], v[64:67], a[172:175], 0
    s_mov_b32 s95, 122880
    ds_write_addtid_b32 v212 offset:54592
    v_mfma_f32_16x16x32_bf16 v[208:211], v[64:67], a[176:179], 0
    buffer_load_dwordx4 v[112:115], v11, s[40:43], s95 offen offset:0 sc1
    s_waitcnt vmcnt(11)
    v_mfma_f32_16x16x32_bf16 v[192:195], v[68:71], a[180:183], v[192:195]
    ds_write_addtid_b32 v213 offset:54848
    ds_write_addtid_b32 v214 offset:55104
    v_mfma_f32_16x16x32_bf16 v[196:199], v[68:71], a[184:187], v[196:199]
    ds_write_addtid_b32 v215 offset:55360
    ds_write_addtid_b32 v216 offset:55632
    v_mfma_f32_16x16x32_bf16 v[200:203], v[68:71], a[188:191], v[200:203]
    ds_write_addtid_b32 v217 offset:55888
    ds_write_addtid_b32 v218 offset:56144
    v_mfma_f32_16x16x32_bf16 v[204:207], v[68:71], a[192:195], v[204:207]
    buffer_load_dwordx4 v[116:119], v11, s[40:43], s95 offen offset:1024 sc1
    ds_write_addtid_b32 v219 offset:56400
    v_mfma_f32_16x16x32_bf16 v[208:211], v[68:71], a[196:199], v[208:211]
    ds_write_addtid_b32 v220 offset:56672
    s_waitcnt vmcnt(11)
    v_mfma_f32_16x16x32_bf16 v[192:195], v[72:75], a[200:203], v[192:195]
    ds_write_addtid_b32 v221 offset:56928
    ds_write_addtid_b32 v222 offset:57184
    v_mfma_f32_16x16x32_bf16 v[196:199], v[72:75], a[204:207], v[196:199]
    ds_write_addtid_b32 v223 offset:57440
    ds_write_addtid_b32 v224 offset:57712
    v_mfma_f32_16x16x32_bf16 v[200:203], v[72:75], a[208:211], v[200:203]
    s_mov_b32 s95, 165888
    ds_write_addtid_b32 v225 offset:57968
    v_mfma_f32_16x16x32_bf16 v[204:207], v[72:75], a[212:215], v[204:207]
    buffer_load_dwordx4 v[120:123], v10, s[40:43], s95 offen offset:0 sc1
    ds_write_addtid_b32 v226 offset:58224
    v_mfma_f32_16x16x32_bf16 v[208:211], v[72:75], a[216:219], v[208:211]
    ds_write_addtid_b32 v227 offset:58480
    s_waitcnt vmcnt(11)
    v_mfma_f32_16x16x32_bf16 v[192:195], v[76:79], a[220:223], v[192:195]
    ds_write_addtid_b32 v228 offset:58752
    ds_write_addtid_b32 v229 offset:59008
    v_mfma_f32_16x16x32_bf16 v[196:199], v[76:79], a[224:227], v[196:199]
    ds_write_addtid_b32 v230 offset:59264
    ds_write_addtid_b32 v231 offset:59520
    v_mfma_f32_16x16x32_bf16 v[200:203], v[76:79], a[228:231], v[200:203]
    buffer_load_dwordx4 v[124:127], v10, s[40:43], s95 offen offset:1024 sc1
    v_mfma_f32_16x16x32_bf16 v[204:207], v[76:79], a[232:235], v[204:207]
    v_mfma_f32_16x16x32_bf16 v[208:211], v[76:79], a[236:239], v[208:211]
    s_waitcnt vmcnt(11)
    v_mfma_f32_16x16x32_bf16 v[192:195], v[80:83], a[240:243], v[192:195]
    s_waitcnt lgkmcnt(0)
    s_barrier
    ds_read_b128 v[136:139], v14 offset:20800
    v_mfma_f32_16x16x32_bf16 v[196:199], v[80:83], a[244:247], v[196:199]
    ds_read_b128 v[140:143], v14 offset:20816
    ds_read_b128 v[144:147], v14 offset:26000
    v_mfma_f32_16x16x32_bf16 v[200:203], v[80:83], a[248:251], v[200:203]
    s_mov_b32 s77, 0
    buffer_load_dwordx4 v[32:35], v13, s[56:59], s77 offen
    v_mfma_f32_16x16x32_bf16 v[204:207], v[80:83], a[252:255], v[204:207]
    ds_read_b128 v[148:151], v14 offset:26016
    ds_read_b128 v[152:155], v14 offset:31200
    v_mfma_f32_16x16x32_bf16 v[208:211], v[80:83], v[232:235], v[208:211]
    ds_read_b128 v[156:159], v14 offset:31216
    s_waitcnt vmcnt(11)
    v_mfma_f32_16x16x32_bf16 v[192:195], v[84:87], v[236:239], v[192:195]
    ds_read_b128 v[160:163], v14 offset:36400
    ds_read_b128 v[164:167], v14 offset:36416
    v_mfma_f32_16x16x32_bf16 v[196:199], v[84:87], v[240:243], v[196:199]
    buffer_load_dwordx4 v[128:131], v10, s[40:43], s95 offen offset:2048 sc1
    v_mfma_f32_16x16x32_bf16 v[200:203], v[84:87], v[244:247], v[200:203]
    s_waitcnt lgkmcnt(6)
    v_add_f32 v136, v136, v24
    v_add_f32_e64 v137, v137, v25
    v_mfma_f32_16x16x32_bf16 v[204:207], v[84:87], v[248:251], v[204:207]
    v_add_f32 v138, v138, v26
    v_add_f32 v139, v139, v27
    v_add_f32_e64 v140, v140, v28
    v_mfma_f32_16x16x32_bf16 v[208:211], v[84:87], v[252:255], v[208:211]
    v_add_f32 v141, v141, v29
    v_add_f32_e64 v142, v142, v30
    s_waitcnt vmcnt(11)
    v_mfma_f32_16x16x32_bf16 v[192:195], v[88:91], a[0:3], v[192:195]
    buffer_load_dwordx4 v[132:135], v10, s[40:43], s95 offen offset:3072 sc1
    v_add_f32 v143, v143, v31
    s_waitcnt lgkmcnt(4)
    v_mfma_f32_16x16x32_bf16 v[196:199], v[88:91], a[4:7], v[196:199]
    v_add_f32 v136, v136, v144
    v_add_f32 v137, v137, v145
    v_add_f32_e64 v138, v138, v146
    v_mfma_f32_16x16x32_bf16 v[200:203], v[88:91], a[8:11], v[200:203]
    v_add_f32 v139, v139, v147
    v_add_f32 v140, v140, v148
    v_add_f32_e64 v141, v141, v149
    v_mfma_f32_16x16x32_bf16 v[204:207], v[88:91], a[12:15], v[204:207]
    v_add_f32 v142, v142, v150
    v_add_f32_e64 v143, v143, v151
    s_waitcnt lgkmcnt(0)
    v_mfma_f32_16x16x32_bf16 v[208:211], v[88:91], a[16:19], v[208:211]
    v_add_f32 v152, v152, v160
    v_add_f32_e64 v153, v153, v161
    s_waitcnt vmcnt(11)
    v_mfma_f32_16x16x32_bf16 v[192:195], v[92:95], a[20:23], v[192:195]
    s_mov_b32 s77, 20480
    buffer_load_dwordx4 v[36:39], v13, s[56:59], s77 offen
    v_add_f32_e64 v154, v154, v162
    v_mfma_f32_16x16x32_bf16 v[196:199], v[92:95], a[24:27], v[196:199]
    v_add_f32 v155, v155, v163
    v_add_f32 v156, v156, v164
    v_add_f32_e64 v157, v157, v165
    v_mfma_f32_16x16x32_bf16 v[200:203], v[92:95], a[28:31], v[200:203]
    v_add_f32 v158, v158, v166
    v_add_f32 v159, v159, v167
    v_add_f32_e64 v136, v136, v152
    v_mfma_f32_16x16x32_bf16 v[204:207], v[92:95], a[32:35], v[204:207]
    s_mov_b32 s95, 169984
    v_add_f32 v137, v137, v153
    v_add_f32 v138, v138, v154
    v_mfma_f32_16x16x32_bf16 v[208:211], v[92:95], a[36:39], v[208:211]
    buffer_load_dwordx4 v[64:67], v10, s[40:43], s95 offen offset:0 sc1
    v_add_f32 v139, v139, v155
    s_waitcnt vmcnt(12)
    v_mfma_f32_16x16x32_bf16 v[192:195], v[96:99], a[40:43], v[192:195]
    v_add_f32 v140, v140, v156
    v_add_f32 v141, v141, v157
    v_add_f32_e64 v142, v142, v158
    v_mfma_f32_16x16x32_bf16 v[196:199], v[96:99], a[44:47], v[196:199]
    v_add_f32 v143, v143, v159
    v_mul_f32 v144, v52, v136
    v_mul_f32_e64 v145, v52, v137
    v_mfma_f32_16x16x32_bf16 v[200:203], v[96:99], a[48:51], v[200:203]
    v_mul_f32 v146, v52, v138
    v_mul_f32 v147, v52, v139
    v_mul_f32_e64 v148, v52, v140
    v_mfma_f32_16x16x32_bf16 v[204:207], v[96:99], a[52:55], v[204:207]
    v_mul_f32 v149, v52, v141
    v_mul_f32 v150, v52, v142
    v_mul_f32_e64 v151, v52, v143
    v_mfma_f32_16x16x32_bf16 v[208:211], v[96:99], a[56:59], v[208:211]
    buffer_load_dwordx4 v[68:71], v10, s[40:43], s95 offen offset:1024 sc1
    s_waitcnt vmcnt(12)
    v_mfma_f32_16x16x32_bf16 v[192:195], v[100:103], a[60:63], v[192:195]
    v_exp_f32 v144, v144
    v_mfma_f32_16x16x32_bf16 v[196:199], v[100:103], a[64:67], v[196:199]
    v_exp_f32_e64 v145, v145
    v_mfma_f32_16x16x32_bf16 v[200:203], v[100:103], a[68:71], v[200:203]
    v_exp_f32_e64 v146, v146
    v_mfma_f32_16x16x32_bf16 v[204:207], v[100:103], a[72:75], v[204:207]
    s_mov_b32 s77, 40960
    buffer_load_dwordx4 v[56:59], v13, s[56:59], s77 offen
    v_mfma_f32_16x16x32_bf16 v[208:211], v[100:103], a[76:79], v[208:211]
    v_exp_f32 v147, v147
    s_waitcnt vmcnt(12)
    v_mfma_f32_16x16x32_bf16 v[192:195], v[104:107], a[80:83], v[192:195]
    v_exp_f32_e64 v148, v148
    v_mfma_f32_16x16x32_bf16 v[196:199], v[104:107], a[84:87], v[196:199]
    v_exp_f32_e64 v149, v149
    v_mfma_f32_16x16x32_bf16 v[200:203], v[104:107], a[88:91], v[200:203]
    buffer_load_dwordx4 v[72:75], v10, s[40:43], s95 offen offset:2048 sc1
    v_exp_f32_e64 v150, v150
    v_mfma_f32_16x16x32_bf16 v[204:207], v[104:107], a[92:95], v[204:207]
    v_exp_f32 v151, v151
    v_add_f32 v144, 1.0, v144
    v_mfma_f32_16x16x32_bf16 v[208:211], v[104:107], a[96:99], v[208:211]
    v_add_f32 v145, 1.0, v145
    v_add_f32_e64 v146, 1.0, v146
    s_waitcnt vmcnt(12)
    v_mfma_f32_16x16x32_bf16 v[192:195], v[108:111], a[100:103], v[192:195]
    v_add_f32 v147, 1.0, v147
    v_add_f32 v148, 1.0, v148
    v_add_f32_e64 v149, 1.0, v149
    v_mfma_f32_16x16x32_bf16 v[196:199], v[108:111], a[104:107], v[196:199]
    v_add_f32 v150, 1.0, v150
    v_add_f32 v151, 1.0, v151
    v_mfma_f32_16x16x32_bf16 v[200:203], v[108:111], a[108:111], v[200:203]
    buffer_load_dwordx4 v[76:79], v10, s[40:43], s95 offen offset:3072 sc1
    v_rcp_f32_e64 v144, v144
    v_mfma_f32_16x16x32_bf16 v[204:207], v[108:111], a[112:115], v[204:207]
    v_rcp_f32_e64 v145, v145
    v_mfma_f32_16x16x32_bf16 v[208:211], v[108:111], a[116:119], v[208:211]
    v_rcp_f32 v146, v146
    s_waitcnt vmcnt(12)
    v_mfma_f32_16x16x32_bf16 v[192:195], v[112:115], a[120:123], v[192:195]
    s_mov_b32 s95, 174080
    v_rcp_f32_e64 v147, v147
    v_mfma_f32_16x16x32_bf16 v[196:199], v[112:115], a[124:127], v[196:199]
    buffer_load_dwordx4 v[80:83], v10, s[40:43], s95 offen offset:0 sc1
    v_rcp_f32_e64 v148, v148
    v_mfma_f32_16x16x32_bf16 v[200:203], v[112:115], a[128:131], v[200:203]
    v_rcp_f32_e64 v149, v149
    v_mfma_f32_16x16x32_bf16 v[204:207], v[112:115], a[132:135], v[204:207]
    v_rcp_f32_e64 v150, v150
    v_mfma_f32_16x16x32_bf16 v[208:211], v[112:115], a[136:139], v[208:211]
    v_rcp_f32 v151, v151
    s_waitcnt vmcnt(12)
    v_mfma_f32_16x16x32_bf16 v[192:195], v[116:119], a[140:143], v[192:195]
    v_mul_f32 v176, v136, v144
    v_mul_f32 v177, v137, v145
    v_mul_f32_e64 v178, v138, v146
    v_mfma_f32_16x16x32_bf16 v[196:199], v[116:119], a[144:147], v[196:199]
    s_mov_b32 s77, 61440
    buffer_load_dwordx4 v[60:63], v13, s[56:59], s77 offen
    v_mul_f32_e64 v179, v139, v147
    v_mfma_f32_16x16x32_bf16 v[200:203], v[116:119], a[148:151], v[200:203]
    v_mul_f32 v180, v140, v148
    v_mul_f32 v181, v141, v149
    v_mul_f32_e64 v182, v142, v150
    v_mfma_f32_16x16x32_bf16 v[204:207], v[116:119], a[152:155], v[204:207]
    v_mul_f32_e64 v183, v143, v151
    v_mfma_f32_16x16x32_bf16 v[208:211], v[116:119], a[156:159], v[208:211]
    s_waitcnt vmcnt(12)
    v_mfma_f32_16x16x32_bf16 v[212:215], v[120:123], a[160:163], 0
    buffer_load_dwordx4 v[84:87], v10, s[40:43], s95 offen offset:1024 sc1
    v_mfma_f32_16x16x32_bf16 v[216:219], v[120:123], a[164:167], 0
    v_mfma_f32_16x16x32_bf16 v[220:223], v[120:123], a[168:171], 0
    v_mfma_f32_16x16x32_bf16 v[224:227], v[120:123], a[172:175], 0
    ds_write_addtid_b32 v192 offset:33792
    ds_write_addtid_b32 v193 offset:34048
    v_mfma_f32_16x16x32_bf16 v[228:231], v[120:123], a[176:179], 0
    buffer_load_dwordx4 v[88:91], v10, s[40:43], s95 offen offset:2048 sc1
    s_waitcnt vmcnt(13)
    v_mfma_f32_16x16x32_bf16 v[212:215], v[124:127], a[180:183], v[212:215]
    buffer_load_dwordx2 v[20:21], v19, s[40:43], 0 offen sc1
    ds_write_addtid_b32 v194 offset:34304
    v_mfma_f32_16x16x32_bf16 v[216:219], v[124:127], a[184:187], v[216:219]
    ds_write_addtid_b32 v195 offset:34560
    ds_write_addtid_b32 v196 offset:34832
    v_mfma_f32_16x16x32_bf16 v[220:223], v[124:127], a[188:191], v[220:223]
    ds_write_addtid_b32 v197 offset:35088
    ds_write_addtid_b32 v198 offset:35344
    v_mfma_f32_16x16x32_bf16 v[224:227], v[124:127], a[192:195], v[224:227]
    ds_write_addtid_b32 v199 offset:35600
    ds_write_addtid_b32 v200 offset:35872
    v_mfma_f32_16x16x32_bf16 v[228:231], v[124:127], a[196:199], v[228:231]
    buffer_load_dwordx4 v[92:95], v10, s[40:43], s95 offen offset:3072 sc1
    s_waitcnt vmcnt(13)
    v_mfma_f32_16x16x32_bf16 v[212:215], v[128:131], a[200:203], v[212:215]
    ds_write_addtid_b32 v201 offset:36128
    ds_write_addtid_b32 v202 offset:36384
    v_mfma_f32_16x16x32_bf16 v[216:219], v[128:131], a[204:207], v[216:219]
    ds_write_addtid_b32 v203 offset:36640
    ds_write_addtid_b32 v204 offset:36912
    v_mfma_f32_16x16x32_bf16 v[220:223], v[128:131], a[208:211], v[220:223]
    s_mov_b32 s95, 178176
    ds_write_addtid_b32 v205 offset:37168
    v_mfma_f32_16x16x32_bf16 v[224:227], v[128:131], a[212:215], v[224:227]
    buffer_load_dwordx4 v[96:99], v11, s[40:43], s95 offen offset:0 sc1
    ds_write_addtid_b32 v206 offset:37424
    v_mfma_f32_16x16x32_bf16 v[228:231], v[128:131], a[216:219], v[228:231]
    ds_write_addtid_b32 v207 offset:37680
    s_waitcnt vmcnt(13)
    v_mfma_f32_16x16x32_bf16 v[212:215], v[132:135], a[220:223], v[212:215]
    ds_write_addtid_b32 v208 offset:37952
    ds_write_addtid_b32 v209 offset:38208
    v_mfma_f32_16x16x32_bf16 v[216:219], v[132:135], a[224:227], v[216:219]
    ds_write_addtid_b32 v210 offset:38464
    ds_write_addtid_b32 v211 offset:38720
    v_mfma_f32_16x16x32_bf16 v[220:223], v[132:135], a[228:231], v[220:223]
    v_mfma_f32_16x16x32_bf16 v[224:227], v[132:135], a[232:235], v[224:227]
    buffer_load_dwordx4 v[100:103], v11, s[40:43], s95 offen offset:1024 sc1
    v_mfma_f32_16x16x32_bf16 v[228:231], v[132:135], a[236:239], v[228:231]
    s_waitcnt vmcnt(12)
    v_mfma_f32_16x16x32_bf16 v[212:215], v[64:67], a[240:243], v[212:215]
    s_waitcnt lgkmcnt(0)
    s_barrier
    ds_read_b128 v[136:139], v14 offset:0
    v_mfma_f32_16x16x32_bf16 v[216:219], v[64:67], a[244:247], v[216:219]
    ds_read_b128 v[140:143], v14 offset:16
    ds_read_b128 v[144:147], v14 offset:5200
    v_mfma_f32_16x16x32_bf16 v[220:223], v[64:67], a[248:251], v[220:223]
    ds_read_b128 v[148:151], v14 offset:5216
    ds_read_b128 v[152:155], v14 offset:10400
    v_mfma_f32_16x16x32_bf16 v[224:227], v[64:67], a[252:255], v[224:227]
    ds_read_b128 v[156:159], v14 offset:10416
    ds_read_b128 v[160:163], v14 offset:15600
    v_mfma_f32_16x16x32_bf16 v[228:231], v[64:67], v[232:235], v[228:231]
    ds_read_b128 v[164:167], v14 offset:15616
    s_waitcnt vmcnt(11)
    v_mfma_f32_16x16x32_bf16 v[212:215], v[68:71], v[236:239], v[212:215]
    v_mfma_f32_16x16x32_bf16 v[216:219], v[68:71], v[240:243], v[216:219]
    s_waitcnt lgkmcnt(6)
    v_add_f32 v136, v136, v24
    v_add_f32_e64 v137, v137, v25
    v_mfma_f32_16x16x32_bf16 v[220:223], v[68:71], v[244:247], v[220:223]
    v_add_f32 v138, v138, v26
    v_add_f32 v139, v139, v27
    v_add_f32_e64 v140, v140, v28
    v_mfma_f32_16x16x32_bf16 v[224:227], v[68:71], v[248:251], v[224:227]
    v_add_f32 v141, v141, v29
    v_add_f32 v142, v142, v30
    v_add_f32_e64 v143, v143, v31
    v_mfma_f32_16x16x32_bf16 v[228:231], v[68:71], v[252:255], v[228:231]
    s_waitcnt lgkmcnt(4)
    v_add_f32 v136, v136, v144
    v_add_f32 v137, v137, v145
    s_waitcnt vmcnt(9)
    v_mfma_f32_16x16x32_bf16 v[212:215], v[72:75], a[0:3], v[212:215]
    v_add_f32 v138, v138, v146
    v_add_f32 v139, v139, v147
    v_add_f32_e64 v140, v140, v148
    v_mfma_f32_16x16x32_bf16 v[216:219], v[72:75], a[4:7], v[216:219]
    v_add_f32 v141, v141, v149
    v_add_f32 v142, v142, v150
    v_add_f32_e64 v143, v143, v151
    v_mfma_f32_16x16x32_bf16 v[220:223], v[72:75], a[8:11], v[220:223]
    s_waitcnt lgkmcnt(0)
    v_add_f32 v152, v152, v160
    v_add_f32_e64 v153, v153, v161
    v_mfma_f32_16x16x32_bf16 v[224:227], v[72:75], a[12:15], v[224:227]
    v_add_f32 v154, v154, v162
    v_add_f32 v155, v155, v163
    v_add_f32_e64 v156, v156, v164
    v_mfma_f32_16x16x32_bf16 v[228:231], v[72:75], a[16:19], v[228:231]
    v_add_f32 v157, v157, v165
    v_add_f32_e64 v158, v158, v166
    s_waitcnt vmcnt(8)
    v_mfma_f32_16x16x32_bf16 v[212:215], v[76:79], a[20:23], v[212:215]
    v_add_f32 v159, v159, v167
    v_add_f32 v136, v136, v152
    v_add_f32_e64 v137, v137, v153
    v_mfma_f32_16x16x32_bf16 v[216:219], v[76:79], a[24:27], v[216:219]
    v_add_f32 v138, v138, v154
    v_add_f32 v139, v139, v155
    v_add_f32_e64 v140, v140, v156
    v_mfma_f32_16x16x32_bf16 v[220:223], v[76:79], a[28:31], v[220:223]
    v_add_f32 v141, v141, v157
    v_add_f32 v142, v142, v158
    v_add_f32_e64 v143, v143, v159
    v_mfma_f32_16x16x32_bf16 v[224:227], v[76:79], a[32:35], v[224:227]
    v_mul_f32 v144, v52, v136
    v_mul_f32 v145, v52, v137
    v_mul_f32_e64 v146, v52, v138
    v_mfma_f32_16x16x32_bf16 v[228:231], v[76:79], a[36:39], v[228:231]
    v_mul_f32 v147, v52, v139
    v_mul_f32_e64 v148, v52, v140
    s_waitcnt vmcnt(7)
    v_mfma_f32_16x16x32_bf16 v[212:215], v[80:83], a[40:43], v[212:215]
    v_mul_f32 v149, v52, v141
    v_mul_f32 v150, v52, v142
    v_mul_f32_e64 v151, v52, v143
    v_mfma_f32_16x16x32_bf16 v[216:219], v[80:83], a[44:47], v[216:219]
    v_exp_f32_e64 v144, v144
    v_mfma_f32_16x16x32_bf16 v[220:223], v[80:83], a[48:51], v[220:223]
    v_exp_f32_e64 v145, v145
    v_mfma_f32_16x16x32_bf16 v[224:227], v[80:83], a[52:55], v[224:227]
    v_exp_f32_e64 v146, v146
    v_mfma_f32_16x16x32_bf16 v[228:231], v[80:83], a[56:59], v[228:231]
    v_exp_f32 v147, v147
    s_waitcnt vmcnt(5)
    v_mfma_f32_16x16x32_bf16 v[212:215], v[84:87], a[60:63], v[212:215]
    s_waitcnt vmcnt(3)
    v_cmp_ne_u64_e64 vcc, s[70:71], v[20:21]
    s_cbranch_vccnz L_poll_12
L_ok_11:
    v_mfma_f32_16x16x32_bf16 v[216:219], v[84:87], a[64:67], v[216:219]
    buffer_load_dwordx4 v[40:43], v12, s[40:43], 0 offen sc1
    v_exp_f32_e64 v148, v148
    v_mfma_f32_16x16x32_bf16 v[220:223], v[84:87], a[68:71], v[220:223]
    buffer_load_dwordx4 v[44:47], v12, s[40:43], s80 offen sc1
    v_exp_f32_e64 v149, v149
    v_mfma_f32_16x16x32_bf16 v[224:227], v[84:87], a[72:75], v[224:227]
    buffer_load_dwordx4 v[48:51], v12, s[40:43], s79 offen sc1
    v_exp_f32_e64 v150, v150
    v_mfma_f32_16x16x32_bf16 v[228:231], v[84:87], a[76:79], v[228:231]
    v_exp_f32_e64 v151, v151
    v_mfma_f32_16x16x32_bf16 v[212:215], v[88:91], a[80:83], v[212:215]
    v_add_f32 v144, 1.0, v144
    v_add_f32 v145, 1.0, v145
    v_add_f32_e64 v146, 1.0, v146
    v_mfma_f32_16x16x32_bf16 v[216:219], v[88:91], a[84:87], v[216:219]
    v_add_f32 v147, 1.0, v147
    v_add_f32 v148, 1.0, v148
    v_add_f32_e64 v149, 1.0, v149
    v_mfma_f32_16x16x32_bf16 v[220:223], v[88:91], a[88:91], v[220:223]
    v_add_f32 v150, 1.0, v150
    v_add_f32 v151, 1.0, v151
    v_mfma_f32_16x16x32_bf16 v[224:227], v[88:91], a[92:95], v[224:227]
    v_rcp_f32_e64 v144, v144
    v_mfma_f32_16x16x32_bf16 v[228:231], v[88:91], a[96:99], v[228:231]
    v_rcp_f32 v145, v145
    s_waitcnt vmcnt(5)
    v_mfma_f32_16x16x32_bf16 v[212:215], v[92:95], a[100:103], v[212:215]
    v_rcp_f32_e64 v146, v146
    v_mfma_f32_16x16x32_bf16 v[216:219], v[92:95], a[104:107], v[216:219]
    v_rcp_f32_e64 v147, v147
    v_mfma_f32_16x16x32_bf16 v[220:223], v[92:95], a[108:111], v[220:223]
    v_rcp_f32_e64 v148, v148
    v_mfma_f32_16x16x32_bf16 v[224:227], v[92:95], a[112:115], v[224:227]
    v_rcp_f32_e64 v149, v149
    v_mfma_f32_16x16x32_bf16 v[228:231], v[92:95], a[116:119], v[228:231]
    v_rcp_f32 v150, v150
    s_waitcnt vmcnt(4)
    v_mfma_f32_16x16x32_bf16 v[212:215], v[96:99], a[120:123], v[212:215]
    v_rcp_f32 v151, v151
    v_mul_f32 v184, v136, v144
    v_mfma_f32_16x16x32_bf16 v[216:219], v[96:99], a[124:127], v[216:219]
    v_mul_f32 v185, v137, v145
    v_mul_f32 v186, v138, v146
    v_mul_f32_e64 v187, v139, v147
    v_mfma_f32_16x16x32_bf16 v[220:223], v[96:99], a[128:131], v[220:223]
    v_mul_f32 v188, v140, v148
    v_mul_f32 v189, v141, v149
    v_mul_f32_e64 v190, v142, v150
    v_mfma_f32_16x16x32_bf16 v[224:227], v[96:99], a[132:135], v[224:227]
    v_mul_f32_e64 v191, v143, v151
    v_mfma_f32_16x16x32_bf16 v[228:231], v[96:99], a[136:139], v[228:231]
    s_waitcnt vmcnt(3)
    v_mfma_f32_16x16x32_bf16 v[212:215], v[100:103], a[140:143], v[212:215]
    v_mfma_f32_16x16x32_bf16 v[216:219], v[100:103], a[144:147], v[216:219]
    v_mfma_f32_16x16x32_bf16 v[220:223], v[100:103], a[148:151], v[220:223]
    v_mfma_f32_16x16x32_bf16 v[224:227], v[100:103], a[152:155], v[224:227]
    v_mfma_f32_16x16x32_bf16 v[228:231], v[100:103], a[156:159], v[228:231]
    v_lshlrev_b32 v80, 16, v32
    v_and_b32 v81, 0xffff0000, v32
    v_lshlrev_b32_e64 v82, 16, v33
    v_and_b32 v83, 0xffff0000, v33
    v_lshlrev_b32_e64 v84, 16, v34
    v_and_b32 v85, 0xffff0000, v34
    v_lshlrev_b32_e64 v86, 16, v35
    v_and_b32 v87, 0xffff0000, v35
    ds_write_addtid_b32 v212 offset:54592
    ds_write_addtid_b32 v213 offset:54848
    ds_write_addtid_b32 v214 offset:55104
    ds_write_addtid_b32 v215 offset:55360
    ds_write_addtid_b32 v216 offset:55632
    ds_write_addtid_b32 v217 offset:55888
    ds_write_addtid_b32 v218 offset:56144
    ds_write_addtid_b32 v219 offset:56400
    ds_write_addtid_b32 v220 offset:56672
    ds_write_addtid_b32 v221 offset:56928
    ds_write_addtid_b32 v222 offset:57184
    ds_write_addtid_b32 v223 offset:57440
    ds_write_addtid_b32 v224 offset:57712
    ds_write_addtid_b32 v225 offset:57968
    ds_write_addtid_b32 v226 offset:58224
    ds_write_addtid_b32 v227 offset:58480
    ds_write_addtid_b32 v228 offset:58752
    ds_write_addtid_b32 v229 offset:59008
    ds_write_addtid_b32 v230 offset:59264
    ds_write_addtid_b32 v231 offset:59520
    s_waitcnt lgkmcnt(0)
    s_barrier
    ds_read_b128 v[136:139], v14 offset:20800
    ds_read_b128 v[140:143], v14 offset:20816
    ds_read_b128 v[144:147], v14 offset:26000
    ds_read_b128 v[148:151], v14 offset:26016
    ds_read_b128 v[152:155], v14 offset:31200
    ds_read_b128 v[156:159], v14 offset:31216
    ds_read_b128 v[160:163], v14 offset:36400
    ds_read_b128 v[164:167], v14 offset:36416
    v_lshlrev_b32_e64 v88, 16, v36
    v_and_b32 v89, 0xffff0000, v36
    v_lshlrev_b32_e64 v90, 16, v37
    v_and_b32 v91, 0xffff0000, v37
    v_lshlrev_b32_e64 v92, 16, v38
    v_and_b32 v93, 0xffff0000, v38
    v_lshlrev_b32_e64 v94, 16, v39
    v_and_b32 v95, 0xffff0000, v39
    v_lshlrev_b32_e64 v96, 16, v56
    v_and_b32 v97, 0xffff0000, v56
    v_lshlrev_b32_e64 v98, 16, v57
    v_and_b32 v99, 0xffff0000, v57
    v_lshlrev_b32_e64 v100, 16, v58
    v_and_b32 v101, 0xffff0000, v58
    v_lshlrev_b32_e64 v102, 16, v59
    v_and_b32 v103, 0xffff0000, v59
    s_waitcnt lgkmcnt(6)
    v_pk_add_f32 v[136:137], v[136:137], v[24:25]
    v_pk_add_f32 v[138:139], v[138:139], v[26:27]
    v_pk_add_f32 v[140:141], v[140:141], v[28:29]
    v_pk_add_f32 v[142:143], v[142:143], v[30:31]
    s_waitcnt lgkmcnt(4)
    v_pk_add_f32 v[136:137], v[136:137], v[144:145]
    v_pk_add_f32 v[138:139], v[138:139], v[146:147]
    v_pk_add_f32 v[140:141], v[140:141], v[148:149]
    v_pk_add_f32 v[142:143], v[142:143], v[150:151]
    s_waitcnt lgkmcnt(0)
    v_pk_add_f32 v[152:153], v[152:153], v[160:161]
    v_pk_add_f32 v[154:155], v[154:155], v[162:163]
    v_pk_add_f32 v[156:157], v[156:157], v[164:165]
    v_pk_add_f32 v[158:159], v[158:159], v[166:167]
    v_pk_add_f32 v[136:137], v[136:137], v[152:153]
    v_pk_add_f32 v[138:139], v[138:139], v[154:155]
    v_pk_add_f32 v[140:141], v[140:141], v[156:157]
    v_pk_add_f32 v[142:143], v[142:143], v[158:159]
    v_pk_mul_f32 v[144:145], v[136:137], v[52:53] op_sel_hi:[1,0]
    v_pk_mul_f32 v[146:147], v[138:139], v[52:53] op_sel_hi:[1,0]
    v_pk_mul_f32 v[148:149], v[140:141], v[52:53] op_sel_hi:[1,0]
    v_pk_mul_f32 v[150:151], v[142:143], v[52:53] op_sel_hi:[1,0]
    v_exp_f32 v144, v144
    v_exp_f32 v145, v145
    v_exp_f32 v146, v146
    v_exp_f32 v147, v147
    v_exp_f32 v148, v148
    v_exp_f32 v149, v149
    v_exp_f32 v150, v150
    v_exp_f32_e64 v151, v151
    v_pk_add_f32 v[144:145], v[144:145], v[52:53] op_sel:[0,1] op_sel_hi:[1,1]
    v_pk_add_f32 v[146:147], v[146:147], v[52:53] op_sel:[0,1] op_sel_hi:[1,1]
    v_pk_add_f32 v[148:149], v[148:149], v[52:53] op_sel:[0,1] op_sel_hi:[1,1]
    v_pk_add_f32 v[150:151], v[150:151], v[52:53] op_sel:[0,1] op_sel_hi:[1,1]
    s_waitcnt vmcnt(0)
    ds_write_b128 v16, v[40:43] offset:0
    ds_write_b128 v16, v[44:47] offset:4160
    ds_write_b128 v16, v[48:51] offset:8320
    v_rcp_f32 v144, v144
    v_rcp_f32 v145, v145
    v_rcp_f32 v146, v146
    v_rcp_f32 v147, v147
    v_rcp_f32 v148, v148
    v_rcp_f32 v149, v149
    v_rcp_f32 v150, v150
    v_rcp_f32_e64 v151, v151
    v_pk_mul_f32 v[136:137], v[136:137], v[144:145]
    v_pk_mul_f32 v[138:139], v[138:139], v[146:147]
    v_pk_mul_f32 v[140:141], v[140:141], v[148:149]
    v_pk_mul_f32 v[142:143], v[142:143], v[150:151]
    s_waitcnt lgkmcnt(0)
    s_barrier
    ds_read_b64 v[64:65], v15 offset:0
    ds_read_b64 v[66:67], v15 offset:128
    ds_read_b64 v[68:69], v15 offset:256
    ds_read_b64 v[70:71], v15 offset:384
    ds_read_b64 v[72:73], v15 offset:512
    ds_read_b64 v[74:75], v15 offset:640
    ds_read_b64 v[76:77], v15 offset:768
    ds_read_b64 v[78:79], v15 offset:896
    v_lshlrev_b32_e64 v104, 16, v60
    v_and_b32 v105, 0xffff0000, v60
    v_lshlrev_b32_e64 v106, 16, v61
    v_and_b32 v107, 0xffff0000, v61
    v_lshlrev_b32_e64 v108, 16, v62
    v_and_b32 v109, 0xffff0000, v62
    v_lshlrev_b32_e64 v110, 16, v63
    v_and_b32 v111, 0xffff0000, v63
    s_waitcnt lgkmcnt(0)
    v_lshlrev_b32 v112, 16, v64
    v_lshlrev_b32 v113, 16, v66
    v_lshlrev_b32 v114, 16, v68
    v_lshlrev_b32 v115, 16, v70
    v_lshlrev_b32 v116, 16, v72
    v_lshlrev_b32 v117, 16, v74
    v_lshlrev_b32 v118, 16, v76
    v_lshlrev_b32_e64 v119, 16, v78
    v_pk_fma_f32 v[80:81], v[168:169], v[112:113], v[80:81]
    v_pk_fma_f32 v[82:83], v[170:171], v[114:115], v[82:83]
    v_pk_fma_f32 v[84:85], v[172:173], v[116:117], v[84:85]
    v_pk_fma_f32 v[86:87], v[174:175], v[118:119], v[86:87]
    v_cvt_pk_bf16_f32 v32, v80, v81
    v_cvt_pk_bf16_f32 v33, v82, v83
    v_cvt_pk_bf16_f32 v34, v84, v85
    v_cvt_pk_bf16_f32 v35, v86, v87
    buffer_store_dwordx4 v[32:35], v13, s[60:63], 0 offen nt
    v_and_b32 v112, 0xffff0000, v64
    v_and_b32 v113, 0xffff0000, v66
    v_and_b32 v114, 0xffff0000, v68
    v_and_b32 v115, 0xffff0000, v70
    v_and_b32 v116, 0xffff0000, v72
    v_and_b32 v117, 0xffff0000, v74
    v_and_b32 v118, 0xffff0000, v76
    v_and_b32 v119, 0xffff0000, v78
    v_pk_fma_f32 v[88:89], v[176:177], v[112:113], v[88:89]
    v_pk_fma_f32 v[90:91], v[178:179], v[114:115], v[90:91]
    v_pk_fma_f32 v[92:93], v[180:181], v[116:117], v[92:93]
    v_pk_fma_f32 v[94:95], v[182:183], v[118:119], v[94:95]
    v_cvt_pk_bf16_f32 v36, v88, v89
    v_cvt_pk_bf16_f32 v37, v90, v91
    v_cvt_pk_bf16_f32 v38, v92, v93
    v_cvt_pk_bf16_f32 v39, v94, v95
    buffer_store_dwordx4 v[36:39], v13, s[60:63], s13 offen nt
    v_lshlrev_b32 v112, 16, v65
    v_lshlrev_b32 v113, 16, v67
    v_lshlrev_b32 v114, 16, v69
    v_lshlrev_b32 v115, 16, v71
    v_lshlrev_b32 v116, 16, v73
    v_lshlrev_b32 v117, 16, v75
    v_lshlrev_b32 v118, 16, v77
    v_lshlrev_b32 v119, 16, v79
    v_pk_fma_f32 v[96:97], v[184:185], v[112:113], v[96:97]
    v_pk_fma_f32 v[98:99], v[186:187], v[114:115], v[98:99]
    v_pk_fma_f32 v[100:101], v[188:189], v[116:117], v[100:101]
    v_pk_fma_f32 v[102:103], v[190:191], v[118:119], v[102:103]
    v_cvt_pk_bf16_f32 v56, v96, v97
    v_cvt_pk_bf16_f32 v57, v98, v99
    v_cvt_pk_bf16_f32 v58, v100, v101
    v_cvt_pk_bf16_f32 v59, v102, v103
    buffer_store_dwordx4 v[56:59], v13, s[60:63], s14 offen nt
    v_and_b32 v112, 0xffff0000, v65
    v_and_b32 v113, 0xffff0000, v67
    v_and_b32 v114, 0xffff0000, v69
    v_and_b32 v115, 0xffff0000, v71
    v_and_b32 v116, 0xffff0000, v73
    v_and_b32 v117, 0xffff0000, v75
    v_and_b32 v118, 0xffff0000, v77
    v_and_b32 v119, 0xffff0000, v79
    v_pk_fma_f32 v[104:105], v[136:137], v[112:113], v[104:105]
    v_pk_fma_f32 v[106:107], v[138:139], v[114:115], v[106:107]
    v_pk_fma_f32 v[108:109], v[140:141], v[116:117], v[108:109]
    v_pk_fma_f32 v[110:111], v[142:143], v[118:119], v[110:111]
    v_cvt_pk_bf16_f32 v60, v104, v105
    v_cvt_pk_bf16_f32 v61, v106, v107
    v_cvt_pk_bf16_f32 v62, v108, v109
    v_cvt_pk_bf16_f32 v63, v110, v111
    buffer_store_dwordx4 v[60:63], v13, s[60:63], s15 offen nt
L_fin:
L_end:
    s_endpgm
L_poll_3:
    s_mov_b32 s81, 0
L_poll_3_l:
    s_sleep 2
    buffer_load_dwordx2 v[20:21], v47, s[40:43], 0 offen sc1
    s_add_u32 s81, s81, 1
    s_waitcnt vmcnt(0)
    v_cmp_ne_u64_e64 vcc, s[70:71], v[20:21]
    s_cbranch_vccz L_ok_2
    s_cmp_lt_u32 s81, 32768
    s_cbranch_scc1 L_poll_3_l
    s_branch L_ok_2
L_poll_9:
    s_mov_b32 s81, 0
L_poll_9_l:
    s_sleep 2
    buffer_load_dwordx2 v[20:21], v18, s[40:43], 0 offen sc1
    s_add_u32 s81, s81, 1
    s_waitcnt vmcnt(0)
    v_cmp_ne_u64 vcc, s[70:71], v[20:21]
    s_cbranch_vccz L_ok_8
    s_cmp_lt_u32 s81, 32768
    s_cbranch_scc1 L_poll_9_l
    s_branch L_ok_8
L_poll_12:
    s_mov_b32 s81, 0
L_poll_12_l:
    s_sleep 2
    buffer_load_dwordx2 v[20:21], v19, s[40:43], 0 offen sc1
    s_add_u32 s81, s81, 1
    s_waitcnt vmcnt(0)
    v_cmp_ne_u64 vcc, s[70:71], v[20:21]
    s_cbranch_vccz L_ok_11
    s_cmp_lt_u32 s81, 32768
    s_cbranch_scc1 L_poll_12_l
    s_branch L_ok_11
L_spare:
    v_mov_b64 v[192:193], 0
    v_mov_b64 v[194:195], 0
    v_mov_b64 v[196:197], 0
    v_mov_b64 v[198:199], 0
    v_mov_b64 v[200:201], 0
    v_mov_b64 v[202:203], 0
    v_mov_b64 v[204:205], 0
    v_mov_b64 v[206:207], 0
    v_add_u32 v104, 512, v104
    v_add_u32_e64 v105, 4, v105
    global_load_short_d16_hi v192, v104, s[6:7]
    global_load_short_d16_hi v193, v104, s[8:9]
    global_load_short_d16_hi v194, v104, s[10:11]
    global_load_short_d16_hi v195, v104, s[12:13]
    global_load_short_d16_hi v196, v104, s[14:15]
    global_load_short_d16_hi v197, v104, s[16:17]
    global_load_short_d16_hi v198, v105, s[18:19]
    global_load_short_d16_hi v199, v105, s[20:21]
    v_add_u32 v104, 512, v104
    v_add_u32_e64 v105, 4, v105
    global_load_short_d16_hi v200, v104, s[6:7]
    global_load_short_d16_hi v201, v104, s[8:9]
    global_load_short_d16_hi v202, v104, s[10:11]
    global_load_short_d16_hi v203, v104, s[12:13]
    global_load_short_d16_hi v204, v104, s[14:15]
    global_load_short_d16_hi v205, v104, s[16:17]
    global_load_short_d16_hi v206, v105, s[18:19]
    global_load_short_d16_hi v207, v105, s[20:21]
    v_lshlrev_b32 v2, 4, v1
    v_lshlrev_b32 v110, 2, v106
    v_and_b32_e64 v107, 31, v0
    v_mul_u32_u24 v106, 1344, v106
    v_add_u32 v106, 98304, v106
    v_lshl_add_u32 v112, v107, 3, v106
    v_lshl_add_u32 v106, v107, 4, v106
    v_mov_b32 v107, v112
    s_lshl_b32 s77, s64, 7
    s_add_u32 s77, s77, 98304
    v_bfe_u32 v112, v1, 2, 2
    v_mul_u32_u24 v156, 1344, v112
    v_lshrrev_b32_e64 v113, 4, v1
    v_lshl_add_u32 v156, v113, 5, v156
    v_and_b32_e64 v114, 3, v1
    v_lshl_add_u32 v156, v114, 3, v156
    v_add_u32_e64 v156, s77, v156
    v_bfe_u32 v112, v1, 2, 3
    v_lshrrev_b32_e64 v113, 5, v1
    v_lshl_add_u32 v113, v113, 4, v112
    v_lshlrev_b32_e64 v113, 8, v113
    v_lshl_add_u32 v113, v114, 3, v113
    s_lshl_b32 s77, s64, 1
    v_xor_b32 v112, s77, v112
    v_lshl_add_u32 v158, v112, 5, v113
    v_add_u32 v158, 69632, v158
    v_xor_b32_e64 v159, 32, v158
    s_mov_b32 s62, 2621440
    s_mov_b32 s63, 0x20000
    s_mul_i32 s23, s3, 10240
    s_lshl_b32 s77, s64, 10
    s_add_u32 s23, s23, s77
    s_add_u32 s23, s23, 3670016
    s_add_u32 s35, s23, 4096
    s_add_u32 s29, s23, 8192
    s_lshl_b32 s34, s3, 5
    s_add_u32 s34, s34, 1048576
    s_lshl_b32 s22, s2, 2
    s_add_u32 s22, s22, s64
    s_lshl_b32 s22, s22, 11
    s_add_u32 s22, s22, 6291456
    s_add_u32 s32, s22, 262144
    s_lshr_b32 s28, s2, 2
    s_lshl_b32 s28, s28, 7
    s_and_b32 s77, s2, 3
    s_lshl_b32 s77, s77, 3
    s_add_u32 s28, s28, s77
    s_add_u32 s28, s28, 4096
    s_cmp_ge_u32 s64, 2
    s_cselect_b32 s77, 0x70000000, 0
    v_or_b32 v157, s77, v2
    s_lshr_b32 s75, s65, 1
    s_lshl_b32 s75, s75, 3
    s_lshr_b32 s77, s66, 2
    s_add_u32 s75, s75, s77
    s_and_b32 s76, s65, 1
    s_lshl_b32 s76, s76, 2
    s_and_b32 s77, s66, 3
    s_add_u32 s76, s76, s77
    s_lshr_b32 s79, s64, 1
    s_and_b32 s80, s64, 1
    s_lshl_b32 s73, s64, 8
    s_lshl_b32 s77, s79, 9
    v_lshrrev_b32 v112, 4, v1
    v_lshl_add_u32 v114, v112, 4, s77
    v_and_b32 v113, 15, v1
    v_add_u32 v28, 47, v113
    v_mul_u32_u24 v28, 1056, v28
    v_add_u32_e64 v28, v28, v114
    v_and_b32 v31, 127, v0
    s_mul_i32 s77, s79, 4112
    s_add_u32 s77, s77, 122880
    s_lshl_b32 s78, s80, 11
    s_add_u32 s95, s77, s78
    v_lshl_add_u32 v30, v1, 2, s95
    v_lshlrev_b32 v29, 5, v113
    v_sub_u32 v29, s77, v29
    s_cmp_eq_u32 s80, 0
    s_cbranch_scc0 L_adh1s
    s_mov_b32 s36, 0x89abcdef
    s_mov_b32 s37, 0x01234567
    s_mov_b32 s38, 0x00477758
    s_mov_b32 s39, 0xbb122230
    s_mov_b32 s77, 0
    s_mov_b32 s95, 16
    v_lshl_add_u32 v29, v112, 3, v29
    v_add_u32 v29, 3552, v29
    s_branch L_adjs
L_adh1s:
    s_mov_b32 s36, 0x778999a6
    s_mov_b32 s37, 0x330444db
    s_mov_b32 s38, 0x556b0097
    s_mov_b32 s39, 0x223c448a
    s_mov_b32 s77, 22
    s_mov_b32 s95, 34
    v_lshlrev_b32 v115, 9, v112
    v_sub_u32_e64 v26, v29, v115
    v_add_u32 v26, 2016, v26
    v_and_b32 v115, 32, v1
    v_lshlrev_b32 v115, 4, v115
    v_sub_u32 v29, v29, v115
    v_and_b32 v115, 16, v1
    v_sub_u32_e64 v29, v29, v115
    v_add_u32 v29, 3056, v29
L_adjs:
    v_lshlrev_b32_e64 v115, 2, v113
    v_lshrrev_b64 v[24:25], v115, s[36:37]
    v_lshrrev_b64 v[20:21], v115, s[38:39]
    v_and_b32 v24, 15, v24
    v_and_b32 v25, 15, v20
    v_add_u32 v24, s77, v24
    v_add_u32 v25, s95, v25
    v_mul_u32_u24 v24, 1056, v24
    v_mul_u32_u24 v25, 1056, v25
    v_add_u32 v24, v24, v114
    v_add_u32 v25, v25, v114
    s_mul_i32 s95, s79, 16640
    s_add_u32 s95, s95, 33792
    s_add_u32 s74, s95, s78
    v_mul_u32_u24 v42, 4160, v112
    v_lshl_add_u32 v42, v113, 2, v42
    v_lshrrev_b32 v114, 5, v1
    v_lshlrev_b32 v115, 2, v114
    v_sub_u32 v42, v42, v115
    s_add_u32 s77, s95, 4096
    v_add_u32 v42, s77, v42
    s_add_u32 s77, s80, 57
    v_min_u32_e64 v41, s77, v1
    s_mul_i32 s77, s64, 4640
    s_add_u32 s77, s77, 102912
    v_lshl_add_u32 v41, v41, 3, s77
    v_and_b32_e64 v115, 1, v1
    v_mul_u32_u24 v40, 9280, v115
    v_lshrrev_b32 v39, 1, v1
    s_lshl_b32 s77, s64, 6
    v_add_u32_e64 v39, s77, v39
    v_lshl_add_u32 v40, v39, 4, v40
    v_add_u32 v40, 102912, v40
    v_mul_u32_u24 v39, 10240, v39
    v_lshl_add_u32 v39, v115, 4, v39
    s_lshl_b32 s77, s69, 5
    s_add_u32 s77, s77, 3670016
    v_add_u32 v39, s77, v39
    s_lshl_b32 s78, s80, 8
    s_sub_u32 s95, s95, s78
    v_mul_u32_u24 v115, 4640, v115
    v_bfe_u32 v44, v1, 1, 3
    v_lshlrev_b32_e64 v44, 6, v44
    v_lshl_add_u32 v44, v112, 4, v44
    v_sub_u32_e64 v44, v44, v115
    s_mul_i32 s77, s79, 9280
    s_sub_u32 s77, s77, s78
    s_add_u32 s77, s77, 107824
    v_add_u32 v44, s77, v44
    v_and_b32 v115, 3, v1
    v_sub_u32 v43, 3, v115
    v_mul_u32_u24 v43, 4160, v43
    v_lshl_add_u32 v43, v112, 4, v43
    v_and_b32 v45, 12, v1
    v_lshlrev_b32 v45, 2, v45
    v_sub_u32_e64 v43, v43, v45
    s_add_u32 s77, s95, 304
    v_add_u32 v43, s77, v43
    v_and_b32 v45, 24, v1
    v_lshlrev_b32 v45, 1, v45
    v_and_b32 v46, 4, v1
    v_lshl_add_u32 v45, v46, 4, v45
    v_lshl_add_u32 v46, v114, 2, v115
    v_mul_u32_u24 v46, 264, v46
    v_add_u32_e64 v45, v45, v46
    s_mul_i32 s77, s79, 16896
    s_mul_i32 s78, s80, 4224
    s_add_u32 s77, s77, s78
    v_add_u32_e64 v45, s77, v45
    s_lshl_b32 s77, s64, 11
    s_add_u32 s77, s77, 4096
    v_lshrrev_b32_e64 v47, 2, v1
    v_lshl_add_u32 v47, v47, 7, s77
    v_lshl_add_u32 v47, v115, 3, v47
    v_mov_b64 v[62:63], 0
    s_waitcnt vmcnt(27)
    v_lshlrev_b32_e64 v64, 16, v84
    v_and_b32 v65, 0xffff0000, v84
    v_lshlrev_b32_e64 v66, 16, v85
    v_and_b32 v67, 0xffff0000, v85
    v_lshlrev_b32_e64 v68, 16, v86
    v_and_b32 v69, 0xffff0000, v86
    v_lshlrev_b32_e64 v70, 16, v87
    v_and_b32 v71, 0xffff0000, v87
    v_lshlrev_b32_e64 v72, 16, v88
    v_and_b32 v73, 0xffff0000, v88
    v_lshlrev_b32_e64 v74, 16, v89
    v_and_b32 v75, 0xffff0000, v89
    v_lshlrev_b32_e64 v76, 16, v90
    v_and_b32 v77, 0xffff0000, v90
    v_lshlrev_b32_e64 v78, 16, v91
    v_and_b32 v79, 0xffff0000, v91
    v_lshlrev_b32_e64 v80, 16, v92
    v_and_b32 v81, 0xffff0000, v92
    v_lshlrev_b32_e64 v82, 16, v93
    v_and_b32 v83, 0xffff0000, v93
    v_pk_add_f32 v[120:121], v[64:65], v[66:67]
    v_pk_add_f32 v[120:121], v[120:121], v[68:69]
    v_pk_add_f32 v[120:121], v[120:121], v[70:71]
    v_pk_add_f32 v[120:121], v[120:121], v[72:73]
    v_pk_add_f32 v[120:121], v[120:121], v[74:75]
    v_pk_add_f32 v[120:121], v[120:121], v[76:77]
    v_pk_add_f32 v[120:121], v[120:121], v[78:79]
    v_pk_add_f32 v[120:121], v[120:121], v[80:81]
    v_pk_add_f32 v[120:121], v[120:121], v[82:83]
    v_add_f32 v120, v120, v121
    s_nop 1
    v_add_f32_dpp v120, v120, v120 row_ror:8 row_mask:0xf bank_mask:0xf
    s_nop 1
    v_add_f32_dpp v120, v120, v120 row_ror:4 row_mask:0xf bank_mask:0xf
    s_nop 1
    v_add_f32_dpp v120, v120, v120 row_ror:2 row_mask:0xf bank_mask:0xf
    s_nop 1
    v_add_f32_dpp v120, v120, v120 row_ror:1 row_mask:0xf bank_mask:0xf
    v_mov_b32 v121, v120
    s_nop 1
    v_permlane16_swap_b32 v120, v121
    v_add_f32_e64 v120, v120, v121
    v_mul_f32 v124, 0x3acccccd, v120
    v_pk_add_f32 v[64:65], v[64:65], v[124:125] op_sel_hi:[1,0] neg_lo:[0,1] neg_hi:[0,1]
    v_pk_add_f32 v[66:67], v[66:67], v[124:125] op_sel_hi:[1,0] neg_lo:[0,1] neg_hi:[0,1]
    v_pk_add_f32 v[68:69], v[68:69], v[124:125] op_sel_hi:[1,0] neg_lo:[0,1] neg_hi:[0,1]
    v_pk_add_f32 v[70:71], v[70:71], v[124:125] op_sel_hi:[1,0] neg_lo:[0,1] neg_hi:[0,1]
    v_pk_add_f32 v[72:73], v[72:73], v[124:125] op_sel_hi:[1,0] neg_lo:[0,1] neg_hi:[0,1]
    v_pk_add_f32 v[74:75], v[74:75], v[124:125] op_sel_hi:[1,0] neg_lo:[0,1] neg_hi:[0,1]
    v_pk_add_f32 v[76:77], v[76:77], v[124:125] op_sel_hi:[1,0] neg_lo:[0,1] neg_hi:[0,1]
    v_pk_add_f32 v[78:79], v[78:79], v[124:125] op_sel_hi:[1,0] neg_lo:[0,1] neg_hi:[0,1]
    v_pk_add_f32 v[80:81], v[80:81], v[124:125] op_sel_hi:[1,0] neg_lo:[0,1] neg_hi:[0,1]
    v_pk_add_f32 v[82:83], v[82:83], v[124:125] op_sel_hi:[1,0] neg_lo:[0,1] neg_hi:[0,1]
    v_pk_mul_f32 v[120:121], v[64:65], v[64:65]
    v_pk_fma_f32 v[120:121], v[66:67], v[66:67], v[120:121]
    v_pk_fma_f32 v[120:121], v[68:69], v[68:69], v[120:121]
    v_pk_fma_f32 v[120:121], v[70:71], v[70:71], v[120:121]
    v_pk_fma_f32 v[120:121], v[72:73], v[72:73], v[120:121]
    v_pk_fma_f32 v[120:121], v[74:75], v[74:75], v[120:121]
    v_pk_fma_f32 v[120:121], v[76:77], v[76:77], v[120:121]
    v_pk_fma_f32 v[120:121], v[78:79], v[78:79], v[120:121]
    v_pk_fma_f32 v[120:121], v[80:81], v[80:81], v[120:121]
    v_pk_fma_f32 v[120:121], v[82:83], v[82:83], v[120:121]
    v_add_f32 v120, v120, v121
    s_nop 1
    v_add_f32_dpp v120, v120, v120 row_ror:8 row_mask:0xf bank_mask:0xf
    s_nop 1
    v_add_f32_dpp v120, v120, v120 row_ror:4 row_mask:0xf bank_mask:0xf
    s_nop 1
    v_add_f32_dpp v120, v120, v120 row_ror:2 row_mask:0xf bank_mask:0xf
    s_nop 1
    v_add_f32_dpp v120, v120, v120 row_ror:1 row_mask:0xf bank_mask:0xf
    v_mov_b32 v121, v120
    s_nop 1
    v_permlane16_swap_b32 v120, v121
    v_add_f32_e64 v120, v120, v121
    v_mul_f32 v120, 0x3acccccd, v120
    v_cvt_pk_bf16_f32 v120, v120, v124
    v_and_b32 v125, 0xffff0000, v120
    v_lshlrev_b32_e64 v120, 16, v120
    v_add_f32 v120, 0x3727c5ac, v120
    v_cvt_pk_bf16_f32 v120, v120, v120
    v_lshlrev_b32 v120, 16, v120
    v_sqrt_f32 v120, v120
    v_lshrrev_b32 v126, 16, v125
    v_sub_f32 v125, v124, v125
    v_cvt_pk_bf16_f32 v120, v120, v120
    v_xor_b32 v126, 0x8000, v126
    v_lshlrev_b32 v120, 16, v120
    v_or_b32 v126, v126, v120
    v_rcp_f32 v120, v120
    s_nop 0
    v_mul_f32_e64 v122, v125, v120
    v_pk_fma_f32 v[64:65], v[64:65], v[120:121], v[122:123] op_sel_hi:[1,0,0]
    v_cvt_pk_bf16_f32 v84, v64, v65
    v_pk_fma_f32 v[66:67], v[66:67], v[120:121], v[122:123] op_sel_hi:[1,0,0]
    v_cvt_pk_bf16_f32 v85, v66, v67
    v_pk_fma_f32 v[68:69], v[68:69], v[120:121], v[122:123] op_sel_hi:[1,0,0]
    v_cvt_pk_bf16_f32 v86, v68, v69
    v_pk_fma_f32 v[70:71], v[70:71], v[120:121], v[122:123] op_sel_hi:[1,0,0]
    v_cvt_pk_bf16_f32 v87, v70, v71
    v_pk_fma_f32 v[72:73], v[72:73], v[120:121], v[122:123] op_sel_hi:[1,0,0]
    v_cvt_pk_bf16_f32 v88, v72, v73
    v_pk_fma_f32 v[74:75], v[74:75], v[120:121], v[122:123] op_sel_hi:[1,0,0]
    v_cvt_pk_bf16_f32 v89, v74, v75
    v_pk_fma_f32 v[76:77], v[76:77], v[120:121], v[122:123] op_sel_hi:[1,0,0]
    v_cvt_pk_bf16_f32 v90, v76, v77
    v_pk_fma_f32 v[78:79], v[78:79], v[120:121], v[122:123] op_sel_hi:[1,0,0]
    v_cvt_pk_bf16_f32 v91, v78, v79
    v_pk_fma_f32 v[80:81], v[80:81], v[120:121], v[122:123] op_sel_hi:[1,0,0]
    v_cvt_pk_bf16_f32 v92, v80, v81
    v_pk_fma_f32 v[82:83], v[82:83], v[120:121], v[122:123] op_sel_hi:[1,0,0]
    v_cvt_pk_bf16_f32 v93, v82, v83
    ds_write_b128 v106, v[84:87]
    ds_write_b128 v106, v[88:91] offset:512
    ds_write_b64 v107, v[92:93] offset:1024
    s_mov_b32 exec_lo, 1
    s_mov_b32 exec_hi, 1
    buffer_store_dword v126, v110, s[40:43], s34 offen sc1
    s_mov_b64 exec, -1
    s_waitcnt vmcnt(20)
    v_mul_f32 v96, 0x3fb8aa3b, v54
    v_exp_f32 v96, v96
    v_cmp_eq_u32 vcc, 48, v31
    v_cvt_pk_bf16_f32 v96, v96, v96
    v_lshlrev_b32 v96, 16, v96
    v_cndmask_b32 v55, 0, v55, vcc
    v_mul_f32 v97, v96, v48
    v_mul_f32 v98, v96, v49
    v_mul_f32 v97, 0x3fb8aa3b, v97
    v_mul_f32 v98, 0.15915494, v98
    v_exp_f32 v99, v97
    v_fract_f32 v100, v98
    v_cos_f32 v102, v100
    v_sin_f32 v103, v100
    v_mul_f32 v102, v99, v102
    v_mul_f32_e64 v103, v99, v103
    v_mul_f32 v99, 0x41800000, v97
    v_mul_f32 v100, 0x41800000, v98
    v_exp_f32 v99, v99
    v_fract_f32 v100, v100
    v_cos_f32 v104, v100
    v_sin_f32 v105, v100
    v_mul_f32 v104, v99, v104
    v_mul_f32 v105, v99, v105
    v_mul_f32 v99, 0x43800000, v97
    v_mul_f32 v100, 0x43800000, v98
    v_exp_f32 v99, v99
    v_fract_f32 v100, v100
    v_cos_f32 v106, v100
    v_sin_f32 v107, v100
    v_mul_f32 v106, v99, v106
    v_mul_f32 v107, v99, v107
    v_pk_mul_f32 v[108:109], v[50:51], v[52:53] op_sel:[0,0] op_sel_hi:[1,0]
    v_pk_fma_f32 v[114:115], v[50:51], v[52:53], v[108:109] op_sel:[1,1,0] op_sel_hi:[0,1,1] neg_lo:[1,0,0]
    v_pk_mul_f32 v[114:115], v[114:115], v[96:97] op_sel_hi:[1,0]
    v_cvt_pk_bf16_f32 v132, v114, -v115
    v_mov_b32 v133, 0x3f80
    v_cvt_pk_bf16_f32 v134, v104, v105
    v_pk_mul_f32 v[108:109], v[114:115], v[102:103] op_sel:[0,0] op_sel_hi:[1,0]
    v_pk_fma_f32 v[112:113], v[114:115], v[102:103], v[108:109] op_sel:[1,1,0] op_sel_hi:[0,1,1] neg_lo:[1,0,0]
    v_cvt_pk_bf16_f32 v135, v112, -v113
    v_pk_mul_f32 v[108:109], v[112:113], v[102:103] op_sel:[0,0] op_sel_hi:[1,0]
    v_pk_fma_f32 v[116:117], v[112:113], v[102:103], v[108:109] op_sel:[1,1,0] op_sel_hi:[0,1,1] neg_lo:[1,0,0]
    v_cvt_pk_bf16_f32 v136, v116, -v117
    v_pk_mul_f32 v[108:109], v[104:105], v[104:105] op_sel:[0,0] op_sel_hi:[1,0]
    v_pk_fma_f32 v[110:111], v[104:105], v[104:105], v[108:109] op_sel:[1,1,0] op_sel_hi:[0,1,1] neg_lo:[1,0,0]
    v_cvt_pk_bf16_f32 v137, v110, v111
    v_pk_mul_f32 v[108:109], v[116:117], v[102:103] op_sel:[0,0] op_sel_hi:[1,0]
    v_pk_fma_f32 v[112:113], v[116:117], v[102:103], v[108:109] op_sel:[1,1,0] op_sel_hi:[0,1,1] neg_lo:[1,0,0]
    v_cvt_pk_bf16_f32 v138, v112, -v113
    v_pk_mul_f32 v[108:109], v[110:111], v[104:105] op_sel:[0,0] op_sel_hi:[1,0]
    v_pk_fma_f32 v[110:111], v[110:111], v[104:105], v[108:109] op_sel:[1,1,0] op_sel_hi:[0,1,1] neg_lo:[1,0,0]
    v_cvt_pk_bf16_f32 v139, v110, v111
    v_pk_mul_f32 v[108:109], v[112:113], v[102:103] op_sel:[0,0] op_sel_hi:[1,0]
    v_pk_fma_f32 v[118:119], v[112:113], v[102:103], v[108:109] op_sel:[1,1,0] op_sel_hi:[0,1,1] neg_lo:[1,0,0]
    v_cvt_pk_bf16_f32 v140, v118, -v119
    v_pk_mul_f32 v[108:109], v[110:111], v[104:105] op_sel:[0,0] op_sel_hi:[1,0]
    v_pk_fma_f32 v[110:111], v[110:111], v[104:105], v[108:109] op_sel:[1,1,0] op_sel_hi:[0,1,1] neg_lo:[1,0,0]
    v_cvt_pk_bf16_f32 v141, v110, v111
    s_waitcnt vmcnt(17) lgkmcnt(0)
    s_barrier
    ds_read_b64_tr_b16 v[160:161], v156 offset:0
    ds_read_b64_tr_b16 v[162:163], v156 offset:5376
    ds_read_b64_tr_b16 v[164:165], v156 offset:512
    ds_read_b64_tr_b16 v[166:167], v156 offset:5888
    ds_read_b64_tr_b16 v[168:169], v156 offset:1024
    ds_read_b64_tr_b16 v[170:171], v156 offset:6400
    ds_read_b64_tr_b16 v[148:149], v158 offset:0
    ds_read_b64_tr_b16 v[150:151], v158 offset:2048
    ds_read_b64_tr_b16 v[152:153], v159 offset:0
    ds_read_b64_tr_b16 v[154:155], v159 offset:2048
    v_readfirstlane_b32 s70, v94
    v_readfirstlane_b32 s71, v95
    s_nop 1
    s_mul_i32 s70, s70, 0x9E3779B1
    s_add_u32 s70, s70, 0x7F4A7C15
    s_add_u32 s71, s71, 1
    v_mov_b32 v22, s70
    v_mov_b32_e64 v23, s71
    s_waitcnt lgkmcnt(8)
    buffer_store_dwordx4 v[160:163], v2, s[40:43], s23 offen sc1
    s_waitcnt lgkmcnt(6)
    buffer_store_dwordx4 v[164:167], v2, s[40:43], s35 offen sc1
    s_waitcnt lgkmcnt(4)
    buffer_store_dwordx4 v[168:171], v157, s[40:43], s29 offen sc1
    s_waitcnt lgkmcnt(0)
    buffer_store_dwordx4 v[148:151], v2, s[40:43], s22 offen sc1
    buffer_store_dwordx4 v[152:155], v2, s[40:43], s22 offen offset:1024 sc1
    s_cmp_ge_u32 s2, 238
    s_cbranch_scc1 L_nou2
    ds_read_b64_tr_b16 v[172:173], v158 offset:61440
    ds_read_b64_tr_b16 v[174:175], v158 offset:63488
    ds_read_b64_tr_b16 v[176:177], v159 offset:61440
    ds_read_b64_tr_b16 v[178:179], v159 offset:63488
    s_waitcnt lgkmcnt(0)
    buffer_store_dwordx4 v[172:175], v2, s[40:43], s32 offen sc1
    buffer_store_dwordx4 v[176:179], v2, s[40:43], s32 offen offset:1024 sc1
L_nou2:
    v_pk_mul_f32 v[108:109], v[118:119], v[102:103] op_sel:[0,0] op_sel_hi:[1,0]
    v_pk_fma_f32 v[112:113], v[118:119], v[102:103], v[108:109] op_sel:[1,1,0] op_sel_hi:[0,1,1] neg_lo:[1,0,0]
    v_cvt_pk_bf16_f32 v142, v112, -v113
    v_pk_mul_f32 v[108:109], v[110:111], v[104:105] op_sel:[0,0] op_sel_hi:[1,0]
    v_pk_fma_f32 v[110:111], v[110:111], v[104:105], v[108:109] op_sel:[1,1,0] op_sel_hi:[0,1,1] neg_lo:[1,0,0]
    v_cvt_pk_bf16_f32 v143, v110, v111
    v_pk_mul_f32 v[108:109], v[112:113], v[102:103] op_sel:[0,0] op_sel_hi:[1,0]
    v_pk_fma_f32 v[120:121], v[112:113], v[102:103], v[108:109] op_sel:[1,1,0] op_sel_hi:[0,1,1] neg_lo:[1,0,0]
    v_cvt_pk_bf16_f32 v144, v120, -v121
    v_pk_mul_f32 v[108:109], v[110:111], v[104:105] op_sel:[0,0] op_sel_hi:[1,0]
    v_pk_fma_f32 v[110:111], v[110:111], v[104:105], v[108:109] op_sel:[1,1,0] op_sel_hi:[0,1,1] neg_lo:[1,0,0]
    v_cvt_pk_bf16_f32 v145, v110, v111
    v_pk_mul_f32 v[108:109], v[120:121], v[102:103] op_sel:[0,0] op_sel_hi:[1,0]
    v_pk_fma_f32 v[112:113], v[120:121], v[102:103], v[108:109] op_sel:[1,1,0] op_sel_hi:[0,1,1] neg_lo:[1,0,0]
    v_cvt_pk_bf16_f32 v146, v112, -v113
    v_pk_mul_f32 v[108:109], v[110:111], v[104:105] op_sel:[0,0] op_sel_hi:[1,0]
    v_pk_fma_f32 v[110:111], v[110:111], v[104:105], v[108:109] op_sel:[1,1,0] op_sel_hi:[0,1,1] neg_lo:[1,0,0]
    v_cvt_pk_bf16_f32 v147, v110, v111
    s_mov_b32 m0, s73
    s_nop 0
    ds_write_addtid_b32 v132 offset:0
    ds_write_addtid_b32 v133 offset:49632
    ds_write_addtid_b32 v134 offset:50688
    ds_write_addtid_b32 v135 offset:1056
    ds_write_addtid_b32 v136 offset:2112
    ds_write_addtid_b32 v137 offset:51744
    ds_write_addtid_b32 v138 offset:3168
    ds_write_addtid_b32 v139 offset:52800
    ds_write_addtid_b32 v140 offset:4224
    ds_write_addtid_b32 v141 offset:53856
    ds_write_addtid_b32 v142 offset:5280
    ds_write_addtid_b32 v143 offset:54912
    ds_write_addtid_b32 v144 offset:6336
    ds_write_addtid_b32 v145 offset:55968
    ds_write_addtid_b32 v146 offset:7392
    ds_write_addtid_b32 v147 offset:57024
    v_pk_mul_f32 v[108:109], v[112:113], v[102:103] op_sel:[0,0] op_sel_hi:[1,0]
    v_pk_fma_f32 v[122:123], v[112:113], v[102:103], v[108:109] op_sel:[1,1,0] op_sel_hi:[0,1,1] neg_lo:[1,0,0]
    v_cvt_pk_bf16_f32 v132, v122, -v123
    v_pk_mul_f32 v[108:109], v[110:111], v[104:105] op_sel:[0,0] op_sel_hi:[1,0]
    v_pk_fma_f32 v[110:111], v[110:111], v[104:105], v[108:109] op_sel:[1,1,0] op_sel_hi:[0,1,1] neg_lo:[1,0,0]
    v_cvt_pk_bf16_f32 v133, v110, v111
    v_pk_mul_f32 v[108:109], v[122:123], v[102:103] op_sel:[0,0] op_sel_hi:[1,0]
    v_pk_fma_f32 v[112:113], v[122:123], v[102:103], v[108:109] op_sel:[1,1,0] op_sel_hi:[0,1,1] neg_lo:[1,0,0]
    v_cvt_pk_bf16_f32 v134, v112, -v113
    v_pk_mul_f32 v[108:109], v[110:111], v[104:105] op_sel:[0,0] op_sel_hi:[1,0]
    v_pk_fma_f32 v[110:111], v[110:111], v[104:105], v[108:109] op_sel:[1,1,0] op_sel_hi:[0,1,1] neg_lo:[1,0,0]
    v_cvt_pk_bf16_f32 v135, v110, v111
    v_pk_mul_f32 v[108:109], v[112:113], v[102:103] op_sel:[0,0] op_sel_hi:[1,0]
    v_pk_fma_f32 v[124:125], v[112:113], v[102:103], v[108:109] op_sel:[1,1,0] op_sel_hi:[0,1,1] neg_lo:[1,0,0]
    v_cvt_pk_bf16_f32 v136, v124, -v125
    v_pk_mul_f32 v[108:109], v[110:111], v[104:105] op_sel:[0,0] op_sel_hi:[1,0]
    v_pk_fma_f32 v[110:111], v[110:111], v[104:105], v[108:109] op_sel:[1,1,0] op_sel_hi:[0,1,1] neg_lo:[1,0,0]
    v_cvt_pk_bf16_f32 v137, v110, v111
    v_pk_mul_f32 v[108:109], v[124:125], v[102:103] op_sel:[0,0] op_sel_hi:[1,0]
    v_pk_fma_f32 v[112:113], v[124:125], v[102:103], v[108:109] op_sel:[1,1,0] op_sel_hi:[0,1,1] neg_lo:[1,0,0]
    v_cvt_pk_bf16_f32 v138, v112, -v113
    v_pk_mul_f32 v[108:109], v[110:111], v[104:105] op_sel:[0,0] op_sel_hi:[1,0]
    v_pk_fma_f32 v[110:111], v[110:111], v[104:105], v[108:109] op_sel:[1,1,0] op_sel_hi:[0,1,1] neg_lo:[1,0,0]
    v_cvt_pk_bf16_f32 v139, v110, v111
    ds_write_addtid_b32 v132 offset:8448
    ds_write_addtid_b32 v133 offset:58080
    ds_write_addtid_b32 v134 offset:9504
    ds_write_addtid_b32 v135 offset:59136
    ds_write_addtid_b32 v136 offset:10560
    ds_write_addtid_b32 v137 offset:60192
    ds_write_addtid_b32 v138 offset:11616
    ds_write_addtid_b32 v139 offset:61248
    v_pk_mul_f32 v[108:109], v[112:113], v[102:103] op_sel:[0,0] op_sel_hi:[1,0]
    v_pk_fma_f32 v[126:127], v[112:113], v[102:103], v[108:109] op_sel:[1,1,0] op_sel_hi:[0,1,1] neg_lo:[1,0,0]
    v_cvt_pk_bf16_f32 v140, v126, -v127
    v_pk_mul_f32 v[108:109], v[110:111], v[104:105] op_sel:[0,0] op_sel_hi:[1,0]
    v_pk_fma_f32 v[110:111], v[110:111], v[104:105], v[108:109] op_sel:[1,1,0] op_sel_hi:[0,1,1] neg_lo:[1,0,0]
    v_cvt_pk_bf16_f32 v141, v110, v111
    v_pk_mul_f32 v[108:109], v[126:127], v[102:103] op_sel:[0,0] op_sel_hi:[1,0]
    v_pk_fma_f32 v[112:113], v[126:127], v[102:103], v[108:109] op_sel:[1,1,0] op_sel_hi:[0,1,1] neg_lo:[1,0,0]
    v_cvt_pk_bf16_f32 v142, v112, -v113
    v_pk_mul_f32 v[108:109], v[110:111], v[104:105] op_sel:[0,0] op_sel_hi:[1,0]
    v_pk_fma_f32 v[110:111], v[110:111], v[104:105], v[108:109] op_sel:[1,1,0] op_sel_hi:[0,1,1] neg_lo:[1,0,0]
    v_cvt_pk_bf16_f32 v143, v110, v111
    v_pk_mul_f32 v[108:109], v[112:113], v[102:103] op_sel:[0,0] op_sel_hi:[1,0]
    v_pk_fma_f32 v[128:129], v[112:113], v[102:103], v[108:109] op_sel:[1,1,0] op_sel_hi:[0,1,1] neg_lo:[1,0,0]
    v_cvt_pk_bf16_f32 v144, v128, -v129
    v_pk_mul_f32 v[108:109], v[110:111], v[104:105] op_sel:[0,0] op_sel_hi:[1,0]
    v_pk_fma_f32 v[110:111], v[110:111], v[104:105], v[108:109] op_sel:[1,1,0] op_sel_hi:[0,1,1] neg_lo:[1,0,0]
    v_cvt_pk_bf16_f32 v145, v110, v111
    v_pk_mul_f32 v[108:109], v[128:129], v[102:103] op_sel:[0,0] op_sel_hi:[1,0]
    v_pk_fma_f32 v[112:113], v[128:129], v[102:103], v[108:109] op_sel:[1,1,0] op_sel_hi:[0,1,1] neg_lo:[1,0,0]
    v_cvt_pk_bf16_f32 v146, v112, -v113
    v_pk_mul_f32 v[108:109], v[110:111], v[104:105] op_sel:[0,0] op_sel_hi:[1,0]
    v_pk_fma_f32 v[110:111], v[110:111], v[104:105], v[108:109] op_sel:[1,1,0] op_sel_hi:[0,1,1] neg_lo:[1,0,0]
    v_cvt_pk_bf16_f32 v147, v110, v111
    ds_write_addtid_b32 v140 offset:12672
    ds_write_addtid_b32 v141 offset:62304
    ds_write_addtid_b32 v142 offset:13728
    ds_write_addtid_b32 v143 offset:63360
    ds_write_addtid_b32 v144 offset:14784
    ds_write_addtid_b32 v145 offset:64416
    ds_write_addtid_b32 v146 offset:15840
    ds_write_addtid_b32 v147 offset:65472
    v_pk_mul_f32 v[108:109], v[112:113], v[102:103] op_sel:[0,0] op_sel_hi:[1,0]
    v_pk_fma_f32 v[130:131], v[112:113], v[102:103], v[108:109] op_sel:[1,1,0] op_sel_hi:[0,1,1] neg_lo:[1,0,0]
    v_pk_mul_f32 v[108:109], v[114:115], v[106:107] op_sel:[0,0] op_sel_hi:[1,0]
    v_pk_fma_f32 v[114:115], v[114:115], v[106:107], v[108:109] op_sel:[1,1,0] op_sel_hi:[0,1,1] neg_lo:[1,0,0]
    v_cvt_pk_bf16_f32 v132, v114, -v115
    v_pk_mul_f32 v[108:109], v[116:117], v[106:107] op_sel:[0,0] op_sel_hi:[1,0]
    v_pk_fma_f32 v[116:117], v[116:117], v[106:107], v[108:109] op_sel:[1,1,0] op_sel_hi:[0,1,1] neg_lo:[1,0,0]
    v_cvt_pk_bf16_f32 v133, v116, -v117
    v_pk_mul_f32 v[108:109], v[118:119], v[106:107] op_sel:[0,0] op_sel_hi:[1,0]
    v_pk_fma_f32 v[118:119], v[118:119], v[106:107], v[108:109] op_sel:[1,1,0] op_sel_hi:[0,1,1] neg_lo:[1,0,0]
    v_cvt_pk_bf16_f32 v134, v118, -v119
    v_pk_mul_f32 v[108:109], v[120:121], v[106:107] op_sel:[0,0] op_sel_hi:[1,0]
    v_pk_fma_f32 v[120:121], v[120:121], v[106:107], v[108:109] op_sel:[1,1,0] op_sel_hi:[0,1,1] neg_lo:[1,0,0]
    v_cvt_pk_bf16_f32 v135, v120, -v121
    v_pk_mul_f32 v[108:109], v[122:123], v[106:107] op_sel:[0,0] op_sel_hi:[1,0]
    v_pk_fma_f32 v[122:123], v[122:123], v[106:107], v[108:109] op_sel:[1,1,0] op_sel_hi:[0,1,1] neg_lo:[1,0,0]
    v_cvt_pk_bf16_f32 v136, v122, -v123
    v_pk_mul_f32 v[108:109], v[124:125], v[106:107] op_sel:[0,0] op_sel_hi:[1,0]
    v_pk_fma_f32 v[124:125], v[124:125], v[106:107], v[108:109] op_sel:[1,1,0] op_sel_hi:[0,1,1] neg_lo:[1,0,0]
    v_cvt_pk_bf16_f32 v137, v124, -v125
    v_pk_mul_f32 v[108:109], v[126:127], v[106:107] op_sel:[0,0] op_sel_hi:[1,0]
    v_pk_fma_f32 v[126:127], v[126:127], v[106:107], v[108:109] op_sel:[1,1,0] op_sel_hi:[0,1,1] neg_lo:[1,0,0]
    v_cvt_pk_bf16_f32 v138, v126, -v127
    v_pk_mul_f32 v[108:109], v[128:129], v[106:107] op_sel:[0,0] op_sel_hi:[1,0]
    v_pk_fma_f32 v[128:129], v[128:129], v[106:107], v[108:109] op_sel:[1,1,0] op_sel_hi:[0,1,1] neg_lo:[1,0,0]
    v_cvt_pk_bf16_f32 v139, v128, -v129
    ds_write_addtid_b32 v132 offset:28512
    ds_write_addtid_b32 v133 offset:17952
    ds_write_addtid_b32 v134 offset:19008
    ds_write_addtid_b32 v135 offset:20064
    ds_write_addtid_b32 v136 offset:16896
    ds_write_addtid_b32 v137 offset:21120
    ds_write_addtid_b32 v138 offset:24288
    ds_write_addtid_b32 v139 offset:22176
    v_pk_mul_f32 v[108:109], v[130:131], v[106:107] op_sel:[0,0] op_sel_hi:[1,0]
    v_pk_fma_f32 v[130:131], v[130:131], v[106:107], v[108:109] op_sel:[1,1,0] op_sel_hi:[0,1,1] neg_lo:[1,0,0]
    v_cvt_pk_bf16_f32 v140, v130, -v131
    v_pk_mul_f32 v[108:109], v[114:115], v[106:107] op_sel:[0,0] op_sel_hi:[1,0]
    v_pk_fma_f32 v[114:115], v[114:115], v[106:107], v[108:109] op_sel:[1,1,0] op_sel_hi:[0,1,1] neg_lo:[1,0,0]
    v_cvt_pk_bf16_f32 v141, v114, -v115
    v_pk_mul_f32 v[108:109], v[118:119], v[106:107] op_sel:[0,0] op_sel_hi:[1,0]
    v_pk_fma_f32 v[118:119], v[118:119], v[106:107], v[108:109] op_sel:[1,1,0] op_sel_hi:[0,1,1] neg_lo:[1,0,0]
    v_cvt_pk_bf16_f32 v142, v118, -v119
    v_pk_mul_f32 v[108:109], v[122:123], v[106:107] op_sel:[0,0] op_sel_hi:[1,0]
    v_pk_fma_f32 v[122:123], v[122:123], v[106:107], v[108:109] op_sel:[1,1,0] op_sel_hi:[0,1,1] neg_lo:[1,0,0]
    v_cvt_pk_bf16_f32 v143, v122, -v123
    v_pk_mul_f32 v[108:109], v[126:127], v[106:107] op_sel:[0,0] op_sel_hi:[1,0]
    v_pk_fma_f32 v[126:127], v[126:127], v[106:107], v[108:109] op_sel:[1,1,0] op_sel_hi:[0,1,1] neg_lo:[1,0,0]
    v_cvt_pk_bf16_f32 v144, v126, -v127
    v_pk_mul_f32 v[108:109], v[130:131], v[106:107] op_sel:[0,0] op_sel_hi:[1,0]
    v_pk_fma_f32 v[130:131], v[130:131], v[106:107], v[108:109] op_sel:[1,1,0] op_sel_hi:[0,1,1] neg_lo:[1,0,0]
    v_cvt_pk_bf16_f32 v145, v130, -v131
    v_pk_mul_f32 v[108:109], v[114:115], v[106:107] op_sel:[0,0] op_sel_hi:[1,0]
    v_pk_fma_f32 v[114:115], v[114:115], v[106:107], v[108:109] op_sel:[1,1,0] op_sel_hi:[0,1,1] neg_lo:[1,0,0]
    v_cvt_pk_bf16_f32 v146, v114, -v115
    v_pk_mul_f32 v[108:109], v[118:119], v[106:107] op_sel:[0,0] op_sel_hi:[1,0]
    v_pk_fma_f32 v[118:119], v[118:119], v[106:107], v[108:109] op_sel:[1,1,0] op_sel_hi:[0,1,1] neg_lo:[1,0,0]
    v_cvt_pk_bf16_f32 v147, v118, -v119
    ds_write_addtid_b32 v140 offset:25344
    ds_write_addtid_b32 v141 offset:29568
    ds_write_addtid_b32 v142 offset:33792
    ds_write_addtid_b32 v143 offset:32736
    ds_write_addtid_b32 v144 offset:31680
    ds_write_addtid_b32 v145 offset:30624
    ds_write_addtid_b32 v146 offset:34848
    ds_write_addtid_b32 v147 offset:36960
    v_pk_mul_f32 v[108:109], v[122:123], v[106:107] op_sel:[0,0] op_sel_hi:[1,0]
    v_pk_fma_f32 v[122:123], v[122:123], v[106:107], v[108:109] op_sel:[1,1,0] op_sel_hi:[0,1,1] neg_lo:[1,0,0]
    v_cvt_pk_bf16_f32 v132, v122, -v123
    v_pk_mul_f32 v[108:109], v[126:127], v[106:107] op_sel:[0,0] op_sel_hi:[1,0]
    v_pk_fma_f32 v[126:127], v[126:127], v[106:107], v[108:109] op_sel:[1,1,0] op_sel_hi:[0,1,1] neg_lo:[1,0,0]
    v_cvt_pk_bf16_f32 v133, v126, -v127
    v_pk_mul_f32 v[108:109], v[130:131], v[106:107] op_sel:[0,0] op_sel_hi:[1,0]
    v_pk_fma_f32 v[130:131], v[130:131], v[106:107], v[108:109] op_sel:[1,1,0] op_sel_hi:[0,1,1] neg_lo:[1,0,0]
    v_cvt_pk_bf16_f32 v134, v130, -v131
    v_pk_mul_f32 v[108:109], v[114:115], v[106:107] op_sel:[0,0] op_sel_hi:[1,0]
    v_pk_fma_f32 v[114:115], v[114:115], v[106:107], v[108:109] op_sel:[1,1,0] op_sel_hi:[0,1,1] neg_lo:[1,0,0]
    v_cvt_pk_bf16_f32 v135, v114, -v115
    v_pk_mul_f32 v[108:109], v[122:123], v[106:107] op_sel:[0,0] op_sel_hi:[1,0]
    v_pk_fma_f32 v[122:123], v[122:123], v[106:107], v[108:109] op_sel:[1,1,0] op_sel_hi:[0,1,1] neg_lo:[1,0,0]
    v_cvt_pk_bf16_f32 v136, v122, -v123
    v_pk_mul_f32 v[108:109], v[130:131], v[106:107] op_sel:[0,0] op_sel_hi:[1,0]
    v_pk_fma_f32 v[130:131], v[130:131], v[106:107], v[108:109] op_sel:[1,1,0] op_sel_hi:[0,1,1] neg_lo:[1,0,0]
    v_cvt_pk_bf16_f32 v137, v130, -v131
    v_pk_mul_f32 v[108:109], v[114:115], v[106:107] op_sel:[0,0] op_sel_hi:[1,0]
    v_pk_fma_f32 v[114:115], v[114:115], v[106:107], v[108:109] op_sel:[1,1,0] op_sel_hi:[0,1,1] neg_lo:[1,0,0]
    v_cvt_pk_bf16_f32 v138, v114, -v115
    v_pk_mul_f32 v[108:109], v[122:123], v[106:107] op_sel:[0,0] op_sel_hi:[1,0]
    v_pk_fma_f32 v[122:123], v[122:123], v[106:107], v[108:109] op_sel:[1,1,0] op_sel_hi:[0,1,1] neg_lo:[1,0,0]
    v_cvt_pk_bf16_f32 v139, v122, -v123
    ds_write_addtid_b32 v132 offset:27456
    ds_write_addtid_b32 v133 offset:23232
    ds_write_addtid_b32 v134 offset:26400
    ds_write_addtid_b32 v135 offset:43296
    ds_write_addtid_b32 v136 offset:45408
    ds_write_addtid_b32 v137 offset:35904
    ds_write_addtid_b32 v138 offset:47520
    ds_write_addtid_b32 v139 offset:42240
    v_pk_mul_f32 v[108:109], v[130:131], v[106:107] op_sel:[0,0] op_sel_hi:[1,0]
    v_pk_fma_f32 v[130:131], v[130:131], v[106:107], v[108:109] op_sel:[1,1,0] op_sel_hi:[0,1,1] neg_lo:[1,0,0]
    v_cvt_pk_bf16_f32 v140, v130, -v131
    v_pk_mul_f32 v[108:109], v[114:115], v[106:107] op_sel:[0,0] op_sel_hi:[1,0]
    v_pk_fma_f32 v[114:115], v[114:115], v[106:107], v[108:109] op_sel:[1,1,0] op_sel_hi:[0,1,1] neg_lo:[1,0,0]
    v_cvt_pk_bf16_f32 v141, v114, -v115
    v_pk_mul_f32 v[108:109], v[122:123], v[106:107] op_sel:[0,0] op_sel_hi:[1,0]
    v_pk_fma_f32 v[122:123], v[122:123], v[106:107], v[108:109] op_sel:[1,1,0] op_sel_hi:[0,1,1] neg_lo:[1,0,0]
    v_cvt_pk_bf16_f32 v142, v122, -v123
    v_pk_mul_f32 v[108:109], v[130:131], v[106:107] op_sel:[0,0] op_sel_hi:[1,0]
    v_pk_fma_f32 v[130:131], v[130:131], v[106:107], v[108:109] op_sel:[1,1,0] op_sel_hi:[0,1,1] neg_lo:[1,0,0]
    v_cvt_pk_bf16_f32 v143, v130, -v131
    v_pk_mul_f32 v[108:109], v[114:115], v[106:107] op_sel:[0,0] op_sel_hi:[1,0]
    v_pk_fma_f32 v[114:115], v[114:115], v[106:107], v[108:109] op_sel:[1,1,0] op_sel_hi:[0,1,1] neg_lo:[1,0,0]
    v_cvt_pk_bf16_f32 v144, v114, -v115
    v_pk_mul_f32 v[108:109], v[122:123], v[106:107] op_sel:[0,0] op_sel_hi:[1,0]
    v_pk_fma_f32 v[122:123], v[122:123], v[106:107], v[108:109] op_sel:[1,1,0] op_sel_hi:[0,1,1] neg_lo:[1,0,0]
    v_cvt_pk_bf16_f32 v145, v122, -v123
    v_pk_mul_f32 v[108:109], v[130:131], v[106:107] op_sel:[0,0] op_sel_hi:[1,0]
    v_pk_fma_f32 v[130:131], v[130:131], v[106:107], v[108:109] op_sel:[1,1,0] op_sel_hi:[0,1,1] neg_lo:[1,0,0]
    v_cvt_pk_bf16_f32 v146, v130, -v131
    ds_write_addtid_b32 v140 offset:41184
    ds_write_addtid_b32 v141 offset:46464
    ds_write_addtid_b32 v142 offset:44352
    ds_write_addtid_b32 v143 offset:40128
    ds_write_addtid_b32 v144 offset:48576
    ds_write_addtid_b32 v145 offset:39072
    ds_write_addtid_b32 v146 offset:38016
    s_lshr_b32 s77, s64, 1
    s_mul_i32 s77, s77, 4112
    s_add_u32 s77, s77, 126976
    v_mov_b32 v88, s77
    v_mov_b32 v89, 0
    ds_write_b32 v88, v89
    s_waitcnt lgkmcnt(0)
    s_barrier
    ds_read_b128 a[0:3], v28 offset:0
    ds_read_b128 a[4:7], v24 offset:0
    ds_read_b128 a[8:11], v25 offset:0
    ds_read_b128 a[12:15], v28 offset:64
    ds_read_b128 a[16:19], v24 offset:64
    ds_read_b128 a[20:23], v25 offset:64
    ds_read_b128 a[24:27], v28 offset:128
    ds_read_b128 a[28:31], v24 offset:128
    ds_read_b128 a[32:35], v25 offset:128
    ds_read_b128 a[36:39], v28 offset:192
    ds_read_b128 a[40:43], v24 offset:192
    ds_read_b128 a[44:47], v25 offset:192
    s_waitcnt vmcnt(14)
    v_mul_f32 v96, 0x3fb8aa3b, v198
    v_exp_f32 v96, v96
    v_cmp_eq_u32_e64 vcc, 48, v31
    v_cvt_pk_bf16_f32 v96, v96, v96
    v_lshlrev_b32 v96, 16, v96
    v_cndmask_b32 v199, 0, v199, vcc
    v_mul_f32 v97, v96, v192
    v_mul_f32 v98, v96, v193
    v_mul_f32 v97, 0x3fb8aa3b, v97
    v_mul_f32 v98, 0.15915494, v98
    v_exp_f32 v99, v97
    v_fract_f32 v100, v98
    v_cos_f32 v102, v100
    v_sin_f32 v103, v100
    v_mul_f32 v102, v99, v102
    v_mul_f32_e64 v103, v99, v103
    v_mul_f32 v99, 0x41800000, v97
    v_mul_f32 v100, 0x41800000, v98
    v_exp_f32 v99, v99
    v_fract_f32 v100, v100
    v_cos_f32 v104, v100
    v_sin_f32 v105, v100
    v_mul_f32 v104, v99, v104
    v_mul_f32 v105, v99, v105
    v_mul_f32 v99, 0x43800000, v97
    v_mul_f32 v100, 0x43800000, v98
    v_exp_f32 v99, v99
    v_fract_f32 v100, v100
    v_cos_f32 v106, v100
    s_waitcnt lgkmcnt(9)
    v_mfma_f32_16x16x32_bf16 v[64:67], a[4:7], a[0:3], 0
    ds_read_b128 a[48:51], v28 offset:256
    v_mfma_f32_16x16x32_bf16 v[68:71], a[8:11], a[0:3], 0
    ds_read_b128 a[52:55], v24 offset:256
    s_waitcnt lgkmcnt(8)
    v_mfma_f32_16x16x32_bf16 v[64:67], a[16:19], a[12:15], v[64:67]
    ds_read_b128 a[56:59], v25 offset:256
    v_mfma_f32_16x16x32_bf16 v[68:71], a[20:23], a[12:15], v[68:71]
    ds_read_b128 a[60:63], v28 offset:320
    s_waitcnt lgkmcnt(7)
    v_mfma_f32_16x16x32_bf16 v[64:67], a[28:31], a[24:27], v[64:67]
    ds_read_b128 a[64:67], v24 offset:320
    v_mfma_f32_16x16x32_bf16 v[68:71], a[32:35], a[24:27], v[68:71]
    ds_read_b128 a[68:71], v25 offset:320
    s_waitcnt lgkmcnt(6)
    v_mfma_f32_16x16x32_bf16 v[64:67], a[40:43], a[36:39], v[64:67]
    ds_read_b128 a[72:75], v28 offset:384
    v_mfma_f32_16x16x32_bf16 v[68:71], a[44:47], a[36:39], v[68:71]
    ds_read_b128 a[76:79], v24 offset:384
    s_waitcnt lgkmcnt(5)
    v_mfma_f32_16x16x32_bf16 v[64:67], a[52:55], a[48:51], v[64:67]
    ds_read_b128 a[80:83], v25 offset:384
    v_mfma_f32_16x16x32_bf16 v[68:71], a[56:59], a[48:51], v[68:71]
    ds_read_b128 a[84:87], v28 offset:448
    s_waitcnt lgkmcnt(4)
    v_mfma_f32_16x16x32_bf16 v[64:67], a[64:67], a[60:63], v[64:67]
    ds_read_b128 a[88:91], v24 offset:448
    v_mfma_f32_16x16x32_bf16 v[68:71], a[68:71], a[60:63], v[68:71]
    ds_read_b128 a[92:95], v25 offset:448
    s_waitcnt lgkmcnt(3)
    v_mfma_f32_16x16x32_bf16 v[64:67], a[76:79], a[72:75], v[64:67]
    v_mfma_f32_16x16x32_bf16 v[68:71], a[80:83], a[72:75], v[68:71]
    s_waitcnt lgkmcnt(0)
    v_mfma_f32_16x16x32_bf16 v[64:67], a[88:91], a[84:87], v[64:67]
    v_mfma_f32_16x16x32_bf16 v[68:71], a[92:95], a[84:87], v[68:71]
    s_bitcmp1_b32 s64, 0
    s_cbranch_scc1 L_kh_15
    s_nop 5
    v_add_f32_e64 v67, v67, v55
    v_cvt_pk_bf16_f32 v72, v64, v65
    v_cvt_pk_bf16_f32 v73, v66, v67
    v_cvt_pk_bf16_f32 v74, v68, v69
    v_cvt_pk_bf16_f32 v75, v70, v71
    ds_write_b64 v29, v[72:73] offset:512
    ds_write_b64 v29, v[74:75] offset:0
    s_branch L_kj_16
L_kh_15:
    s_nop 5
    v_cvt_pk_bf16_f32 v72, v66, v66
    v_cvt_pk_bf16_f32 v73, v65, v65
    v_cvt_pk_bf16_f32 v74, v65, v64
    v_cvt_pk_bf16_f32 v75, v64, v64
    v_cvt_pk_bf16_f32 v76, v70, v70
    v_cvt_pk_bf16_f32 v77, v70, v70
    v_cvt_pk_bf16_f32 v78, v69, v69
    v_cvt_pk_bf16_f32 v79, v69, v69
    v_cvt_pk_bf16_f32 v80, v69, v69
    v_cvt_pk_bf16_f32 v81, v69, v68
    v_cvt_pk_bf16_f32 v82, v68, v68
    v_cvt_pk_bf16_f32 v83, v68, v68
    ds_write_b128 v29, v[72:75]
    ds_write_b128 v26, v[76:79]
    ds_write_b128 v26, v[80:83] offset:16
L_kj_16:
    v_sin_f32 v107, v100
    v_mul_f32 v106, v99, v106
    v_mul_f32_e64 v107, v99, v107
    v_pk_mul_f32 v[108:109], v[194:195], v[196:197] op_sel:[0,0] op_sel_hi:[1,0]
    v_pk_fma_f32 v[114:115], v[194:195], v[196:197], v[108:109] op_sel:[1,1,0] op_sel_hi:[0,1,1] neg_lo:[1,0,0]
    v_pk_mul_f32 v[114:115], v[114:115], v[96:97] op_sel_hi:[1,0]
    v_cvt_pk_bf16_f32 v132, v114, -v115
    v_mov_b32 v133, 0x3f80
    v_cvt_pk_bf16_f32 v134, v104, v105
    v_pk_mul_f32 v[108:109], v[114:115], v[102:103] op_sel:[0,0] op_sel_hi:[1,0]
    v_pk_fma_f32 v[112:113], v[114:115], v[102:103], v[108:109] op_sel:[1,1,0] op_sel_hi:[0,1,1] neg_lo:[1,0,0]
    v_cvt_pk_bf16_f32 v135, v112, -v113
    v_pk_mul_f32 v[108:109], v[112:113], v[102:103] op_sel:[0,0] op_sel_hi:[1,0]
    v_pk_fma_f32 v[116:117], v[112:113], v[102:103], v[108:109] op_sel:[1,1,0] op_sel_hi:[0,1,1] neg_lo:[1,0,0]
    v_cvt_pk_bf16_f32 v136, v116, -v117
    v_pk_mul_f32 v[108:109], v[104:105], v[104:105] op_sel:[0,0] op_sel_hi:[1,0]
    v_pk_fma_f32 v[110:111], v[104:105], v[104:105], v[108:109] op_sel:[1,1,0] op_sel_hi:[0,1,1] neg_lo:[1,0,0]
    v_cvt_pk_bf16_f32 v137, v110, v111
    v_pk_mul_f32 v[108:109], v[116:117], v[102:103] op_sel:[0,0] op_sel_hi:[1,0]
    v_pk_fma_f32 v[112:113], v[116:117], v[102:103], v[108:109] op_sel:[1,1,0] op_sel_hi:[0,1,1] neg_lo:[1,0,0]
    v_cvt_pk_bf16_f32 v138, v112, -v113
    v_pk_mul_f32 v[108:109], v[110:111], v[104:105] op_sel:[0,0] op_sel_hi:[1,0]
    v_pk_fma_f32 v[110:111], v[110:111], v[104:105], v[108:109] op_sel:[1,1,0] op_sel_hi:[0,1,1] neg_lo:[1,0,0]
    v_cvt_pk_bf16_f32 v139, v110, v111
    v_pk_mul_f32 v[108:109], v[112:113], v[102:103] op_sel:[0,0] op_sel_hi:[1,0]
    v_pk_fma_f32 v[118:119], v[112:113], v[102:103], v[108:109] op_sel:[1,1,0] op_sel_hi:[0,1,1] neg_lo:[1,0,0]
    v_cvt_pk_bf16_f32 v140, v118, -v119
    v_pk_mul_f32 v[108:109], v[110:111], v[104:105] op_sel:[0,0] op_sel_hi:[1,0]
    v_pk_fma_f32 v[110:111], v[110:111], v[104:105], v[108:109] op_sel:[1,1,0] op_sel_hi:[0,1,1] neg_lo:[1,0,0]
    v_cvt_pk_bf16_f32 v141, v110, v111
    s_waitcnt lgkmcnt(0) vmcnt(0)
    s_barrier
    s_cmp_lg_u32 s64, 0
    s_cbranch_scc1 L_fs_17
    s_mov_b64 exec, 1
    buffer_store_dwordx2 v[22:23], v2, s[40:43], s28 offen sc1
    s_mov_b64 exec, -1
L_fs_17:
    v_add_u32_e64 v88, 4, v30
    ds_read2st64_b32 v[208:209], v30 offset0:0 offset1:1
    ds_read2st64_b32 v[210:211], v30 offset0:2 offset1:3
    ds_read2st64_b32 v[212:213], v30 offset0:4 offset1:5
    ds_read2st64_b32 v[214:215], v30 offset0:6 offset1:7
    ds_read2st64_b32 v[216:217], v88 offset0:0 offset1:1
    ds_read2st64_b32 v[218:219], v88 offset0:2 offset1:3
    ds_read2st64_b32 v[220:221], v88 offset0:4 offset1:5
    ds_read2st64_b32 v[222:223], v88 offset0:6 offset1:7
    v_pk_mul_f32 v[108:109], v[118:119], v[102:103] op_sel:[0,0] op_sel_hi:[1,0]
    v_pk_fma_f32 v[112:113], v[118:119], v[102:103], v[108:109] op_sel:[1,1,0] op_sel_hi:[0,1,1] neg_lo:[1,0,0]
    v_cvt_pk_bf16_f32 v142, v112, -v113
    v_pk_mul_f32 v[108:109], v[110:111], v[104:105] op_sel:[0,0] op_sel_hi:[1,0]
    v_pk_fma_f32 v[110:111], v[110:111], v[104:105], v[108:109] op_sel:[1,1,0] op_sel_hi:[0,1,1] neg_lo:[1,0,0]
    v_cvt_pk_bf16_f32 v143, v110, v111
    v_pk_mul_f32 v[108:109], v[112:113], v[102:103] op_sel:[0,0] op_sel_hi:[1,0]
    v_pk_fma_f32 v[120:121], v[112:113], v[102:103], v[108:109] op_sel:[1,1,0] op_sel_hi:[0,1,1] neg_lo:[1,0,0]
    v_cvt_pk_bf16_f32 v144, v120, -v121
    v_pk_mul_f32 v[108:109], v[110:111], v[104:105] op_sel:[0,0] op_sel_hi:[1,0]
    v_pk_fma_f32 v[110:111], v[110:111], v[104:105], v[108:109] op_sel:[1,1,0] op_sel_hi:[0,1,1] neg_lo:[1,0,0]
    v_cvt_pk_bf16_f32 v145, v110, v111
    v_pk_mul_f32 v[108:109], v[120:121], v[102:103] op_sel:[0,0] op_sel_hi:[1,0]
    v_pk_fma_f32 v[112:113], v[120:121], v[102:103], v[108:109] op_sel:[1,1,0] op_sel_hi:[0,1,1] neg_lo:[1,0,0]
    v_cvt_pk_bf16_f32 v146, v112, -v113
    v_pk_mul_f32 v[108:109], v[110:111], v[104:105] op_sel:[0,0] op_sel_hi:[1,0]
    v_pk_fma_f32 v[110:111], v[110:111], v[104:105], v[108:109] op_sel:[1,1,0] op_sel_hi:[0,1,1] neg_lo:[1,0,0]
    v_cvt_pk_bf16_f32 v147, v110, v111
    s_waitcnt lgkmcnt(0)
    v_alignbit_b32 v216, v216, v208, 16
    v_alignbit_b32 v217, v217, v209, 16
    v_alignbit_b32 v218, v218, v210, 16
    v_alignbit_b32 v219, v219, v211, 16
    v_alignbit_b32 v220, v220, v212, 16
    v_alignbit_b32 v221, v221, v213, 16
    v_alignbit_b32 v222, v222, v214, 16
    v_alignbit_b32 v223, v223, v215, 16
    s_mov_b32 m0, s73
    s_nop 0
    ds_write_addtid_b32 v132 offset:0
    ds_write_addtid_b32 v133 offset:49632
    ds_write_addtid_b32 v134 offset:50688
    ds_write_addtid_b32 v135 offset:1056
    ds_write_addtid_b32 v136 offset:2112
    ds_write_addtid_b32 v137 offset:51744
    ds_write_addtid_b32 v138 offset:3168
    ds_write_addtid_b32 v139 offset:52800
    ds_write_addtid_b32 v140 offset:4224
    ds_write_addtid_b32 v141 offset:53856
    ds_write_addtid_b32 v142 offset:5280
    ds_write_addtid_b32 v143 offset:54912
    ds_write_addtid_b32 v144 offset:6336
    ds_write_addtid_b32 v145 offset:55968
    ds_write_addtid_b32 v146 offset:7392
    ds_write_addtid_b32 v147 offset:57024
    v_pk_mul_f32 v[108:109], v[112:113], v[102:103] op_sel:[0,0] op_sel_hi:[1,0]
    v_pk_fma_f32 v[122:123], v[112:113], v[102:103], v[108:109] op_sel:[1,1,0] op_sel_hi:[0,1,1] neg_lo:[1,0,0]
    v_cvt_pk_bf16_f32 v132, v122, -v123
    v_pk_mul_f32 v[108:109], v[110:111], v[104:105] op_sel:[0,0] op_sel_hi:[1,0]
    v_pk_fma_f32 v[110:111], v[110:111], v[104:105], v[108:109] op_sel:[1,1,0] op_sel_hi:[0,1,1] neg_lo:[1,0,0]
    v_cvt_pk_bf16_f32 v133, v110, v111
    v_pk_mul_f32 v[108:109], v[122:123], v[102:103] op_sel:[0,0] op_sel_hi:[1,0]
    v_pk_fma_f32 v[112:113], v[122:123], v[102:103], v[108:109] op_sel:[1,1,0] op_sel_hi:[0,1,1] neg_lo:[1,0,0]
    v_cvt_pk_bf16_f32 v134, v112, -v113
    v_pk_mul_f32 v[108:109], v[110:111], v[104:105] op_sel:[0,0] op_sel_hi:[1,0]
    v_pk_fma_f32 v[110:111], v[110:111], v[104:105], v[108:109] op_sel:[1,1,0] op_sel_hi:[0,1,1] neg_lo:[1,0,0]
    v_cvt_pk_bf16_f32 v135, v110, v111
    v_pk_mul_f32 v[108:109], v[112:113], v[102:103] op_sel:[0,0] op_sel_hi:[1,0]
    v_pk_fma_f32 v[124:125], v[112:113], v[102:103], v[108:109] op_sel:[1,1,0] op_sel_hi:[0,1,1] neg_lo:[1,0,0]
    v_cvt_pk_bf16_f32 v136, v124, -v125
    v_pk_mul_f32 v[108:109], v[110:111], v[104:105] op_sel:[0,0] op_sel_hi:[1,0]
    v_pk_fma_f32 v[110:111], v[110:111], v[104:105], v[108:109] op_sel:[1,1,0] op_sel_hi:[0,1,1] neg_lo:[1,0,0]
    v_cvt_pk_bf16_f32 v137, v110, v111
    v_pk_mul_f32 v[108:109], v[124:125], v[102:103] op_sel:[0,0] op_sel_hi:[1,0]
    v_pk_fma_f32 v[112:113], v[124:125], v[102:103], v[108:109] op_sel:[1,1,0] op_sel_hi:[0,1,1] neg_lo:[1,0,0]
    v_cvt_pk_bf16_f32 v138, v112, -v113
    v_pk_mul_f32 v[108:109], v[110:111], v[104:105] op_sel:[0,0] op_sel_hi:[1,0]
    v_pk_fma_f32 v[110:111], v[110:111], v[104:105], v[108:109] op_sel:[1,1,0] op_sel_hi:[0,1,1] neg_lo:[1,0,0]
    v_cvt_pk_bf16_f32 v139, v110, v111
    ds_write_addtid_b32 v132 offset:8448
    ds_write_addtid_b32 v133 offset:58080
    ds_write_addtid_b32 v134 offset:9504
    ds_write_addtid_b32 v135 offset:59136
    ds_write_addtid_b32 v136 offset:10560
    ds_write_addtid_b32 v137 offset:60192
    ds_write_addtid_b32 v138 offset:11616
    ds_write_addtid_b32 v139 offset:61248
    v_pk_mul_f32 v[108:109], v[112:113], v[102:103] op_sel:[0,0] op_sel_hi:[1,0]
    v_pk_fma_f32 v[126:127], v[112:113], v[102:103], v[108:109] op_sel:[1,1,0] op_sel_hi:[0,1,1] neg_lo:[1,0,0]
    v_cvt_pk_bf16_f32 v140, v126, -v127
    v_pk_mul_f32 v[108:109], v[110:111], v[104:105] op_sel:[0,0] op_sel_hi:[1,0]
    v_pk_fma_f32 v[110:111], v[110:111], v[104:105], v[108:109] op_sel:[1,1,0] op_sel_hi:[0,1,1] neg_lo:[1,0,0]
    v_cvt_pk_bf16_f32 v141, v110, v111
    v_pk_mul_f32 v[108:109], v[126:127], v[102:103] op_sel:[0,0] op_sel_hi:[1,0]
    v_pk_fma_f32 v[112:113], v[126:127], v[102:103], v[108:109] op_sel:[1,1,0] op_sel_hi:[0,1,1] neg_lo:[1,0,0]
    v_cvt_pk_bf16_f32 v142, v112, -v113
    v_pk_mul_f32 v[108:109], v[110:111], v[104:105] op_sel:[0,0] op_sel_hi:[1,0]
    v_pk_fma_f32 v[110:111], v[110:111], v[104:105], v[108:109] op_sel:[1,1,0] op_sel_hi:[0,1,1] neg_lo:[1,0,0]
    v_cvt_pk_bf16_f32 v143, v110, v111
    v_pk_mul_f32 v[108:109], v[112:113], v[102:103] op_sel:[0,0] op_sel_hi:[1,0]
    v_pk_fma_f32 v[128:129], v[112:113], v[102:103], v[108:109] op_sel:[1,1,0] op_sel_hi:[0,1,1] neg_lo:[1,0,0]
    v_cvt_pk_bf16_f32 v144, v128, -v129
    v_pk_mul_f32 v[108:109], v[110:111], v[104:105] op_sel:[0,0] op_sel_hi:[1,0]
    v_pk_fma_f32 v[110:111], v[110:111], v[104:105], v[108:109] op_sel:[1,1,0] op_sel_hi:[0,1,1] neg_lo:[1,0,0]
    v_cvt_pk_bf16_f32 v145, v110, v111
    v_pk_mul_f32 v[108:109], v[128:129], v[102:103] op_sel:[0,0] op_sel_hi:[1,0]
    v_pk_fma_f32 v[112:113], v[128:129], v[102:103], v[108:109] op_sel:[1,1,0] op_sel_hi:[0,1,1] neg_lo:[1,0,0]
    v_cvt_pk_bf16_f32 v146, v112, -v113
    v_pk_mul_f32 v[108:109], v[110:111], v[104:105] op_sel:[0,0] op_sel_hi:[1,0]
    v_pk_fma_f32 v[110:111], v[110:111], v[104:105], v[108:109] op_sel:[1,1,0] op_sel_hi:[0,1,1] neg_lo:[1,0,0]
    v_cvt_pk_bf16_f32 v147, v110, v111
    ds_write_addtid_b32 v140 offset:12672
    ds_write_addtid_b32 v141 offset:62304
    ds_write_addtid_b32 v142 offset:13728
    ds_write_addtid_b32 v143 offset:63360
    ds_write_addtid_b32 v144 offset:14784
    ds_write_addtid_b32 v145 offset:64416
    ds_write_addtid_b32 v146 offset:15840
    ds_write_addtid_b32 v147 offset:65472
    v_pk_mul_f32 v[108:109], v[112:113], v[102:103] op_sel:[0,0] op_sel_hi:[1,0]
    v_pk_fma_f32 v[130:131], v[112:113], v[102:103], v[108:109] op_sel:[1,1,0] op_sel_hi:[0,1,1] neg_lo:[1,0,0]
    v_pk_mul_f32 v[108:109], v[114:115], v[106:107] op_sel:[0,0] op_sel_hi:[1,0]
    v_pk_fma_f32 v[114:115], v[114:115], v[106:107], v[108:109] op_sel:[1,1,0] op_sel_hi:[0,1,1] neg_lo:[1,0,0]
    v_cvt_pk_bf16_f32 v132, v114, -v115
    v_pk_mul_f32 v[108:109], v[116:117], v[106:107] op_sel:[0,0] op_sel_hi:[1,0]
    v_pk_fma_f32 v[116:117], v[116:117], v[106:107], v[108:109] op_sel:[1,1,0] op_sel_hi:[0,1,1] neg_lo:[1,0,0]
    v_cvt_pk_bf16_f32 v133, v116, -v117
    v_pk_mul_f32 v[108:109], v[118:119], v[106:107] op_sel:[0,0] op_sel_hi:[1,0]
    v_pk_fma_f32 v[118:119], v[118:119], v[106:107], v[108:109] op_sel:[1,1,0] op_sel_hi:[0,1,1] neg_lo:[1,0,0]
    v_cvt_pk_bf16_f32 v134, v118, -v119
    v_pk_mul_f32 v[108:109], v[120:121], v[106:107] op_sel:[0,0] op_sel_hi:[1,0]
    v_pk_fma_f32 v[120:121], v[120:121], v[106:107], v[108:109] op_sel:[1,1,0] op_sel_hi:[0,1,1] neg_lo:[1,0,0]
    v_cvt_pk_bf16_f32 v135, v120, -v121
    v_pk_mul_f32 v[108:109], v[122:123], v[106:107] op_sel:[0,0] op_sel_hi:[1,0]
    v_pk_fma_f32 v[122:123], v[122:123], v[106:107], v[108:109] op_sel:[1,1,0] op_sel_hi:[0,1,1] neg_lo:[1,0,0]
    v_cvt_pk_bf16_f32 v136, v122, -v123
    v_pk_mul_f32 v[108:109], v[124:125], v[106:107] op_sel:[0,0] op_sel_hi:[1,0]
    v_pk_fma_f32 v[124:125], v[124:125], v[106:107], v[108:109] op_sel:[1,1,0] op_sel_hi:[0,1,1] neg_lo:[1,0,0]
    v_cvt_pk_bf16_f32 v137, v124, -v125
    v_pk_mul_f32 v[108:109], v[126:127], v[106:107] op_sel:[0,0] op_sel_hi:[1,0]
    v_pk_fma_f32 v[126:127], v[126:127], v[106:107], v[108:109] op_sel:[1,1,0] op_sel_hi:[0,1,1] neg_lo:[1,0,0]
    v_cvt_pk_bf16_f32 v138, v126, -v127
    v_pk_mul_f32 v[108:109], v[128:129], v[106:107] op_sel:[0,0] op_sel_hi:[1,0]
    v_pk_fma_f32 v[128:129], v[128:129], v[106:107], v[108:109] op_sel:[1,1,0] op_sel_hi:[0,1,1] neg_lo:[1,0,0]
    v_cvt_pk_bf16_f32 v139, v128, -v129
    ds_write_addtid_b32 v132 offset:28512
    ds_write_addtid_b32 v133 offset:17952
    ds_write_addtid_b32 v134 offset:19008
    ds_write_addtid_b32 v135 offset:20064
    ds_write_addtid_b32 v136 offset:16896
    ds_write_addtid_b32 v137 offset:21120
    ds_write_addtid_b32 v138 offset:24288
    ds_write_addtid_b32 v139 offset:22176
    v_pk_mul_f32 v[108:109], v[130:131], v[106:107] op_sel:[0,0] op_sel_hi:[1,0]
    v_pk_fma_f32 v[130:131], v[130:131], v[106:107], v[108:109] op_sel:[1,1,0] op_sel_hi:[0,1,1] neg_lo:[1,0,0]
    v_cvt_pk_bf16_f32 v140, v130, -v131
    v_pk_mul_f32 v[108:109], v[114:115], v[106:107] op_sel:[0,0] op_sel_hi:[1,0]
    v_pk_fma_f32 v[114:115], v[114:115], v[106:107], v[108:109] op_sel:[1,1,0] op_sel_hi:[0,1,1] neg_lo:[1,0,0]
    v_cvt_pk_bf16_f32 v141, v114, -v115
    v_pk_mul_f32 v[108:109], v[118:119], v[106:107] op_sel:[0,0] op_sel_hi:[1,0]
    v_pk_fma_f32 v[118:119], v[118:119], v[106:107], v[108:109] op_sel:[1,1,0] op_sel_hi:[0,1,1] neg_lo:[1,0,0]
    v_cvt_pk_bf16_f32 v142, v118, -v119
    v_pk_mul_f32 v[108:109], v[122:123], v[106:107] op_sel:[0,0] op_sel_hi:[1,0]
    v_pk_fma_f32 v[122:123], v[122:123], v[106:107], v[108:109] op_sel:[1,1,0] op_sel_hi:[0,1,1] neg_lo:[1,0,0]
    v_cvt_pk_bf16_f32 v143, v122, -v123
    v_pk_mul_f32 v[108:109], v[126:127], v[106:107] op_sel:[0,0] op_sel_hi:[1,0]
    v_pk_fma_f32 v[126:127], v[126:127], v[106:107], v[108:109] op_sel:[1,1,0] op_sel_hi:[0,1,1] neg_lo:[1,0,0]
    v_cvt_pk_bf16_f32 v144, v126, -v127
    v_pk_mul_f32 v[108:109], v[130:131], v[106:107] op_sel:[0,0] op_sel_hi:[1,0]
    v_pk_fma_f32 v[130:131], v[130:131], v[106:107], v[108:109] op_sel:[1,1,0] op_sel_hi:[0,1,1] neg_lo:[1,0,0]
    v_cvt_pk_bf16_f32 v145, v130, -v131
    v_pk_mul_f32 v[108:109], v[114:115], v[106:107] op_sel:[0,0] op_sel_hi:[1,0]
    v_pk_fma_f32 v[114:115], v[114:115], v[106:107], v[108:109] op_sel:[1,1,0] op_sel_hi:[0,1,1] neg_lo:[1,0,0]
    v_cvt_pk_bf16_f32 v146, v114, -v115
    v_pk_mul_f32 v[108:109], v[118:119], v[106:107] op_sel:[0,0] op_sel_hi:[1,0]
    v_pk_fma_f32 v[118:119], v[118:119], v[106:107], v[108:109] op_sel:[1,1,0] op_sel_hi:[0,1,1] neg_lo:[1,0,0]
    v_cvt_pk_bf16_f32 v147, v118, -v119
    ds_write_addtid_b32 v140 offset:25344
    ds_write_addtid_b32 v141 offset:29568
    ds_write_addtid_b32 v142 offset:33792
    ds_write_addtid_b32 v143 offset:32736
    ds_write_addtid_b32 v144 offset:31680
    ds_write_addtid_b32 v145 offset:30624
    ds_write_addtid_b32 v146 offset:34848
    ds_write_addtid_b32 v147 offset:36960
    v_pk_mul_f32 v[108:109], v[122:123], v[106:107] op_sel:[0,0] op_sel_hi:[1,0]
    v_pk_fma_f32 v[122:123], v[122:123], v[106:107], v[108:109] op_sel:[1,1,0] op_sel_hi:[0,1,1] neg_lo:[1,0,0]
    v_cvt_pk_bf16_f32 v132, v122, -v123
    v_pk_mul_f32 v[108:109], v[126:127], v[106:107] op_sel:[0,0] op_sel_hi:[1,0]
    v_pk_fma_f32 v[126:127], v[126:127], v[106:107], v[108:109] op_sel:[1,1,0] op_sel_hi:[0,1,1] neg_lo:[1,0,0]
    v_cvt_pk_bf16_f32 v133, v126, -v127
    v_pk_mul_f32 v[108:109], v[130:131], v[106:107] op_sel:[0,0] op_sel_hi:[1,0]
    v_pk_fma_f32 v[130:131], v[130:131], v[106:107], v[108:109] op_sel:[1,1,0] op_sel_hi:[0,1,1] neg_lo:[1,0,0]
    v_cvt_pk_bf16_f32 v134, v130, -v131
    v_pk_mul_f32 v[108:109], v[114:115], v[106:107] op_sel:[0,0] op_sel_hi:[1,0]
    v_pk_fma_f32 v[114:115], v[114:115], v[106:107], v[108:109] op_sel:[1,1,0] op_sel_hi:[0,1,1] neg_lo:[1,0,0]
    v_cvt_pk_bf16_f32 v135, v114, -v115
    v_pk_mul_f32 v[108:109], v[122:123], v[106:107] op_sel:[0,0] op_sel_hi:[1,0]
    v_pk_fma_f32 v[122:123], v[122:123], v[106:107], v[108:109] op_sel:[1,1,0] op_sel_hi:[0,1,1] neg_lo:[1,0,0]
    v_cvt_pk_bf16_f32 v136, v122, -v123
    v_pk_mul_f32 v[108:109], v[130:131], v[106:107] op_sel:[0,0] op_sel_hi:[1,0]
    v_pk_fma_f32 v[130:131], v[130:131], v[106:107], v[108:109] op_sel:[1,1,0] op_sel_hi:[0,1,1] neg_lo:[1,0,0]
    v_cvt_pk_bf16_f32 v137, v130, -v131
    v_pk_mul_f32 v[108:109], v[114:115], v[106:107] op_sel:[0,0] op_sel_hi:[1,0]
    v_pk_fma_f32 v[114:115], v[114:115], v[106:107], v[108:109] op_sel:[1,1,0] op_sel_hi:[0,1,1] neg_lo:[1,0,0]
    v_cvt_pk_bf16_f32 v138, v114, -v115
    v_pk_mul_f32 v[108:109], v[122:123], v[106:107] op_sel:[0,0] op_sel_hi:[1,0]
    v_pk_fma_f32 v[122:123], v[122:123], v[106:107], v[108:109] op_sel:[1,1,0] op_sel_hi:[0,1,1] neg_lo:[1,0,0]
    v_cvt_pk_bf16_f32 v139, v122, -v123
    ds_write_addtid_b32 v132 offset:27456
    ds_write_addtid_b32 v133 offset:23232
    ds_write_addtid_b32 v134 offset:26400
    ds_write_addtid_b32 v135 offset:43296
    ds_write_addtid_b32 v136 offset:45408
    ds_write_addtid_b32 v137 offset:35904
    ds_write_addtid_b32 v138 offset:47520
    ds_write_addtid_b32 v139 offset:42240
    v_pk_mul_f32 v[108:109], v[130:131], v[106:107] op_sel:[0,0] op_sel_hi:[1,0]
    v_pk_fma_f32 v[130:131], v[130:131], v[106:107], v[108:109] op_sel:[1,1,0] op_sel_hi:[0,1,1] neg_lo:[1,0,0]
    v_cvt_pk_bf16_f32 v140, v130, -v131
    v_pk_mul_f32 v[108:109], v[114:115], v[106:107] op_sel:[0,0] op_sel_hi:[1,0]
    v_pk_fma_f32 v[114:115], v[114:115], v[106:107], v[108:109] op_sel:[1,1,0] op_sel_hi:[0,1,1] neg_lo:[1,0,0]
    v_cvt_pk_bf16_f32 v141, v114, -v115
    v_pk_mul_f32 v[108:109], v[122:123], v[106:107] op_sel:[0,0] op_sel_hi:[1,0]
    v_pk_fma_f32 v[122:123], v[122:123], v[106:107], v[108:109] op_sel:[1,1,0] op_sel_hi:[0,1,1] neg_lo:[1,0,0]
    v_cvt_pk_bf16_f32 v142, v122, -v123
    v_pk_mul_f32 v[108:109], v[130:131], v[106:107] op_sel:[0,0] op_sel_hi:[1,0]
    v_pk_fma_f32 v[130:131], v[130:131], v[106:107], v[108:109] op_sel:[1,1,0] op_sel_hi:[0,1,1] neg_lo:[1,0,0]
    v_cvt_pk_bf16_f32 v143, v130, -v131
    v_pk_mul_f32 v[108:109], v[114:115], v[106:107] op_sel:[0,0] op_sel_hi:[1,0]
    v_pk_fma_f32 v[114:115], v[114:115], v[106:107], v[108:109] op_sel:[1,1,0] op_sel_hi:[0,1,1] neg_lo:[1,0,0]
    v_cvt_pk_bf16_f32 v144, v114, -v115
    v_pk_mul_f32 v[108:109], v[122:123], v[106:107] op_sel:[0,0] op_sel_hi:[1,0]
    v_pk_fma_f32 v[122:123], v[122:123], v[106:107], v[108:109] op_sel:[1,1,0] op_sel_hi:[0,1,1] neg_lo:[1,0,0]
    v_cvt_pk_bf16_f32 v145, v122, -v123
    v_pk_mul_f32 v[108:109], v[130:131], v[106:107] op_sel:[0,0] op_sel_hi:[1,0]
    v_pk_fma_f32 v[130:131], v[130:131], v[106:107], v[108:109] op_sel:[1,1,0] op_sel_hi:[0,1,1] neg_lo:[1,0,0]
    v_cvt_pk_bf16_f32 v146, v130, -v131
    ds_write_addtid_b32 v140 offset:41184
    ds_write_addtid_b32 v141 offset:46464
    ds_write_addtid_b32 v142 offset:44352
    ds_write_addtid_b32 v143 offset:40128
    ds_write_addtid_b32 v144 offset:48576
    ds_write_addtid_b32 v145 offset:39072
    ds_write_addtid_b32 v146 offset:38016
    s_waitcnt lgkmcnt(0)
    s_barrier
    ds_read_b128 a[0:3], v28 offset:0
    ds_read_b128 a[4:7], v24 offset:0
    ds_read_b128 a[8:11], v25 offset:0
    ds_read_b128 a[12:15], v28 offset:64
    ds_read_b128 a[16:19], v24 offset:64
    ds_read_b128 a[20:23], v25 offset:64
    ds_read_b128 a[24:27], v28 offset:128
    ds_read_b128 a[28:31], v24 offset:128
    ds_read_b128 a[32:35], v25 offset:128
    ds_read_b128 a[36:39], v28 offset:192
    ds_read_b128 a[40:43], v24 offset:192
    ds_read_b128 a[44:47], v25 offset:192
    v_mul_f32 v96, 0x3fb8aa3b, v206
    v_exp_f32 v96, v96
    v_cmp_eq_u32_e64 vcc, 48, v31
    v_cvt_pk_bf16_f32 v96, v96, v96
    v_lshlrev_b32 v96, 16, v96
    v_cndmask_b32 v207, 0, v207, vcc
    v_mul_f32 v97, v96, v200
    v_mul_f32 v98, v96, v201
    v_mul_f32 v97, 0x3fb8aa3b, v97
    v_mul_f32 v98, 0.15915494, v98
    v_exp_f32 v99, v97
    v_fract_f32 v100, v98
    v_cos_f32 v102, v100
    v_sin_f32 v103, v100
    v_mul_f32 v102, v99, v102
    v_mul_f32_e64 v103, v99, v103
    v_mul_f32 v99, 0x41800000, v97
    v_mul_f32 v100, 0x41800000, v98
    v_exp_f32 v99, v99
    v_fract_f32 v100, v100
    v_cos_f32 v104, v100
    v_sin_f32 v105, v100
    v_mul_f32 v104, v99, v104
    v_mul_f32 v105, v99, v105
    v_mul_f32 v99, 0x43800000, v97
    v_mul_f32 v100, 0x43800000, v98
    v_exp_f32 v99, v99
    v_fract_f32 v100, v100
    v_cos_f32 v106, v100
    s_waitcnt lgkmcnt(9)
    v_mfma_f32_16x16x32_bf16 v[64:67], a[4:7], a[0:3], 0
    ds_read_b128 a[48:51], v28 offset:256
    v_mfma_f32_16x16x32_bf16 v[68:71], a[8:11], a[0:3], 0
    ds_read_b128 a[52:55], v24 offset:256
    s_waitcnt lgkmcnt(8)
    v_mfma_f32_16x16x32_bf16 v[64:67], a[16:19], a[12:15], v[64:67]
    ds_read_b128 a[56:59], v25 offset:256
    v_mfma_f32_16x16x32_bf16 v[68:71], a[20:23], a[12:15], v[68:71]
    ds_read_b128 a[60:63], v28 offset:320
    s_waitcnt lgkmcnt(7)
    v_mfma_f32_16x16x32_bf16 v[64:67], a[28:31], a[24:27], v[64:67]
    ds_read_b128 a[64:67], v24 offset:320
    v_mfma_f32_16x16x32_bf16 v[68:71], a[32:35], a[24:27], v[68:71]
    ds_read_b128 a[68:71], v25 offset:320
    s_waitcnt lgkmcnt(6)
    v_mfma_f32_16x16x32_bf16 v[64:67], a[40:43], a[36:39], v[64:67]
    ds_read_b128 a[72:75], v28 offset:384
    v_mfma_f32_16x16x32_bf16 v[68:71], a[44:47], a[36:39], v[68:71]
    ds_read_b128 a[76:79], v24 offset:384
    s_waitcnt lgkmcnt(5)
    v_mfma_f32_16x16x32_bf16 v[64:67], a[52:55], a[48:51], v[64:67]
    ds_read_b128 a[80:83], v25 offset:384
    v_mfma_f32_16x16x32_bf16 v[68:71], a[56:59], a[48:51], v[68:71]
    ds_read_b128 a[84:87], v28 offset:448
    s_waitcnt lgkmcnt(4)
    v_mfma_f32_16x16x32_bf16 v[64:67], a[64:67], a[60:63], v[64:67]
    ds_read_b128 a[88:91], v24 offset:448
    v_mfma_f32_16x16x32_bf16 v[68:71], a[68:71], a[60:63], v[68:71]
    ds_read_b128 a[92:95], v25 offset:448
    s_waitcnt lgkmcnt(3)
    v_mfma_f32_16x16x32_bf16 v[64:67], a[76:79], a[72:75], v[64:67]
    v_mfma_f32_16x16x32_bf16 v[68:71], a[80:83], a[72:75], v[68:71]
    s_waitcnt lgkmcnt(0)
    v_mfma_f32_16x16x32_bf16 v[64:67], a[88:91], a[84:87], v[64:67]
    v_mfma_f32_16x16x32_bf16 v[68:71], a[92:95], a[84:87], v[68:71]
    s_bitcmp1_b32 s64, 0
    s_cbranch_scc1 L_kh_19
    s_nop 5
    v_add_f32_e64 v67, v67, v199
    v_cvt_pk_bf16_f32 v72, v64, v65
    v_cvt_pk_bf16_f32 v73, v66, v67
    v_cvt_pk_bf16_f32 v74, v68, v69
    v_cvt_pk_bf16_f32 v75, v70, v71
    ds_write_b64 v29, v[72:73] offset:512
    ds_write_b64 v29, v[74:75] offset:0
    s_branch L_kj_20
L_kh_19:
    s_nop 5
    v_cvt_pk_bf16_f32 v72, v66, v66
    v_cvt_pk_bf16_f32 v73, v65, v65
    v_cvt_pk_bf16_f32 v74, v65, v64
    v_cvt_pk_bf16_f32 v75, v64, v64
    v_cvt_pk_bf16_f32 v76, v70, v70
    v_cvt_pk_bf16_f32 v77, v70, v70
    v_cvt_pk_bf16_f32 v78, v69, v69
    v_cvt_pk_bf16_f32 v79, v69, v69
    v_cvt_pk_bf16_f32 v80, v69, v69
    v_cvt_pk_bf16_f32 v81, v69, v68
    v_cvt_pk_bf16_f32 v82, v68, v68
    v_cvt_pk_bf16_f32 v83, v68, v68
    ds_write_b128 v29, v[72:75]
    ds_write_b128 v26, v[76:79]
    ds_write_b128 v26, v[80:83] offset:16
L_kj_20:
    v_sin_f32 v107, v100
    v_mul_f32 v106, v99, v106
    v_mul_f32_e64 v107, v99, v107
    v_pk_mul_f32 v[108:109], v[202:203], v[204:205] op_sel:[0,0] op_sel_hi:[1,0]
    v_pk_fma_f32 v[114:115], v[202:203], v[204:205], v[108:109] op_sel:[1,1,0] op_sel_hi:[0,1,1] neg_lo:[1,0,0]
    v_pk_mul_f32 v[114:115], v[114:115], v[96:97] op_sel_hi:[1,0]
    v_cvt_pk_bf16_f32 v132, v114, -v115
    v_mov_b32 v133, 0x3f80
    v_cvt_pk_bf16_f32 v134, v104, v105
    v_pk_mul_f32 v[108:109], v[114:115], v[102:103] op_sel:[0,0] op_sel_hi:[1,0]
    v_pk_fma_f32 v[112:113], v[114:115], v[102:103], v[108:109] op_sel:[1,1,0] op_sel_hi:[0,1,1] neg_lo:[1,0,0]
    v_cvt_pk_bf16_f32 v135, v112, -v113
    v_pk_mul_f32 v[108:109], v[112:113], v[102:103] op_sel:[0,0] op_sel_hi:[1,0]
    v_pk_fma_f32 v[116:117], v[112:113], v[102:103], v[108:109] op_sel:[1,1,0] op_sel_hi:[0,1,1] neg_lo:[1,0,0]
    v_cvt_pk_bf16_f32 v136, v116, -v117
    v_pk_mul_f32 v[108:109], v[104:105], v[104:105] op_sel:[0,0] op_sel_hi:[1,0]
    v_pk_fma_f32 v[110:111], v[104:105], v[104:105], v[108:109] op_sel:[1,1,0] op_sel_hi:[0,1,1] neg_lo:[1,0,0]
    v_cvt_pk_bf16_f32 v137, v110, v111
    v_pk_mul_f32 v[108:109], v[116:117], v[102:103] op_sel:[0,0] op_sel_hi:[1,0]
    v_pk_fma_f32 v[112:113], v[116:117], v[102:103], v[108:109] op_sel:[1,1,0] op_sel_hi:[0,1,1] neg_lo:[1,0,0]
    v_cvt_pk_bf16_f32 v138, v112, -v113
    v_pk_mul_f32 v[108:109], v[110:111], v[104:105] op_sel:[0,0] op_sel_hi:[1,0]
    v_pk_fma_f32 v[110:111], v[110:111], v[104:105], v[108:109] op_sel:[1,1,0] op_sel_hi:[0,1,1] neg_lo:[1,0,0]
    v_cvt_pk_bf16_f32 v139, v110, v111
    v_pk_mul_f32 v[108:109], v[112:113], v[102:103] op_sel:[0,0] op_sel_hi:[1,0]
    v_pk_fma_f32 v[118:119], v[112:113], v[102:103], v[108:109] op_sel:[1,1,0] op_sel_hi:[0,1,1] neg_lo:[1,0,0]
    v_cvt_pk_bf16_f32 v140, v118, -v119
    v_pk_mul_f32 v[108:109], v[110:111], v[104:105] op_sel:[0,0] op_sel_hi:[1,0]
    v_pk_fma_f32 v[110:111], v[110:111], v[104:105], v[108:109] op_sel:[1,1,0] op_sel_hi:[0,1,1] neg_lo:[1,0,0]
    v_cvt_pk_bf16_f32 v141, v110, v111
    s_mul_i32 s77, s64, 573440
    s_mul_i32 s78, s76, 5120
    s_add_u32 s77, s77, s78
    s_add_u32 s77, s77, 6291456
    v_add_u32 v8, s77, v2
    v_add_u32 v9, 4096, v8
    s_cmp_eq_u32 s64, 3
    s_cselect_b32 s94, 0x70000000, 0
    s_mul_i32 s77, s75, 221184
    s_mul_i32 s78, s64, 14336
    s_add_u32 s77, s77, s78
    s_add_u32 s77, s77, 11272192
    v_add_u32 v10, s77, v2
    v_or_b32 v11, s94, v10
    v_lshrrev_b32 v12, 3, v1
    v_lshlrev_b32 v12, 12, v12
    v_and_b32_e64 v90, 7, v1
    v_lshl_add_u32 v12, v90, 4, v12
    s_mul_i32 s77, s76, 327680
    s_lshl_b32 s78, s75, 7
    s_add_u32 s77, s77, s78
    s_lshl_b32 s78, s64, 15
    s_add_u32 s77, s77, s78
    s_add_u32 s77, s77, 8650752
    v_add_u32 v12, s77, v12
    v_min_u32 v90, 39, v1
    v_mul_u32_u24 v91, 26, v90
    v_lshrrev_b32 v91, 8, v91
    v_mul_u32_u24 v92, 10, v91
    v_sub_u32 v92, v90, v92
    v_lshl_add_u32 v93, v91, 2, s64
    v_mul_u32_u24 v13, 1280, v93
    v_lshl_add_u32 v13, v92, 4, v13
    s_mul_i32 s77, s75, 81920
    s_mul_i32 s78, s76, 160
    s_add_u32 s77, s77, s78
    v_add_u32 v13, s77, v13
    v_cmp_gt_u32_e64 vcc, 40, v1
    v_mov_b32 v90, 0x70000000
    v_lshl_add_u32 v17, v92, 4, s78
    v_cndmask_b32_e64 v13, v90, v13, vcc
    v_mul_u32_u24 v15, 1040, v92
    v_and_b32_e64 v90, 1, v91
    v_lshl_add_u32 v15, v90, 3, v15
    v_lshrrev_b32_e64 v90, 1, v91
    v_lshl_add_u32 v15, v90, 6, v15
    s_lshl_b32 s77, s64, 4
    s_add_u32 s77, s77, 86016
    v_add_u32 v15, s77, v15
    v_lshrrev_b32_e64 v90, 1, v92
    v_mul_u32_u24 v14, 1040, v90
    v_lshl_add_u32 v14, v91, 6, v14
    v_and_b32_e64 v90, 1, v92
    v_lshl_add_u32 v14, v90, 5, v14
    s_lshl_b32 s77, s64, 8
    s_add_u32 s77, s77, 33792
    v_add_u32 v14, s77, v14
    s_mul_i32 s77, s64, 1040
    s_add_u32 s77, s77, 86016
    v_add_u32_e64 v16, s77, v2
    s_mul_i32 s77, s76, 40
    s_lshl_b32 s78, s64, 2
    s_add_u32 s77, s77, s78
    s_lshl_b32 s77, s77, 7
    s_add_u32 s77, s77, 163840
    s_cmp_lt_u32 s64, 2
    s_cselect_b32 s78, 2, 1
    v_lshrrev_b32 v90, 2, v1
    v_min_u32 v90, s78, v90
    v_lshl_add_u32 v19, v90, 11, s77
    v_and_b32_e64 v91, 3, v1
    v_lshl_add_u32 v19, v91, 7, v19
    s_mul_i32 s77, s75, 28
    s_mul_i32 s78, s64, 7
    s_lshr_b32 s78, s78, 1
    s_add_u32 s77, s77, s78
    s_lshl_b32 s77, s77, 7
    s_add_u32 s77, s77, 40960
    v_lshl_add_u32 v18, v91, 7, s77
    v_bfe_u32 v90, v1, 2, 1
    v_mul_u32_u24 v90, 1792, v90
    v_add_u32 v18, v18, v90
    s_waitcnt lgkmcnt(0)
    s_barrier
    v_add_u32_e64 v88, 4, v30
    ds_read2st64_b32 v[240:241], v30 offset0:0 offset1:1
    ds_read2st64_b32 v[242:243], v30 offset0:2 offset1:3
    ds_read2st64_b32 v[244:245], v30 offset0:4 offset1:5
    ds_read2st64_b32 v[246:247], v30 offset0:6 offset1:7
    ds_read2st64_b32 v[248:249], v88 offset0:0 offset1:1
    ds_read2st64_b32 v[250:251], v88 offset0:2 offset1:3
    ds_read2st64_b32 v[252:253], v88 offset0:4 offset1:5
    ds_read2st64_b32 v[254:255], v88 offset0:6 offset1:7
    v_pk_mul_f32 v[108:109], v[118:119], v[102:103] op_sel:[0,0] op_sel_hi:[1,0]
    v_pk_fma_f32 v[112:113], v[118:119], v[102:103], v[108:109] op_sel:[1,1,0] op_sel_hi:[0,1,1] neg_lo:[1,0,0]
    v_cvt_pk_bf16_f32 v142, v112, -v113
    v_pk_mul_f32 v[108:109], v[110:111], v[104:105] op_sel:[0,0] op_sel_hi:[1,0]
    v_pk_fma_f32 v[110:111], v[110:111], v[104:105], v[108:109] op_sel:[1,1,0] op_sel_hi:[0,1,1] neg_lo:[1,0,0]
    v_cvt_pk_bf16_f32 v143, v110, v111
    v_pk_mul_f32 v[108:109], v[112:113], v[102:103] op_sel:[0,0] op_sel_hi:[1,0]
    v_pk_fma_f32 v[120:121], v[112:113], v[102:103], v[108:109] op_sel:[1,1,0] op_sel_hi:[0,1,1] neg_lo:[1,0,0]
    v_cvt_pk_bf16_f32 v144, v120, -v121
    v_pk_mul_f32 v[108:109], v[110:111], v[104:105] op_sel:[0,0] op_sel_hi:[1,0]
    v_pk_fma_f32 v[110:111], v[110:111], v[104:105], v[108:109] op_sel:[1,1,0] op_sel_hi:[0,1,1] neg_lo:[1,0,0]
    v_cvt_pk_bf16_f32 v145, v110, v111
    v_pk_mul_f32 v[108:109], v[120:121], v[102:103] op_sel:[0,0] op_sel_hi:[1,0]
    v_pk_fma_f32 v[112:113], v[120:121], v[102:103], v[108:109] op_sel:[1,1,0] op_sel_hi:[0,1,1] neg_lo:[1,0,0]
    v_cvt_pk_bf16_f32 v146, v112, -v113
    v_pk_mul_f32 v[108:109], v[110:111], v[104:105] op_sel:[0,0] op_sel_hi:[1,0]
    v_pk_fma_f32 v[110:111], v[110:111], v[104:105], v[108:109] op_sel:[1,1,0] op_sel_hi:[0,1,1] neg_lo:[1,0,0]
    v_cvt_pk_bf16_f32 v147, v110, v111
    s_waitcnt lgkmcnt(0)
    v_alignbit_b32 v248, v248, v240, 16
    v_alignbit_b32 v249, v249, v241, 16
    v_alignbit_b32 v250, v250, v242, 16
    v_alignbit_b32 v251, v251, v243, 16
    v_alignbit_b32 v252, v252, v244, 16
    v_alignbit_b32 v253, v253, v245, 16
    v_alignbit_b32 v254, v254, v246, 16
    v_alignbit_b32 v255, v255, v247, 16
    s_mov_b32 m0, s73
    s_nop 0
    ds_write_addtid_b32 v132 offset:0
    ds_write_addtid_b32 v133 offset:49632
    ds_write_addtid_b32 v134 offset:50688
    ds_write_addtid_b32 v135 offset:1056
    ds_write_addtid_b32 v136 offset:2112
    ds_write_addtid_b32 v137 offset:51744
    ds_write_addtid_b32 v138 offset:3168
    ds_write_addtid_b32 v139 offset:52800
    ds_write_addtid_b32 v140 offset:4224
    ds_write_addtid_b32 v141 offset:53856
    ds_write_addtid_b32 v142 offset:5280
    ds_write_addtid_b32 v143 offset:54912
    ds_write_addtid_b32 v144 offset:6336
    ds_write_addtid_b32 v145 offset:55968
    ds_write_addtid_b32 v146 offset:7392
    ds_write_addtid_b32 v147 offset:57024
    v_pk_mul_f32 v[108:109], v[112:113], v[102:103] op_sel:[0,0] op_sel_hi:[1,0]
    v_pk_fma_f32 v[122:123], v[112:113], v[102:103], v[108:109] op_sel:[1,1,0] op_sel_hi:[0,1,1] neg_lo:[1,0,0]
    v_cvt_pk_bf16_f32 v132, v122, -v123
    v_pk_mul_f32 v[108:109], v[110:111], v[104:105] op_sel:[0,0] op_sel_hi:[1,0]
    v_pk_fma_f32 v[110:111], v[110:111], v[104:105], v[108:109] op_sel:[1,1,0] op_sel_hi:[0,1,1] neg_lo:[1,0,0]
    v_cvt_pk_bf16_f32 v133, v110, v111
    v_pk_mul_f32 v[108:109], v[122:123], v[102:103] op_sel:[0,0] op_sel_hi:[1,0]
    v_pk_fma_f32 v[112:113], v[122:123], v[102:103], v[108:109] op_sel:[1,1,0] op_sel_hi:[0,1,1] neg_lo:[1,0,0]
    v_cvt_pk_bf16_f32 v134, v112, -v113
    v_pk_mul_f32 v[108:109], v[110:111], v[104:105] op_sel:[0,0] op_sel_hi:[1,0]
    v_pk_fma_f32 v[110:111], v[110:111], v[104:105], v[108:109] op_sel:[1,1,0] op_sel_hi:[0,1,1] neg_lo:[1,0,0]
    v_cvt_pk_bf16_f32 v135, v110, v111
    v_pk_mul_f32 v[108:109], v[112:113], v[102:103] op_sel:[0,0] op_sel_hi:[1,0]
    v_pk_fma_f32 v[124:125], v[112:113], v[102:103], v[108:109] op_sel:[1,1,0] op_sel_hi:[0,1,1] neg_lo:[1,0,0]
    v_cvt_pk_bf16_f32 v136, v124, -v125
    v_pk_mul_f32 v[108:109], v[110:111], v[104:105] op_sel:[0,0] op_sel_hi:[1,0]
    v_pk_fma_f32 v[110:111], v[110:111], v[104:105], v[108:109] op_sel:[1,1,0] op_sel_hi:[0,1,1] neg_lo:[1,0,0]
    v_cvt_pk_bf16_f32 v137, v110, v111
    v_pk_mul_f32 v[108:109], v[124:125], v[102:103] op_sel:[0,0] op_sel_hi:[1,0]
    v_pk_fma_f32 v[112:113], v[124:125], v[102:103], v[108:109] op_sel:[1,1,0] op_sel_hi:[0,1,1] neg_lo:[1,0,0]
    v_cvt_pk_bf16_f32 v138, v112, -v113
    v_pk_mul_f32 v[108:109], v[110:111], v[104:105] op_sel:[0,0] op_sel_hi:[1,0]
    v_pk_fma_f32 v[110:111], v[110:111], v[104:105], v[108:109] op_sel:[1,1,0] op_sel_hi:[0,1,1] neg_lo:[1,0,0]
    v_cvt_pk_bf16_f32 v139, v110, v111
    ds_write_addtid_b32 v132 offset:8448
    ds_write_addtid_b32 v133 offset:58080
    ds_write_addtid_b32 v134 offset:9504
    ds_write_addtid_b32 v135 offset:59136
    ds_write_addtid_b32 v136 offset:10560
    ds_write_addtid_b32 v137 offset:60192
    ds_write_addtid_b32 v138 offset:11616
    ds_write_addtid_b32 v139 offset:61248
    v_pk_mul_f32 v[108:109], v[112:113], v[102:103] op_sel:[0,0] op_sel_hi:[1,0]
    v_pk_fma_f32 v[126:127], v[112:113], v[102:103], v[108:109] op_sel:[1,1,0] op_sel_hi:[0,1,1] neg_lo:[1,0,0]
    v_cvt_pk_bf16_f32 v140, v126, -v127
    v_pk_mul_f32 v[108:109], v[110:111], v[104:105] op_sel:[0,0] op_sel_hi:[1,0]
    buffer_load_dwordx2 v[20:21], v47, s[40:43], 0 offen sc1
    v_pk_fma_f32 v[110:111], v[110:111], v[104:105], v[108:109] op_sel:[1,1,0] op_sel_hi:[0,1,1] neg_lo:[1,0,0]
    v_cvt_pk_bf16_f32 v141, v110, v111
    v_pk_mul_f32 v[108:109], v[126:127], v[102:103] op_sel:[0,0] op_sel_hi:[1,0]
    v_pk_fma_f32 v[112:113], v[126:127], v[102:103], v[108:109] op_sel:[1,1,0] op_sel_hi:[0,1,1] neg_lo:[1,0,0]
    v_cvt_pk_bf16_f32 v142, v112, -v113
    v_pk_mul_f32 v[108:109], v[110:111], v[104:105] op_sel:[0,0] op_sel_hi:[1,0]
    v_pk_fma_f32 v[110:111], v[110:111], v[104:105], v[108:109] op_sel:[1,1,0] op_sel_hi:[0,1,1] neg_lo:[1,0,0]
    v_cvt_pk_bf16_f32 v143, v110, v111
    v_pk_mul_f32 v[108:109], v[112:113], v[102:103] op_sel:[0,0] op_sel_hi:[1,0]
    v_pk_fma_f32 v[128:129], v[112:113], v[102:103], v[108:109] op_sel:[1,1,0] op_sel_hi:[0,1,1] neg_lo:[1,0,0]
    v_cvt_pk_bf16_f32 v144, v128, -v129
    v_pk_mul_f32 v[108:109], v[110:111], v[104:105] op_sel:[0,0] op_sel_hi:[1,0]
    v_pk_fma_f32 v[110:111], v[110:111], v[104:105], v[108:109] op_sel:[1,1,0] op_sel_hi:[0,1,1] neg_lo:[1,0,0]
    v_cvt_pk_bf16_f32 v145, v110, v111
    v_pk_mul_f32 v[108:109], v[128:129], v[102:103] op_sel:[0,0] op_sel_hi:[1,0]
    v_pk_fma_f32 v[112:113], v[128:129], v[102:103], v[108:109] op_sel:[1,1,0] op_sel_hi:[0,1,1] neg_lo:[1,0,0]
    v_cvt_pk_bf16_f32 v146, v112, -v113
    v_pk_mul_f32 v[108:109], v[110:111], v[104:105] op_sel:[0,0] op_sel_hi:[1,0]
    v_pk_fma_f32 v[110:111], v[110:111], v[104:105], v[108:109] op_sel:[1,1,0] op_sel_hi:[0,1,1] neg_lo:[1,0,0]
    v_cvt_pk_bf16_f32 v147, v110, v111
    ds_write_addtid_b32 v140 offset:12672
    ds_write_addtid_b32 v141 offset:62304
    ds_write_addtid_b32 v142 offset:13728
    ds_write_addtid_b32 v143 offset:63360
    ds_write_addtid_b32 v144 offset:14784
    ds_write_addtid_b32 v145 offset:64416
    ds_write_addtid_b32 v146 offset:15840
    ds_write_addtid_b32 v147 offset:65472
    v_pk_mul_f32 v[108:109], v[112:113], v[102:103] op_sel:[0,0] op_sel_hi:[1,0]
    v_pk_fma_f32 v[130:131], v[112:113], v[102:103], v[108:109] op_sel:[1,1,0] op_sel_hi:[0,1,1] neg_lo:[1,0,0]
    v_pk_mul_f32 v[108:109], v[114:115], v[106:107] op_sel:[0,0] op_sel_hi:[1,0]
    v_pk_fma_f32 v[114:115], v[114:115], v[106:107], v[108:109] op_sel:[1,1,0] op_sel_hi:[0,1,1] neg_lo:[1,0,0]
    v_cvt_pk_bf16_f32 v132, v114, -v115
    v_pk_mul_f32 v[108:109], v[116:117], v[106:107] op_sel:[0,0] op_sel_hi:[1,0]
    v_pk_fma_f32 v[116:117], v[116:117], v[106:107], v[108:109] op_sel:[1,1,0] op_sel_hi:[0,1,1] neg_lo:[1,0,0]
    v_cvt_pk_bf16_f32 v133, v116, -v117
    v_pk_mul_f32 v[108:109], v[118:119], v[106:107] op_sel:[0,0] op_sel_hi:[1,0]
    v_pk_fma_f32 v[118:119], v[118:119], v[106:107], v[108:109] op_sel:[1,1,0] op_sel_hi:[0,1,1] neg_lo:[1,0,0]
    v_cvt_pk_bf16_f32 v134, v118, -v119
    v_pk_mul_f32 v[108:109], v[120:121], v[106:107] op_sel:[0,0] op_sel_hi:[1,0]
    v_pk_fma_f32 v[120:121], v[120:121], v[106:107], v[108:109] op_sel:[1,1,0] op_sel_hi:[0,1,1] neg_lo:[1,0,0]
    v_cvt_pk_bf16_f32 v135, v120, -v121
    v_pk_mul_f32 v[108:109], v[122:123], v[106:107] op_sel:[0,0] op_sel_hi:[1,0]
    v_pk_fma_f32 v[122:123], v[122:123], v[106:107], v[108:109] op_sel:[1,1,0] op_sel_hi:[0,1,1] neg_lo:[1,0,0]
    v_cvt_pk_bf16_f32 v136, v122, -v123
    v_pk_mul_f32 v[108:109], v[124:125], v[106:107] op_sel:[0,0] op_sel_hi:[1,0]
    v_pk_fma_f32 v[124:125], v[124:125], v[106:107], v[108:109] op_sel:[1,1,0] op_sel_hi:[0,1,1] neg_lo:[1,0,0]
    v_cvt_pk_bf16_f32 v137, v124, -v125
    v_pk_mul_f32 v[108:109], v[126:127], v[106:107] op_sel:[0,0] op_sel_hi:[1,0]
    v_pk_fma_f32 v[126:127], v[126:127], v[106:107], v[108:109] op_sel:[1,1,0] op_sel_hi:[0,1,1] neg_lo:[1,0,0]
    v_cvt_pk_bf16_f32 v138, v126, -v127
    v_pk_mul_f32 v[108:109], v[128:129], v[106:107] op_sel:[0,0] op_sel_hi:[1,0]
    v_pk_fma_f32 v[128:129], v[128:129], v[106:107], v[108:109] op_sel:[1,1,0] op_sel_hi:[0,1,1] neg_lo:[1,0,0]
    v_cvt_pk_bf16_f32 v139, v128, -v129
    ds_write_addtid_b32 v132 offset:28512
    ds_write_addtid_b32 v133 offset:17952
    ds_write_addtid_b32 v134 offset:19008
    ds_write_addtid_b32 v135 offset:20064
    ds_write_addtid_b32 v136 offset:16896
    ds_write_addtid_b32 v137 offset:21120
    ds_write_addtid_b32 v138 offset:24288
    ds_write_addtid_b32 v139 offset:22176
    v_pk_mul_f32 v[108:109], v[130:131], v[106:107] op_sel:[0,0] op_sel_hi:[1,0]
    v_pk_fma_f32 v[130:131], v[130:131], v[106:107], v[108:109] op_sel:[1,1,0] op_sel_hi:[0,1,1] neg_lo:[1,0,0]
    v_cvt_pk_bf16_f32 v140, v130, -v131
    v_pk_mul_f32 v[108:109], v[114:115], v[106:107] op_sel:[0,0] op_sel_hi:[1,0]
    v_pk_fma_f32 v[114:115], v[114:115], v[106:107], v[108:109] op_sel:[1,1,0] op_sel_hi:[0,1,1] neg_lo:[1,0,0]
    v_cvt_pk_bf16_f32 v141, v114, -v115
    v_pk_mul_f32 v[108:109], v[118:119], v[106:107] op_sel:[0,0] op_sel_hi:[1,0]
    v_pk_fma_f32 v[118:119], v[118:119], v[106:107], v[108:109] op_sel:[1,1,0] op_sel_hi:[0,1,1] neg_lo:[1,0,0]
    v_cvt_pk_bf16_f32 v142, v118, -v119
    v_pk_mul_f32 v[108:109], v[122:123], v[106:107] op_sel:[0,0] op_sel_hi:[1,0]
    v_pk_fma_f32 v[122:123], v[122:123], v[106:107], v[108:109] op_sel:[1,1,0] op_sel_hi:[0,1,1] neg_lo:[1,0,0]
    v_cvt_pk_bf16_f32 v143, v122, -v123
    v_pk_mul_f32 v[108:109], v[126:127], v[106:107] op_sel:[0,0] op_sel_hi:[1,0]
    v_pk_fma_f32 v[126:127], v[126:127], v[106:107], v[108:109] op_sel:[1,1,0] op_sel_hi:[0,1,1] neg_lo:[1,0,0]
    v_cvt_pk_bf16_f32 v144, v126, -v127
    v_pk_mul_f32 v[108:109], v[130:131], v[106:107] op_sel:[0,0] op_sel_hi:[1,0]
    v_pk_fma_f32 v[130:131], v[130:131], v[106:107], v[108:109] op_sel:[1,1,0] op_sel_hi:[0,1,1] neg_lo:[1,0,0]
    v_cvt_pk_bf16_f32 v145, v130, -v131
    v_pk_mul_f32 v[108:109], v[114:115], v[106:107] op_sel:[0,0] op_sel_hi:[1,0]
    v_pk_fma_f32 v[114:115], v[114:115], v[106:107], v[108:109] op_sel:[1,1,0] op_sel_hi:[0,1,1] neg_lo:[1,0,0]
    v_cvt_pk_bf16_f32 v146, v114, -v115
    v_pk_mul_f32 v[108:109], v[118:119], v[106:107] op_sel:[0,0] op_sel_hi:[1,0]
    v_pk_fma_f32 v[118:119], v[118:119], v[106:107], v[108:109] op_sel:[1,1,0] op_sel_hi:[0,1,1] neg_lo:[1,0,0]
    v_cvt_pk_bf16_f32 v147, v118, -v119
    ds_write_addtid_b32 v140 offset:25344
    ds_write_addtid_b32 v141 offset:29568
    ds_write_addtid_b32 v142 offset:33792
    ds_write_addtid_b32 v143 offset:32736
    ds_write_addtid_b32 v144 offset:31680
    ds_write_addtid_b32 v145 offset:30624
    ds_write_addtid_b32 v146 offset:34848
    ds_write_addtid_b32 v147 offset:36960
    v_pk_mul_f32 v[108:109], v[122:123], v[106:107] op_sel:[0,0] op_sel_hi:[1,0]
    v_pk_fma_f32 v[122:123], v[122:123], v[106:107], v[108:109] op_sel:[1,1,0] op_sel_hi:[0,1,1] neg_lo:[1,0,0]
    v_cvt_pk_bf16_f32 v132, v122, -v123
    v_pk_mul_f32 v[108:109], v[126:127], v[106:107] op_sel:[0,0] op_sel_hi:[1,0]
    v_pk_fma_f32 v[126:127], v[126:127], v[106:107], v[108:109] op_sel:[1,1,0] op_sel_hi:[0,1,1] neg_lo:[1,0,0]
    v_cvt_pk_bf16_f32 v133, v126, -v127
    v_pk_mul_f32 v[108:109], v[130:131], v[106:107] op_sel:[0,0] op_sel_hi:[1,0]
    v_pk_fma_f32 v[130:131], v[130:131], v[106:107], v[108:109] op_sel:[1,1,0] op_sel_hi:[0,1,1] neg_lo:[1,0,0]
    v_cvt_pk_bf16_f32 v134, v130, -v131
    v_pk_mul_f32 v[108:109], v[114:115], v[106:107] op_sel:[0,0] op_sel_hi:[1,0]
    v_pk_fma_f32 v[114:115], v[114:115], v[106:107], v[108:109] op_sel:[1,1,0] op_sel_hi:[0,1,1] neg_lo:[1,0,0]
    v_cvt_pk_bf16_f32 v135, v114, -v115
    v_pk_mul_f32 v[108:109], v[122:123], v[106:107] op_sel:[0,0] op_sel_hi:[1,0]
    v_pk_fma_f32 v[122:123], v[122:123], v[106:107], v[108:109] op_sel:[1,1,0] op_sel_hi:[0,1,1] neg_lo:[1,0,0]
    v_cvt_pk_bf16_f32 v136, v122, -v123
    v_pk_mul_f32 v[108:109], v[130:131], v[106:107] op_sel:[0,0] op_sel_hi:[1,0]
    v_pk_fma_f32 v[130:131], v[130:131], v[106:107], v[108:109] op_sel:[1,1,0] op_sel_hi:[0,1,1] neg_lo:[1,0,0]
    v_cvt_pk_bf16_f32 v137, v130, -v131
    v_pk_mul_f32 v[108:109], v[114:115], v[106:107] op_sel:[0,0] op_sel_hi:[1,0]
    v_pk_fma_f32 v[114:115], v[114:115], v[106:107], v[108:109] op_sel:[1,1,0] op_sel_hi:[0,1,1] neg_lo:[1,0,0]
    v_cvt_pk_bf16_f32 v138, v114, -v115
    v_pk_mul_f32 v[108:109], v[122:123], v[106:107] op_sel:[0,0] op_sel_hi:[1,0]
    v_pk_fma_f32 v[122:123], v[122:123], v[106:107], v[108:109] op_sel:[1,1,0] op_sel_hi:[0,1,1] neg_lo:[1,0,0]
    v_cvt_pk_bf16_f32 v139, v122, -v123
    ds_write_addtid_b32 v132 offset:27456
    ds_write_addtid_b32 v133 offset:23232
    ds_write_addtid_b32 v134 offset:26400
    ds_write_addtid_b32 v135 offset:43296
    ds_write_addtid_b32 v136 offset:45408
    ds_write_addtid_b32 v137 offset:35904
    ds_write_addtid_b32 v138 offset:47520
    ds_write_addtid_b32 v139 offset:42240
    v_pk_mul_f32 v[108:109], v[130:131], v[106:107] op_sel:[0,0] op_sel_hi:[1,0]
    v_pk_fma_f32 v[130:131], v[130:131], v[106:107], v[108:109] op_sel:[1,1,0] op_sel_hi:[0,1,1] neg_lo:[1,0,0]
    v_cvt_pk_bf16_f32 v140, v130, -v131
    v_pk_mul_f32 v[108:109], v[114:115], v[106:107] op_sel:[0,0] op_sel_hi:[1,0]
    v_pk_fma_f32 v[114:115], v[114:115], v[106:107], v[108:109] op_sel:[1,1,0] op_sel_hi:[0,1,1] neg_lo:[1,0,0]
    v_cvt_pk_bf16_f32 v141, v114, -v115
    v_pk_mul_f32 v[108:109], v[122:123], v[106:107] op_sel:[0,0] op_sel_hi:[1,0]
    v_pk_fma_f32 v[122:123], v[122:123], v[106:107], v[108:109] op_sel:[1,1,0] op_sel_hi:[0,1,1] neg_lo:[1,0,0]
    v_cvt_pk_bf16_f32 v142, v122, -v123
    v_pk_mul_f32 v[108:109], v[130:131], v[106:107] op_sel:[0,0] op_sel_hi:[1,0]
    v_pk_fma_f32 v[130:131], v[130:131], v[106:107], v[108:109] op_sel:[1,1,0] op_sel_hi:[0,1,1] neg_lo:[1,0,0]
    v_cvt_pk_bf16_f32 v143, v130, -v131
    s_waitcnt vmcnt(0)
    v_cmp_ne_u64_e64 vcc, s[70:71], v[20:21]
    s_cbranch_vccnz L_poll_22
L_ok_21:
    s_barrier
    s_cmp_lg_u32 s2, 255
    s_cbranch_scc1 L_noagg
    s_cmp_lg_u32 s64, 0
    s_cbranch_scc1 L_fs_23
    s_mov_b64 exec, 1
    buffer_store_dwordx2 v[22:23], v2, s[40:43], 0 offen sc1
    s_mov_b64 exec, -1
L_fs_23:
L_noagg:
    s_mov_b32 s26, 327680
    v_pk_mul_f32 v[108:109], v[114:115], v[106:107] op_sel:[0,0] op_sel_hi:[1,0]
    v_pk_fma_f32 v[114:115], v[114:115], v[106:107], v[108:109] op_sel:[1,1,0] op_sel_hi:[0,1,1] neg_lo:[1,0,0]
    v_cvt_pk_bf16_f32 v144, v114, -v115
    buffer_load_dwordx4 a[136:139], v39, s[40:43], 0 offen offset:0 sc1
    v_pk_mul_f32 v[108:109], v[122:123], v[106:107] op_sel:[0,0] op_sel_hi:[1,0]
    v_pk_fma_f32 v[122:123], v[122:123], v[106:107], v[108:109] op_sel:[1,1,0] op_sel_hi:[0,1,1] neg_lo:[1,0,0]
    v_cvt_pk_bf16_f32 v145, v122, -v123
    buffer_load_dwordx4 a[140:143], v39, s[40:43], s26 offen offset:0 sc1
    v_pk_mul_f32 v[108:109], v[130:131], v[106:107] op_sel:[0,0] op_sel_hi:[1,0]
    v_pk_fma_f32 v[130:131], v[130:131], v[106:107], v[108:109] op_sel:[1,1,0] op_sel_hi:[0,1,1] neg_lo:[1,0,0]
    v_cvt_pk_bf16_f32 v146, v130, -v131
    ds_write_addtid_b32 v140 offset:41184
    ds_write_addtid_b32 v141 offset:46464
    ds_write_addtid_b32 v142 offset:44352
    ds_write_addtid_b32 v143 offset:40128
    ds_write_addtid_b32 v144 offset:48576
    ds_write_addtid_b32 v145 offset:39072
    ds_write_addtid_b32 v146 offset:38016
    s_waitcnt lgkmcnt(0)
    s_barrier
    ds_read_b128 a[0:3], v28 offset:0
    ds_read_b128 a[4:7], v24 offset:0
    ds_read_b128 a[8:11], v25 offset:0
    ds_read_b128 a[12:15], v28 offset:64
    ds_read_b128 a[16:19], v24 offset:64
    ds_read_b128 a[20:23], v25 offset:64
    ds_read_b128 a[24:27], v28 offset:128
    ds_read_b128 a[28:31], v24 offset:128
    ds_read_b128 a[32:35], v25 offset:128
    ds_read_b128 a[36:39], v28 offset:192
    ds_read_b128 a[40:43], v24 offset:192
    ds_read_b128 a[44:47], v25 offset:192
    s_mov_b32 m0, s74
    s_nop 0
    ds_write_addtid_b32 v208 offset:35840
    ds_write_addtid_b32 v209 offset:36096
    ds_write_addtid_b32 v210 offset:36352
    s_mov_b32 s25, 0
    ds_write_addtid_b32 v211 offset:36608
    ds_write_addtid_b32 v212 offset:36864
    ds_write_addtid_b32 v213 offset:37120
    ds_write_addtid_b32 v214 offset:37376
    ds_write_addtid_b32 v215 offset:37632
    buffer_load_dwordx4 a[160:163], v8, s[40:43], s25 offen offset:0 sc1
    ds_write_addtid_b32 v216 offset:40000
    ds_write_addtid_b32 v217 offset:40256
    ds_write_addtid_b32 v218 offset:40512
    ds_write_addtid_b32 v219 offset:40768
    ds_write_addtid_b32 v220 offset:41024
    ds_write_addtid_b32 v221 offset:41280
    buffer_load_dwordx4 a[164:167], v8, s[40:43], s25 offen offset:1024 sc1
    ds_write_addtid_b32 v222 offset:41536
    ds_write_addtid_b32 v223 offset:41792
    ds_write_addtid_b32 v208 offset:44156
    ds_write_addtid_b32 v209 offset:44412
    ds_write_addtid_b32 v210 offset:44668
    ds_write_addtid_b32 v211 offset:44924
    buffer_load_dwordx4 a[168:171], v8, s[40:43], s25 offen offset:2048 sc1
    ds_write_addtid_b32 v212 offset:45180
    ds_write_addtid_b32 v213 offset:45436
    ds_write_addtid_b32 v214 offset:45692
    ds_write_addtid_b32 v215 offset:45948
    ds_write_addtid_b32 v216 offset:48316
    ds_write_addtid_b32 v217 offset:48572
    buffer_load_dwordx4 a[172:175], v8, s[40:43], s25 offen offset:3072 sc1
    ds_write_addtid_b32 v218 offset:48828
    ds_write_addtid_b32 v219 offset:49084
    ds_write_addtid_b32 v220 offset:49340
    ds_write_addtid_b32 v221 offset:49596
    ds_write_addtid_b32 v222 offset:49852
    ds_write_addtid_b32 v223 offset:50108
    s_waitcnt lgkmcnt(15)
    v_mfma_f32_16x16x32_bf16 v[64:67], a[4:7], a[0:3], 0
    ds_read_b128 a[48:51], v28 offset:256
    v_mfma_f32_16x16x32_bf16 v[68:71], a[8:11], a[0:3], 0
    ds_read_b128 a[52:55], v24 offset:256
    s_waitcnt lgkmcnt(15)
    v_mfma_f32_16x16x32_bf16 v[64:67], a[16:19], a[12:15], v[64:67]
    ds_read_b128 a[56:59], v25 offset:256
    v_mfma_f32_16x16x32_bf16 v[68:71], a[20:23], a[12:15], v[68:71]
    ds_read_b128 a[60:63], v28 offset:320
    s_waitcnt lgkmcnt(15)
    v_mfma_f32_16x16x32_bf16 v[64:67], a[28:31], a[24:27], v[64:67]
    ds_read_b128 a[64:67], v24 offset:320
    v_mfma_f32_16x16x32_bf16 v[68:71], a[32:35], a[24:27], v[68:71]
    ds_read_b128 a[68:71], v25 offset:320
    s_waitcnt lgkmcnt(15)
    v_mfma_f32_16x16x32_bf16 v[64:67], a[40:43], a[36:39], v[64:67]
    ds_read_b128 a[72:75], v28 offset:384
    v_mfma_f32_16x16x32_bf16 v[68:71], a[44:47], a[36:39], v[68:71]
    ds_read_b128 a[76:79], v24 offset:384
    s_waitcnt lgkmcnt(5)
    v_mfma_f32_16x16x32_bf16 v[64:67], a[52:55], a[48:51], v[64:67]
    ds_read_b128 a[80:83], v25 offset:384
    v_mfma_f32_16x16x32_bf16 v[68:71], a[56:59], a[48:51], v[68:71]
    ds_read_b128 a[84:87], v28 offset:448
    s_waitcnt lgkmcnt(4)
    v_mfma_f32_16x16x32_bf16 v[64:67], a[64:67], a[60:63], v[64:67]
    ds_read_b128 a[88:91], v24 offset:448
    v_mfma_f32_16x16x32_bf16 v[68:71], a[68:71], a[60:63], v[68:71]
    ds_read_b128 a[92:95], v25 offset:448
    s_waitcnt lgkmcnt(3)
    v_mfma_f32_16x16x32_bf16 v[64:67], a[76:79], a[72:75], v[64:67]
    v_mfma_f32_16x16x32_bf16 v[68:71], a[80:83], a[72:75], v[68:71]
    s_waitcnt lgkmcnt(0)
    v_mfma_f32_16x16x32_bf16 v[64:67], a[88:91], a[84:87], v[64:67]
    v_mfma_f32_16x16x32_bf16 v[68:71], a[92:95], a[84:87], v[68:71]
    s_bitcmp1_b32 s64, 0
    s_cbranch_scc1 L_kh_25
    s_nop 5
    v_add_f32 v67, v67, v207
    v_cvt_pk_bf16_f32 v72, v64, v65
    v_cvt_pk_bf16_f32 v73, v66, v67
    v_cvt_pk_bf16_f32 v74, v68, v69
    v_cvt_pk_bf16_f32 v75, v70, v71
    ds_write_b64 v29, v[72:73] offset:512
    ds_write_b64 v29, v[74:75] offset:0
    s_branch L_kj_26
L_kh_25:
    s_nop 5
    v_cvt_pk_bf16_f32 v72, v66, v66
    v_cvt_pk_bf16_f32 v73, v65, v65
    v_cvt_pk_bf16_f32 v74, v65, v64
    v_cvt_pk_bf16_f32 v75, v64, v64
    v_cvt_pk_bf16_f32 v76, v70, v70
    v_cvt_pk_bf16_f32 v77, v70, v70
    v_cvt_pk_bf16_f32 v78, v69, v69
    v_cvt_pk_bf16_f32 v79, v69, v69
    v_cvt_pk_bf16_f32 v80, v69, v69
    v_cvt_pk_bf16_f32 v81, v69, v68
    v_cvt_pk_bf16_f32 v82, v68, v68
    v_cvt_pk_bf16_f32 v83, v68, v68
    ds_write_b128 v29, v[72:75]
    ds_write_b128 v26, v[76:79]
    ds_write_b128 v26, v[80:83] offset:16
L_kj_26:
    ds_write_b32 v42, v62 offset:35840
    ds_write_b64 v41, v[62:63] offset:0
    s_waitcnt vmcnt(4)
    ds_write_b128 v40, a[136:139] offset:464
    ds_write_b64 v40, a[136:137] offset:5112
    ds_write_b64 v40, a[138:139] offset:5120
    ds_write_b128 v40, a[140:143] offset:976
    ds_write_b64 v40, a[140:141] offset:5624
    ds_write_b64 v40, a[142:143] offset:5632
    s_waitcnt lgkmcnt(0)
    s_barrier
    v_add_u32 v88, 4, v30
    ds_read2st64_b32 v[224:225], v30 offset0:0 offset1:1
    ds_read2st64_b32 v[226:227], v30 offset0:2 offset1:3
    ds_read2st64_b32 v[228:229], v30 offset0:4 offset1:5
    ds_read2st64_b32 v[230:231], v30 offset0:6 offset1:7
    ds_read2st64_b32 v[232:233], v88 offset0:0 offset1:1
    ds_read2st64_b32 v[234:235], v88 offset0:2 offset1:3
    ds_read2st64_b32 v[236:237], v88 offset0:4 offset1:5
    ds_read2st64_b32 v[238:239], v88 offset0:6 offset1:7
    ds_read_b128 v[96:99], v43 offset:39616
    ds_read_b128 v[128:131], v44 offset:192
    ds_read_b128 v[100:103], v43 offset:39104
    ds_read_b128 v[132:135], v44 offset:704
    ds_read_b128 v[104:107], v43 offset:38592
    ds_read_b128 v[136:139], v44 offset:1216
    ds_read_b128 v[108:111], v43 offset:38080
    ds_read_b128 v[140:143], v44 offset:1728
    s_waitcnt lgkmcnt(6)
    v_mfma_f32_16x16x32_bf16 v[64:67], v[96:99], v[128:131], 0
    ds_read_b128 v[112:115], v43 offset:37568
    s_waitcnt lgkmcnt(5)
    v_mfma_f32_16x16x32_bf16 v[68:71], v[96:99], v[132:135], 0
    ds_read_b128 v[144:147], v44 offset:2240
    v_mfma_f32_16x16x32_bf16 v[68:71], v[100:103], v[128:131], v[68:71]
    ds_read_b128 v[116:119], v43 offset:37056
    v_mfma_f32_16x16x32_bf16 v[72:75], v[100:103], v[132:135], 0
    ds_read_b128 v[148:151], v44 offset:2752
    s_waitcnt lgkmcnt(6)
    v_mfma_f32_16x16x32_bf16 v[72:75], v[96:99], v[136:139], v[72:75]
    ds_read_b128 v[120:123], v43 offset:36544
    s_mov_b32 s26, 327680
    v_mfma_f32_16x16x32_bf16 v[72:75], v[104:107], v[128:131], v[72:75]
    ds_read_b128 v[152:155], v44 offset:3264
    buffer_load_dwordx4 a[144:147], v39, s[40:43], 0 offen offset:32 sc1
    v_mfma_f32_16x16x32_bf16 v[76:79], v[100:103], v[136:139], 0
    ds_read_b128 v[124:127], v43 offset:36032
    v_alignbit_b32 v232, v232, v224, 16
    v_mfma_f32_16x16x32_bf16 v[76:79], v[104:107], v[132:135], v[76:79]
    ds_read_b128 v[156:159], v44 offset:3776
    v_alignbit_b32 v233, v233, v225, 16
    v_mfma_f32_16x16x32_bf16 v[80:83], v[104:107], v[136:139], 0
    v_alignbit_b32 v234, v234, v226, 16
    v_alignbit_b32 v235, v235, v227, 16
    s_waitcnt lgkmcnt(8)
    v_mfma_f32_16x16x32_bf16 v[76:79], v[96:99], v[140:143], v[76:79]
    v_alignbit_b32 v236, v236, v228, 16
    v_alignbit_b32 v237, v237, v229, 16
    v_alignbit_b32 v238, v238, v230, 16
    v_mfma_f32_16x16x32_bf16 v[76:79], v[108:111], v[128:131], v[76:79]
    ds_read_b128 v[160:163], v43 offset:39552
    v_alignbit_b32 v239, v239, v231, 16
    s_mov_b32 m0, s74
    v_mfma_f32_16x16x32_bf16 v[80:83], v[100:103], v[140:143], v[80:83]
    ds_write_addtid_b32 v240 offset:0
    v_mfma_f32_16x16x32_bf16 v[80:83], v[108:111], v[132:135], v[80:83]
    ds_read_b128 v[192:195], v44 offset:128
    ds_write_addtid_b32 v241 offset:256
    v_mfma_f32_16x16x32_bf16 v[84:87], v[104:107], v[140:143], 0
    ds_read_b128 v[164:167], v43 offset:39040
    ds_write_addtid_b32 v242 offset:512
    v_mfma_f32_16x16x32_bf16 v[84:87], v[108:111], v[136:139], v[84:87]
    ds_write_addtid_b32 v243 offset:768
    v_mfma_f32_16x16x32_bf16 v[88:91], v[108:111], v[140:143], 0
    ds_read_b128 v[196:199], v44 offset:640
    s_waitcnt lgkmcnt(14)
    v_mfma_f32_16x16x32_bf16 v[80:83], v[96:99], v[144:147], v[80:83]
    ds_read_b128 v[168:171], v43 offset:38528
    ds_write_addtid_b32 v244 offset:1024
    v_mfma_f32_16x16x32_bf16 v[80:83], v[112:115], v[128:131], v[80:83]
    ds_write_addtid_b32 v245 offset:1280
    v_mfma_f32_16x16x32_bf16 v[84:87], v[100:103], v[144:147], v[84:87]
    ds_read_b128 v[200:203], v44 offset:1152
    ds_write_addtid_b32 v246 offset:1536
    v_mfma_f32_16x16x32_bf16 v[84:87], v[112:115], v[132:135], v[84:87]
    ds_read_b128 v[172:175], v43 offset:38016
    ds_write_addtid_b32 v247 offset:1792
    v_mfma_f32_16x16x32_bf16 v[88:91], v[104:107], v[144:147], v[88:91]
    ds_write_addtid_b32 v248 offset:4160
    v_mfma_f32_16x16x32_bf16 v[88:91], v[112:115], v[136:139], v[88:91]
    ds_read_b128 v[204:207], v44 offset:1664
    ds_write_addtid_b32 v249 offset:4416
    v_mfma_f32_16x16x32_bf16 v[92:95], v[108:111], v[144:147], 0
    ds_read_b128 v[176:179], v43 offset:37504
    ds_write_addtid_b32 v250 offset:4672
    v_mfma_f32_16x16x32_bf16 v[92:95], v[112:115], v[140:143], v[92:95]
    ds_write_addtid_b32 v251 offset:4928
    s_waitcnt lgkmcnt(15)
    v_mfma_f32_16x16x32_bf16 v[84:87], v[96:99], v[148:151], v[84:87]
    ds_read_b128 v[208:211], v44 offset:2176
    ds_write_addtid_b32 v252 offset:5184
    v_mfma_f32_16x16x32_bf16 v[84:87], v[116:119], v[128:131], v[84:87]
    ds_read_b128 v[180:183], v43 offset:36992
    ds_write_addtid_b32 v253 offset:5440
    v_mfma_f32_16x16x32_bf16 v[88:91], v[100:103], v[148:151], v[88:91]
    ds_write_addtid_b32 v254 offset:5696
    buffer_load_dwordx4 a[148:151], v39, s[40:43], s26 offen offset:32 sc1
    v_mfma_f32_16x16x32_bf16 v[88:91], v[116:119], v[132:135], v[88:91]
    ds_read_b128 v[212:215], v44 offset:2688
    ds_write_addtid_b32 v255 offset:5952
    v_mfma_f32_16x16x32_bf16 v[92:95], v[104:107], v[148:151], v[92:95]
    ds_read_b128 v[184:187], v43 offset:36480
    ds_write_addtid_b32 v240 offset:8316
    v_mfma_f32_16x16x32_bf16 v[92:95], v[116:119], v[136:139], v[92:95]
    ds_write_addtid_b32 v241 offset:8572
    s_waitcnt lgkmcnt(15)
    v_mfma_f32_16x16x32_bf16 v[88:91], v[96:99], v[152:155], v[88:91]
    ds_read_b128 v[216:219], v44 offset:3200
    ds_write_addtid_b32 v242 offset:8828
    v_mfma_f32_16x16x32_bf16 v[88:91], v[120:123], v[128:131], v[88:91]
    ds_read_b128 v[188:191], v43 offset:35968
    ds_write_addtid_b32 v243 offset:9084
    v_mfma_f32_16x16x32_bf16 v[92:95], v[100:103], v[152:155], v[92:95]
    ds_write_addtid_b32 v244 offset:9340
    v_mfma_f32_16x16x32_bf16 v[92:95], v[120:123], v[132:135], v[92:95]
    ds_read_b128 v[220:223], v44 offset:3712
    s_waitcnt lgkmcnt(15)
    v_mfma_f32_16x16x32_bf16 v[92:95], v[96:99], v[156:159], v[92:95]
    ds_write_addtid_b32 v245 offset:9596
    v_mfma_f32_16x16x32_bf16 v[92:95], v[124:127], v[128:131], v[92:95]
    ds_write_addtid_b32 v246 offset:9852
    s_waitcnt lgkmcnt(15)
    v_mfma_f32_16x16x32_bf16 v[64:67], v[160:163], v[192:195], v[64:67]
    ds_write_addtid_b32 v247 offset:10108
    v_mfma_f32_16x16x32_bf16 v[68:71], v[160:163], v[196:199], v[68:71]
    ds_read_b128 v[96:99], v43 offset:39488
    ds_write_addtid_b32 v248 offset:12476
    v_mfma_f32_16x16x32_bf16 v[68:71], v[164:167], v[192:195], v[68:71]
    ds_write_addtid_b32 v249 offset:12732
    v_mfma_f32_16x16x32_bf16 v[72:75], v[164:167], v[196:199], v[72:75]
    ds_read_b128 v[128:131], v44 offset:64
    ds_write_addtid_b32 v250 offset:12988
    v_mfma_f32_16x16x32_bf16 v[72:75], v[160:163], v[200:203], v[72:75]
    ds_write_addtid_b32 v251 offset:13244
    s_mov_b32 s26, 327680
    v_mfma_f32_16x16x32_bf16 v[72:75], v[168:171], v[192:195], v[72:75]
    ds_read_b128 v[100:103], v43 offset:38976
    ds_write_addtid_b32 v252 offset:13500
    v_mfma_f32_16x16x32_bf16 v[76:79], v[164:167], v[200:203], v[76:79]
    ds_write_addtid_b32 v253 offset:13756
    buffer_load_dwordx4 a[152:155], v39, s[40:43], 0 offen offset:64 sc1
    v_mfma_f32_16x16x32_bf16 v[76:79], v[168:171], v[196:199], v[76:79]
    ds_read_b128 v[132:135], v44 offset:576
    ds_write_addtid_b32 v254 offset:14012
    v_mfma_f32_16x16x32_bf16 v[80:83], v[168:171], v[200:203], v[80:83]
    ds_write_addtid_b32 v255 offset:14268
    v_mfma_f32_16x16x32_bf16 v[76:79], v[160:163], v[204:207], v[76:79]
    ds_read_b128 v[104:107], v43 offset:38464
    v_mfma_f32_16x16x32_bf16 v[76:79], v[172:175], v[192:195], v[76:79]
    v_mfma_f32_16x16x32_bf16 v[80:83], v[164:167], v[204:207], v[80:83]
    ds_read_b128 v[136:139], v44 offset:1088
    v_mfma_f32_16x16x32_bf16 v[80:83], v[172:175], v[196:199], v[80:83]
    v_mfma_f32_16x16x32_bf16 v[84:87], v[168:171], v[204:207], v[84:87]
    ds_read_b128 v[108:111], v43 offset:37952
    v_mfma_f32_16x16x32_bf16 v[84:87], v[172:175], v[200:203], v[84:87]
    v_mfma_f32_16x16x32_bf16 v[88:91], v[172:175], v[204:207], v[88:91]
    ds_read_b128 v[140:143], v44 offset:1600
    s_waitcnt lgkmcnt(15)
    v_mfma_f32_16x16x32_bf16 v[80:83], v[160:163], v[208:211], v[80:83]
    v_mfma_f32_16x16x32_bf16 v[80:83], v[176:179], v[192:195], v[80:83]
    ds_read_b128 v[112:115], v43 offset:37440
    v_mfma_f32_16x16x32_bf16 v[84:87], v[164:167], v[208:211], v[84:87]
    v_mfma_f32_16x16x32_bf16 v[84:87], v[176:179], v[196:199], v[84:87]
    ds_read_b128 v[144:147], v44 offset:2112
    v_mfma_f32_16x16x32_bf16 v[88:91], v[168:171], v[208:211], v[88:91]
    v_mfma_f32_16x16x32_bf16 v[88:91], v[176:179], v[200:203], v[88:91]
    ds_read_b128 v[116:119], v43 offset:36928
    v_mfma_f32_16x16x32_bf16 v[92:95], v[172:175], v[208:211], v[92:95]
    buffer_load_dwordx4 a[156:159], v39, s[40:43], s26 offen offset:64 sc1
    v_mfma_f32_16x16x32_bf16 v[92:95], v[176:179], v[204:207], v[92:95]
    ds_read_b128 v[148:151], v44 offset:2624
    v_mfma_f32_16x16x32_bf16 v[84:87], v[160:163], v[212:215], v[84:87]
    ds_write_b32 v42, v62 offset:0
    v_mfma_f32_16x16x32_bf16 v[84:87], v[180:183], v[192:195], v[84:87]
    ds_read_b128 v[120:123], v43 offset:36416
    v_mfma_f32_16x16x32_bf16 v[88:91], v[164:167], v[212:215], v[88:91]
    ds_write_b64 v41, v[62:63] offset:28288
    v_mfma_f32_16x16x32_bf16 v[88:91], v[180:183], v[196:199], v[88:91]
    ds_read_b128 v[152:155], v44 offset:3136
    s_waitcnt vmcnt(2)
    v_mfma_f32_16x16x32_bf16 v[92:95], v[168:171], v[212:215], v[92:95]
    ds_write_b128 v40, a[144:147] offset:28752
    v_mfma_f32_16x16x32_bf16 v[92:95], v[180:183], v[200:203], v[92:95]
    ds_read_b128 v[124:127], v43 offset:35904
    v_mfma_f32_16x16x32_bf16 v[88:91], v[160:163], v[216:219], v[88:91]
    ds_write_b64 v40, a[144:145] offset:33400
    v_mfma_f32_16x16x32_bf16 v[88:91], v[184:187], v[192:195], v[88:91]
    ds_read_b128 v[156:159], v44 offset:3648
    v_mfma_f32_16x16x32_bf16 v[92:95], v[164:167], v[216:219], v[92:95]
    ds_write_b64 v40, a[146:147] offset:33408
    v_mfma_f32_16x16x32_bf16 v[92:95], v[184:187], v[196:199], v[92:95]
    ds_write_b128 v40, a[148:151] offset:29264
    v_mfma_f32_16x16x32_bf16 v[92:95], v[160:163], v[220:223], v[92:95]
    ds_write_b64 v40, a[148:149] offset:33912
    v_mfma_f32_16x16x32_bf16 v[92:95], v[188:191], v[192:195], v[92:95]
    s_waitcnt lgkmcnt(15)
    v_mfma_f32_16x16x32_bf16 v[64:67], v[96:99], v[128:131], v[64:67]
    ds_write_b64 v40, a[150:151] offset:33920
    v_mfma_f32_16x16x32_bf16 v[68:71], v[96:99], v[132:135], v[68:71]
    ds_read_b128 v[160:163], v43 offset:39424
    v_mfma_f32_16x16x32_bf16 v[68:71], v[100:103], v[128:131], v[68:71]
    v_mfma_f32_16x16x32_bf16 v[72:75], v[100:103], v[132:135], v[72:75]
    ds_read_b128 v[192:195], v44 offset:0
    s_mov_b32 s25, 0
    v_mfma_f32_16x16x32_bf16 v[72:75], v[96:99], v[136:139], v[72:75]
    s_waitcnt lgkmcnt(2)
    s_barrier
    buffer_load_dwordx4 a[176:179], v9, s[40:43], s25 offen offset:0 sc1
    v_mfma_f32_16x16x32_bf16 v[72:75], v[104:107], v[128:131], v[72:75]
    ds_read_b128 v[164:167], v43 offset:38912
    v_mfma_f32_16x16x32_bf16 v[76:79], v[100:103], v[136:139], v[76:79]
    v_mfma_f32_16x16x32_bf16 v[76:79], v[104:107], v[132:135], v[76:79]
    ds_read_b128 v[196:199], v44 offset:512
    v_mfma_f32_16x16x32_bf16 v[80:83], v[104:107], v[136:139], v[80:83]
    s_mov_b32 s25, 40960
    v_mfma_f32_16x16x32_bf16 v[76:79], v[96:99], v[140:143], v[76:79]
    ds_read_b128 v[168:171], v43 offset:38400
    buffer_load_dwordx4 a[180:183], v8, s[40:43], s25 offen offset:0 sc1
    v_mfma_f32_16x16x32_bf16 v[76:79], v[108:111], v[128:131], v[76:79]
    v_mfma_f32_16x16x32_bf16 v[80:83], v[100:103], v[140:143], v[80:83]
    ds_read_b128 v[200:203], v44 offset:1024
    v_mfma_f32_16x16x32_bf16 v[80:83], v[108:111], v[132:135], v[80:83]
    v_mfma_f32_16x16x32_bf16 v[84:87], v[104:107], v[140:143], v[84:87]
    ds_read_b128 v[172:175], v43 offset:37888
    buffer_load_dwordx4 a[184:187], v8, s[40:43], s25 offen offset:1024 sc1
    v_mfma_f32_16x16x32_bf16 v[84:87], v[108:111], v[136:139], v[84:87]
    v_mfma_f32_16x16x32_bf16 v[88:91], v[108:111], v[140:143], v[88:91]
    ds_read_b128 v[204:207], v44 offset:1536
    v_mfma_f32_16x16x32_bf16 v[80:83], v[96:99], v[144:147], v[80:83]
    v_mfma_f32_16x16x32_bf16 v[80:83], v[112:115], v[128:131], v[80:83]
    ds_read_b128 v[176:179], v43 offset:37376
    v_mfma_f32_16x16x32_bf16 v[84:87], v[100:103], v[144:147], v[84:87]
    buffer_load_dwordx4 a[188:191], v8, s[40:43], s25 offen offset:2048 sc1
    v_mfma_f32_16x16x32_bf16 v[84:87], v[112:115], v[132:135], v[84:87]
    ds_read_b128 v[208:211], v44 offset:2048
    v_mfma_f32_16x16x32_bf16 v[88:91], v[104:107], v[144:147], v[88:91]
    v_mfma_f32_16x16x32_bf16 v[88:91], v[112:115], v[136:139], v[88:91]
    ds_read_b128 v[180:183], v43 offset:36864
    v_mfma_f32_16x16x32_bf16 v[92:95], v[108:111], v[144:147], v[92:95]
    buffer_load_dwordx4 a[192:195], v8, s[40:43], s25 offen offset:3072 sc1
    v_mfma_f32_16x16x32_bf16 v[92:95], v[112:115], v[140:143], v[92:95]
    ds_read_b128 v[212:215], v44 offset:2560
    v_mfma_f32_16x16x32_bf16 v[84:87], v[96:99], v[148:151], v[84:87]
    v_mfma_f32_16x16x32_bf16 v[84:87], v[116:119], v[128:131], v[84:87]
    ds_read_b128 v[184:187], v43 offset:36352
    v_mfma_f32_16x16x32_bf16 v[88:91], v[100:103], v[148:151], v[88:91]
    v_mfma_f32_16x16x32_bf16 v[88:91], v[116:119], v[132:135], v[88:91]
    ds_read_b128 v[216:219], v44 offset:3072
    buffer_load_dwordx4 a[196:199], v9, s[40:43], s25 offen offset:0 sc1
    v_mfma_f32_16x16x32_bf16 v[92:95], v[104:107], v[148:151], v[92:95]
    v_mfma_f32_16x16x32_bf16 v[92:95], v[116:119], v[136:139], v[92:95]
    ds_read_b128 v[188:191], v43 offset:35840
    v_mfma_f32_16x16x32_bf16 v[88:91], v[96:99], v[152:155], v[88:91]
    s_mov_b32 s25, 81920
    v_mfma_f32_16x16x32_bf16 v[88:91], v[120:123], v[128:131], v[88:91]
    ds_read_b128 v[220:223], v44 offset:3584
    buffer_load_dwordx4 a[200:203], v8, s[40:43], s25 offen offset:0 sc1
    v_mfma_f32_16x16x32_bf16 v[92:95], v[100:103], v[152:155], v[92:95]
    v_mfma_f32_16x16x32_bf16 v[92:95], v[120:123], v[132:135], v[92:95]
    v_mfma_f32_16x16x32_bf16 v[92:95], v[96:99], v[156:159], v[92:95]
    v_mfma_f32_16x16x32_bf16 v[92:95], v[124:127], v[128:131], v[92:95]
    s_waitcnt lgkmcnt(8)
    v_mfma_f32_16x16x32_bf16 v[64:67], v[160:163], v[192:195], v[64:67]
    s_mul_i32 m0, s64, 8448
    buffer_load_dwordx4 a[204:207], v8, s[40:43], s25 offen offset:1024 sc1
    v_mfma_f32_16x16x32_bf16 v[68:71], v[160:163], v[196:199], v[68:71]
    v_mfma_f32_16x16x32_bf16 v[68:71], v[164:167], v[192:195], v[68:71]
    v_mfma_f32_16x16x32_bf16 v[72:75], v[160:163], v[200:203], v[72:75]
    ds_read_b128 v[96:99], v43 offset:3776
    v_mfma_f32_16x16x32_bf16 v[72:75], v[164:167], v[196:199], v[72:75]
    s_nop 0
    ds_write_addtid_b32 v64 offset:0
    v_mfma_f32_16x16x32_bf16 v[72:75], v[168:171], v[192:195], v[72:75]
    ds_read_b128 v[128:131], v44 offset:28480
    ds_write_addtid_b32 v65 offset:264
    v_mfma_f32_16x16x32_bf16 v[76:79], v[160:163], v[204:207], v[76:79]
    ds_write_addtid_b32 v66 offset:528
    buffer_load_dwordx4 a[208:211], v8, s[40:43], s25 offen offset:2048 sc1
    v_mfma_f32_16x16x32_bf16 v[76:79], v[164:167], v[200:203], v[76:79]
    ds_read_b128 v[100:103], v43 offset:3264
    ds_write_addtid_b32 v67 offset:792
    v_mfma_f32_16x16x32_bf16 v[76:79], v[168:171], v[196:199], v[76:79]
    ds_write_addtid_b32 v68 offset:1056
    v_mfma_f32_16x16x32_bf16 v[76:79], v[172:175], v[192:195], v[76:79]
    ds_read_b128 v[132:135], v44 offset:28992
    s_waitcnt lgkmcnt(9)
    v_mfma_f32_16x16x32_bf16 v[80:83], v[160:163], v[208:211], v[80:83]
    ds_write_addtid_b32 v69 offset:1320
    buffer_load_dwordx4 a[212:215], v8, s[40:43], s25 offen offset:3072 sc1
    v_mfma_f32_16x16x32_bf16 v[80:83], v[164:167], v[204:207], v[80:83]
    ds_read_b128 v[104:107], v43 offset:2752
    ds_write_addtid_b32 v70 offset:1584
    v_mfma_f32_16x16x32_bf16 v[80:83], v[168:171], v[200:203], v[80:83]
    ds_read_b128 v[136:139], v44 offset:29504
    ds_write_addtid_b32 v71 offset:1848
    v_mfma_f32_16x16x32_bf16 v[80:83], v[172:175], v[196:199], v[80:83]
    ds_write_addtid_b32 v72 offset:2112
    v_mfma_f32_16x16x32_bf16 v[80:83], v[176:179], v[192:195], v[80:83]
    ds_read_b128 v[108:111], v43 offset:2240
    ds_write_addtid_b32 v73 offset:2376
    v_mfma_f32_16x16x32_bf16 v[84:87], v[160:163], v[212:215], v[84:87]
    ds_write_addtid_b32 v74 offset:2640
    buffer_load_dwordx4 a[216:219], v9, s[40:43], s25 offen offset:0 sc1
    v_mfma_f32_16x16x32_bf16 v[84:87], v[164:167], v[208:211], v[84:87]
    ds_read_b128 v[140:143], v44 offset:30016
    ds_write_addtid_b32 v75 offset:2904
    v_mfma_f32_16x16x32_bf16 v[84:87], v[168:171], v[204:207], v[84:87]
    ds_write_addtid_b32 v76 offset:3168
    s_mov_b32 s25, 122880
    v_mfma_f32_16x16x32_bf16 v[84:87], v[172:175], v[200:203], v[84:87]
    ds_read_b128 v[112:115], v43 offset:1728
    ds_write_addtid_b32 v77 offset:3432
    v_mfma_f32_16x16x32_bf16 v[84:87], v[176:179], v[196:199], v[84:87]
    ds_write_addtid_b32 v78 offset:3696
    buffer_load_dwordx4 a[220:223], v8, s[40:43], s25 offen offset:0 sc1
    v_mfma_f32_16x16x32_bf16 v[84:87], v[180:183], v[192:195], v[84:87]
    ds_read_b128 v[144:147], v44 offset:30528
    ds_write_addtid_b32 v79 offset:3960
    v_mfma_f32_16x16x32_bf16 v[88:91], v[160:163], v[216:219], v[88:91]
    ds_read_b128 v[116:119], v43 offset:1216
    ds_write_addtid_b32 v80 offset:4224
    v_mfma_f32_16x16x32_bf16 v[88:91], v[164:167], v[212:215], v[88:91]
    ds_write_addtid_b32 v81 offset:4488
    v_mfma_f32_16x16x32_bf16 v[88:91], v[168:171], v[208:211], v[88:91]
    ds_read_b128 v[148:151], v44 offset:31040
    ds_write_addtid_b32 v82 offset:4752
    v_mfma_f32_16x16x32_bf16 v[88:91], v[172:175], v[204:207], v[88:91]
    ds_write_addtid_b32 v83 offset:5016
    buffer_load_dwordx4 a[224:227], v8, s[40:43], s25 offen offset:1024 sc1
    v_mfma_f32_16x16x32_bf16 v[88:91], v[176:179], v[200:203], v[88:91]
    ds_read_b128 v[120:123], v43 offset:704
    ds_write_addtid_b32 v84 offset:5280
    v_mfma_f32_16x16x32_bf16 v[88:91], v[180:183], v[196:199], v[88:91]
    ds_write_addtid_b32 v85 offset:5544
    v_mfma_f32_16x16x32_bf16 v[88:91], v[184:187], v[192:195], v[88:91]
    ds_read_b128 v[152:155], v44 offset:31552
    ds_write_addtid_b32 v86 offset:5808
    v_mfma_f32_16x16x32_bf16 v[92:95], v[160:163], v[220:223], v[92:95]
    ds_write_addtid_b32 v87 offset:6072
    buffer_load_dwordx4 a[228:231], v8, s[40:43], s25 offen offset:2048 sc1
    v_mfma_f32_16x16x32_bf16 v[92:95], v[164:167], v[216:219], v[92:95]
    ds_read_b128 v[124:127], v43 offset:192
    v_mfma_f32_16x16x32_bf16 v[92:95], v[168:171], v[212:215], v[92:95]
    v_mfma_f32_16x16x32_bf16 v[92:95], v[172:175], v[208:211], v[92:95]
    ds_read_b128 v[156:159], v44 offset:32064
    ds_write_addtid_b32 v88 offset:6336
    v_mfma_f32_16x16x32_bf16 v[92:95], v[176:179], v[204:207], v[92:95]
    ds_write_addtid_b32 v89 offset:6600
    buffer_load_dwordx4 a[232:235], v8, s[40:43], s25 offen offset:3072 sc1
    v_mfma_f32_16x16x32_bf16 v[92:95], v[180:183], v[200:203], v[92:95]
    ds_write_addtid_b32 v90 offset:6864
    v_mfma_f32_16x16x32_bf16 v[92:95], v[184:187], v[196:199], v[92:95]
    ds_write_addtid_b32 v91 offset:7128
    v_mfma_f32_16x16x32_bf16 v[92:95], v[188:191], v[192:195], v[92:95]
    s_waitcnt lgkmcnt(15)
    v_mfma_f32_16x16x32_bf16 v[64:67], v[96:99], v[128:131], 0
    buffer_load_dwordx4 a[236:239], v9, s[40:43], s25 offen offset:0 sc1
    v_mfma_f32_16x16x32_bf16 v[68:71], v[96:99], v[132:135], 0
    ds_read_b128 v[160:163], v43 offset:3712
    v_mfma_f32_16x16x32_bf16 v[68:71], v[100:103], v[128:131], v[68:71]
    v_mfma_f32_16x16x32_bf16 v[72:75], v[100:103], v[132:135], 0
    ds_read_b128 v[192:195], v44 offset:28416
    ds_write_addtid_b32 v92 offset:7392
    v_mfma_f32_16x16x32_bf16 v[72:75], v[96:99], v[136:139], v[72:75]
    ds_write_addtid_b32 v93 offset:7656
    s_mov_b32 s25, 163840
    v_mfma_f32_16x16x32_bf16 v[72:75], v[104:107], v[128:131], v[72:75]
    ds_read_b128 v[164:167], v43 offset:3200
    ds_write_addtid_b32 v94 offset:7920
    v_mfma_f32_16x16x32_bf16 v[76:79], v[100:103], v[136:139], 0
    ds_write_addtid_b32 v95 offset:8184
    buffer_load_dwordx4 a[240:243], v8, s[40:43], s25 offen offset:0 sc1
    v_mfma_f32_16x16x32_bf16 v[76:79], v[104:107], v[132:135], v[76:79]
    ds_read_b128 v[196:199], v44 offset:28928
    v_mfma_f32_16x16x32_bf16 v[80:83], v[104:107], v[136:139], 0
    v_mfma_f32_16x16x32_bf16 v[76:79], v[96:99], v[140:143], v[76:79]
    ds_read_b128 v[168:171], v43 offset:2688
    buffer_load_dwordx4 a[244:247], v8, s[40:43], s25 offen offset:1024 sc1
    v_mfma_f32_16x16x32_bf16 v[76:79], v[108:111], v[128:131], v[76:79]
    s_waitcnt lgkmcnt(2)
    s_barrier
    ds_read_b64 v[24:25], v45 offset:0
    v_mfma_f32_16x16x32_bf16 v[80:83], v[100:103], v[140:143], v[80:83]
    ds_read_b128 v[200:203], v44 offset:29440
    ds_read_b64 v[26:27], v45 offset:128
    v_mfma_f32_16x16x32_bf16 v[80:83], v[108:111], v[132:135], v[80:83]
    ds_read_b64 v[28:29], v45 offset:8
    ds_read_b64 v[30:31], v45 offset:136
    v_mfma_f32_16x16x32_bf16 v[84:87], v[104:107], v[140:143], 0
    ds_read_b128 v[172:175], v43 offset:2176
    ds_read_b64 v[32:33], v45 offset:8448
    v_mfma_f32_16x16x32_bf16 v[84:87], v[108:111], v[136:139], v[84:87]
    ds_read_b64 v[34:35], v45 offset:8576
    buffer_load_dwordx4 a[248:251], v8, s[40:43], s25 offen offset:2048 sc1
    v_mfma_f32_16x16x32_bf16 v[88:91], v[108:111], v[140:143], 0
    ds_read_b128 v[204:207], v44 offset:29952
    v_mfma_f32_16x16x32_bf16 v[80:83], v[96:99], v[144:147], v[80:83]
    ds_read_b64 v[36:37], v45 offset:8456
    ds_read_b64 v[38:39], v45 offset:8584
    v_mfma_f32_16x16x32_bf16 v[80:83], v[112:115], v[128:131], v[80:83]
    ds_read_b128 v[176:179], v43 offset:1664
    s_lshl_b32 s24, s69, 2
    s_add_u32 s24, s24, s64
    v_mfma_f32_16x16x32_bf16 v[84:87], v[100:103], v[144:147], v[84:87]
    s_lshl_b32 s24, s24, 11
    s_add_u32 s24, s24, 8650752
    s_mov_b32 m0, s74
    v_mfma_f32_16x16x32_bf16 v[84:87], v[112:115], v[132:135], v[84:87]
    ds_read_b128 v[208:211], v44 offset:30464
    ds_write_addtid_b32 v224 offset:35840
    v_mfma_f32_16x16x32_bf16 v[88:91], v[104:107], v[144:147], v[88:91]
    ds_write_addtid_b32 v225 offset:36096
    buffer_load_dwordx4 a[252:255], v8, s[40:43], s25 offen offset:3072 sc1
    v_mfma_f32_16x16x32_bf16 v[88:91], v[112:115], v[136:139], v[88:91]
    ds_read_b128 v[180:183], v43 offset:1152
    ds_write_addtid_b32 v226 offset:36352
    v_mfma_f32_16x16x32_bf16 v[92:95], v[108:111], v[144:147], 0
    ds_write_addtid_b32 v227 offset:36608
    s_mov_b32 s25, 245760
    s_waitcnt lgkmcnt(7)
    v_mfma_f32_16x16x32_bf16 v[92:95], v[112:115], v[140:143], v[92:95]
    ds_read_b128 v[212:215], v44 offset:30976
    ds_write_addtid_b32 v228 offset:36864
    v_mfma_f32_16x16x32_bf16 v[84:87], v[96:99], v[148:151], v[84:87]
    buffer_load_dwordx4 a[0:3], v8, s[40:43], s25 offen offset:0 sc1
    v_add_f32 v24, v24, v32
    v_mfma_f32_16x16x32_bf16 v[84:87], v[116:119], v[128:131], v[84:87]
    ds_read_b128 v[184:187], v43 offset:640
    ds_write_addtid_b32 v229 offset:37120
    v_mfma_f32_16x16x32_bf16 v[88:91], v[100:103], v[148:151], v[88:91]
    v_add_f32_e64 v25, v25, v33
    v_mfma_f32_16x16x32_bf16 v[88:91], v[116:119], v[132:135], v[88:91]
    ds_read_b128 v[216:219], v44 offset:31488
    ds_write_addtid_b32 v230 offset:37376
    v_mfma_f32_16x16x32_bf16 v[92:95], v[104:107], v[148:151], v[92:95]
    buffer_load_dwordx4 a[4:7], v8, s[40:43], s25 offen offset:1024 sc1
    v_add_f32_e64 v26, v26, v34
    v_mfma_f32_16x16x32_bf16 v[92:95], v[116:119], v[136:139], v[92:95]
    ds_read_b128 v[188:191], v43 offset:128
    ds_write_addtid_b32 v231 offset:37632
    v_mfma_f32_16x16x32_bf16 v[88:91], v[96:99], v[152:155], v[88:91]
    v_add_f32_e64 v27, v27, v35
    v_mfma_f32_16x16x32_bf16 v[88:91], v[120:123], v[128:131], v[88:91]
    ds_read_b128 v[220:223], v44 offset:32000
    ds_write_addtid_b32 v232 offset:40000
    v_mfma_f32_16x16x32_bf16 v[92:95], v[100:103], v[152:155], v[92:95]
    buffer_load_dwordx4 a[8:11], v8, s[40:43], s25 offen offset:2048 sc1
    v_add_f32_e64 v28, v28, v36
    v_mfma_f32_16x16x32_bf16 v[92:95], v[120:123], v[132:135], v[92:95]
    ds_write_addtid_b32 v233 offset:40256
    v_add_f32_e64 v29, v29, v37
    v_mfma_f32_16x16x32_bf16 v[92:95], v[96:99], v[156:159], v[92:95]
    ds_write_addtid_b32 v234 offset:40512
    v_add_f32_e64 v30, v30, v38
    v_mfma_f32_16x16x32_bf16 v[92:95], v[124:127], v[128:131], v[92:95]
    ds_write_addtid_b32 v235 offset:40768
    v_mfma_f32_16x16x32_bf16 v[64:67], v[160:163], v[192:195], v[64:67]
    v_add_f32_e64 v31, v31, v39
    v_mfma_f32_16x16x32_bf16 v[68:71], v[160:163], v[196:199], v[68:71]
    ds_read_b128 v[96:99], v43 offset:3648
    ds_write_addtid_b32 v236 offset:41024
    v_mfma_f32_16x16x32_bf16 v[68:71], v[164:167], v[192:195], v[68:71]
    buffer_load_dwordx4 a[12:15], v8, s[40:43], s25 offen offset:3072 sc1
    v_cvt_pk_bf16_f32 v48, v24, v26
    v_mfma_f32_16x16x32_bf16 v[72:75], v[164:167], v[196:199], v[72:75]
    ds_read_b128 v[128:131], v44 offset:28352
    ds_write_addtid_b32 v237 offset:41280
    v_mfma_f32_16x16x32_bf16 v[72:75], v[160:163], v[200:203], v[72:75]
    v_cvt_pk_bf16_f32 v49, v28, v30
    v_mfma_f32_16x16x32_bf16 v[72:75], v[168:171], v[192:195], v[72:75]
    ds_read_b128 v[100:103], v43 offset:3136
    ds_write_addtid_b32 v238 offset:41536
    v_mfma_f32_16x16x32_bf16 v[76:79], v[164:167], v[200:203], v[76:79]
    buffer_load_dwordx4 a[16:19], v9, s[40:43], s25 offen offset:0 sc1
    v_cvt_pk_bf16_f32 v50, v25, v27
    v_mfma_f32_16x16x32_bf16 v[76:79], v[168:171], v[196:199], v[76:79]
    ds_read_b128 v[132:135], v44 offset:28864
    ds_write_addtid_b32 v239 offset:41792
    v_mfma_f32_16x16x32_bf16 v[80:83], v[168:171], v[200:203], v[80:83]
    v_cvt_pk_bf16_f32 v51, v29, v31
    v_mfma_f32_16x16x32_bf16 v[76:79], v[160:163], v[204:207], v[76:79]
    ds_read_b128 v[104:107], v43 offset:2624
    ds_read_b64 v[24:25], v45 offset:2112
    v_mfma_f32_16x16x32_bf16 v[76:79], v[172:175], v[192:195], v[76:79]
    ds_read_b64 v[26:27], v45 offset:2240
    s_mov_b32 s25, 286720
    v_mfma_f32_16x16x32_bf16 v[80:83], v[164:167], v[204:207], v[80:83]
    ds_read_b128 v[136:139], v44 offset:29376
    ds_read_b64 v[28:29], v45 offset:2120
    v_mfma_f32_16x16x32_bf16 v[80:83], v[172:175], v[196:199], v[80:83]
    ds_read_b64 v[30:31], v45 offset:2248
    buffer_load_dwordx4 a[20:23], v8, s[40:43], s25 offen offset:0 sc1
    v_mfma_f32_16x16x32_bf16 v[84:87], v[168:171], v[204:207], v[84:87]
    ds_read_b128 v[108:111], v43 offset:2112
    ds_read_b64 v[32:33], v45 offset:10560
    v_mfma_f32_16x16x32_bf16 v[84:87], v[172:175], v[200:203], v[84:87]
    ds_read_b64 v[34:35], v45 offset:10688
    buffer_load_dwordx4 a[24:27], v8, s[40:43], s25 offen offset:1024 sc1
    v_mfma_f32_16x16x32_bf16 v[88:91], v[172:175], v[204:207], v[88:91]
    ds_read_b128 v[140:143], v44 offset:29888
    s_waitcnt lgkmcnt(15)
    v_mfma_f32_16x16x32_bf16 v[80:83], v[160:163], v[208:211], v[80:83]
    ds_read_b64 v[36:37], v45 offset:10568
    ds_read_b64 v[38:39], v45 offset:10696
    v_mfma_f32_16x16x32_bf16 v[80:83], v[176:179], v[192:195], v[80:83]
    ds_read_b128 v[112:115], v43 offset:1600
    buffer_store_dwordx4 v[48:51], v2, s[40:43], s24 offen offset:0 sc1
    v_mfma_f32_16x16x32_bf16 v[84:87], v[164:167], v[208:211], v[84:87]
    ds_write_addtid_b32 v224 offset:44156
    v_mfma_f32_16x16x32_bf16 v[84:87], v[176:179], v[196:199], v[84:87]
    ds_read_b128 v[144:147], v44 offset:30400
    ds_write_addtid_b32 v225 offset:44412
    v_mfma_f32_16x16x32_bf16 v[88:91], v[168:171], v[208:211], v[88:91]
    ds_write_addtid_b32 v226 offset:44668
    buffer_load_dwordx4 a[28:31], v8, s[40:43], s25 offen offset:2048 sc1
    v_mfma_f32_16x16x32_bf16 v[88:91], v[176:179], v[200:203], v[88:91]
    ds_read_b128 v[116:119], v43 offset:1088
    ds_write_addtid_b32 v227 offset:44924
    v_mfma_f32_16x16x32_bf16 v[92:95], v[172:175], v[208:211], v[92:95]
    ds_write_addtid_b32 v228 offset:45180
    s_waitcnt lgkmcnt(8)
    v_mfma_f32_16x16x32_bf16 v[92:95], v[176:179], v[204:207], v[92:95]
    ds_read_b128 v[148:151], v44 offset:30912
    ds_write_addtid_b32 v229 offset:45436
    v_mfma_f32_16x16x32_bf16 v[84:87], v[160:163], v[212:215], v[84:87]
    buffer_load_dwordx4 a[32:35], v8, s[40:43], s25 offen offset:3072 sc1
    v_add_f32_e64 v24, v24, v32
    v_mfma_f32_16x16x32_bf16 v[84:87], v[180:183], v[192:195], v[84:87]
    ds_read_b128 v[120:123], v43 offset:576
    ds_write_addtid_b32 v230 offset:45692
    v_mfma_f32_16x16x32_bf16 v[88:91], v[164:167], v[212:215], v[88:91]
    v_add_f32_e64 v25, v25, v33
    v_mfma_f32_16x16x32_bf16 v[88:91], v[180:183], v[196:199], v[88:91]
    ds_read_b128 v[152:155], v44 offset:31424
    ds_write_addtid_b32 v231 offset:45948
    v_mfma_f32_16x16x32_bf16 v[92:95], v[168:171], v[212:215], v[92:95]
    buffer_load_dwordx4 a[36:39], v9, s[40:43], s25 offen offset:0 sc1
    v_add_f32_e64 v26, v26, v34
    v_mfma_f32_16x16x32_bf16 v[92:95], v[180:183], v[200:203], v[92:95]
    ds_read_b128 v[124:127], v43 offset:64
    ds_write_addtid_b32 v232 offset:48316
    v_mfma_f32_16x16x32_bf16 v[88:91], v[160:163], v[216:219], v[88:91]
    v_add_f32_e64 v27, v27, v35
    v_mfma_f32_16x16x32_bf16 v[88:91], v[184:187], v[192:195], v[88:91]
    ds_read_b128 v[156:159], v44 offset:31936
    ds_write_addtid_b32 v233 offset:48572
    v_mfma_f32_16x16x32_bf16 v[92:95], v[164:167], v[216:219], v[92:95]
    s_mov_b32 s25, 327680
    v_add_f32_e64 v28, v28, v36
    v_mfma_f32_16x16x32_bf16 v[92:95], v[184:187], v[196:199], v[92:95]
    ds_write_addtid_b32 v234 offset:48828
    buffer_load_dwordx4 a[40:43], v8, s[40:43], s25 offen offset:0 sc1
    v_mfma_f32_16x16x32_bf16 v[92:95], v[160:163], v[220:223], v[92:95]
    v_add_f32_e64 v29, v29, v37
    v_mfma_f32_16x16x32_bf16 v[92:95], v[188:191], v[192:195], v[92:95]
    ds_write_addtid_b32 v235 offset:49084
    v_mfma_f32_16x16x32_bf16 v[64:67], v[96:99], v[128:131], v[64:67]
    v_add_f32_e64 v30, v30, v38
    v_mfma_f32_16x16x32_bf16 v[68:71], v[96:99], v[132:135], v[68:71]
    ds_read_b128 v[160:163], v43 offset:3584
    ds_write_addtid_b32 v236 offset:49340
    v_mfma_f32_16x16x32_bf16 v[68:71], v[100:103], v[128:131], v[68:71]
    buffer_load_dwordx4 a[44:47], v8, s[40:43], s25 offen offset:1024 sc1
    v_add_f32_e64 v31, v31, v39
    v_mfma_f32_16x16x32_bf16 v[72:75], v[100:103], v[132:135], v[72:75]
    ds_read_b128 v[192:195], v44 offset:28288
    ds_write_addtid_b32 v237 offset:49596
    v_mfma_f32_16x16x32_bf16 v[72:75], v[96:99], v[136:139], v[72:75]
    v_cvt_pk_bf16_f32 v52, v24, v26
    v_mfma_f32_16x16x32_bf16 v[72:75], v[104:107], v[128:131], v[72:75]
    ds_read_b128 v[164:167], v43 offset:3072
    ds_write_addtid_b32 v238 offset:49852
    v_mfma_f32_16x16x32_bf16 v[76:79], v[100:103], v[136:139], v[76:79]
    buffer_load_dwordx4 a[48:51], v8, s[40:43], s25 offen offset:2048 sc1
    v_cvt_pk_bf16_f32 v53, v28, v30
    v_mfma_f32_16x16x32_bf16 v[76:79], v[104:107], v[132:135], v[76:79]
    ds_read_b128 v[196:199], v44 offset:28800
    ds_write_addtid_b32 v239 offset:50108
    v_mfma_f32_16x16x32_bf16 v[80:83], v[104:107], v[136:139], v[80:83]
    v_cvt_pk_bf16_f32 v54, v25, v27
    v_cvt_pk_bf16_f32 v55, v29, v31
    v_mfma_f32_16x16x32_bf16 v[76:79], v[96:99], v[140:143], v[76:79]
    ds_read_b128 v[168:171], v43 offset:2560
    buffer_store_dwordx4 v[52:55], v2, s[40:43], s24 offen offset:1024 sc1
    v_mfma_f32_16x16x32_bf16 v[76:79], v[108:111], v[128:131], v[76:79]
    s_waitcnt vmcnt(35)
    buffer_load_dwordx4 a[52:55], v8, s[40:43], s25 offen offset:3072 sc1
    v_mfma_f32_16x16x32_bf16 v[80:83], v[100:103], v[140:143], v[80:83]
    ds_read_b128 v[200:203], v44 offset:29312
    v_mfma_f32_16x16x32_bf16 v[80:83], v[108:111], v[132:135], v[80:83]
    ds_write_b128 v40, a[152:155] offset:464
    v_mfma_f32_16x16x32_bf16 v[84:87], v[104:107], v[140:143], v[84:87]
    ds_read_b128 v[172:175], v43 offset:2048
    v_mfma_f32_16x16x32_bf16 v[84:87], v[108:111], v[136:139], v[84:87]
    ds_write_b64 v40, a[152:153] offset:5112
    v_mfma_f32_16x16x32_bf16 v[88:91], v[108:111], v[140:143], v[88:91]
    ds_read_b128 v[204:207], v44 offset:29824
    s_waitcnt lgkmcnt(15)
    v_mfma_f32_16x16x32_bf16 v[80:83], v[96:99], v[144:147], v[80:83]
    ds_write_b64 v40, a[154:155] offset:5120
    v_mfma_f32_16x16x32_bf16 v[80:83], v[112:115], v[128:131], v[80:83]
    ds_read_b128 v[176:179], v43 offset:1536
    buffer_load_dwordx4 a[56:59], v9, s[40:43], s25 offen offset:0 sc1
    v_mfma_f32_16x16x32_bf16 v[84:87], v[100:103], v[144:147], v[84:87]
    ds_write_b128 v40, a[156:159] offset:976
    v_mfma_f32_16x16x32_bf16 v[84:87], v[112:115], v[132:135], v[84:87]
    ds_read_b128 v[208:211], v44 offset:30336
    s_mov_b32 s25, 368640
    v_mfma_f32_16x16x32_bf16 v[88:91], v[104:107], v[144:147], v[88:91]
    ds_write_b64 v40, a[156:157] offset:5624
    v_mfma_f32_16x16x32_bf16 v[88:91], v[112:115], v[136:139], v[88:91]
    ds_read_b128 v[180:183], v43 offset:1024
    buffer_load_dwordx4 a[60:63], v8, s[40:43], s25 offen offset:0 sc1
    v_mfma_f32_16x16x32_bf16 v[92:95], v[108:111], v[144:147], v[92:95]
    ds_write_b64 v40, a[158:159] offset:5632
    v_mfma_f32_16x16x32_bf16 v[92:95], v[112:115], v[140:143], v[92:95]
    ds_read_b128 v[212:215], v44 offset:30848
    v_mfma_f32_16x16x32_bf16 v[84:87], v[96:99], v[148:151], v[84:87]
    buffer_load_dwordx4 a[64:67], v8, s[40:43], s25 offen offset:1024 sc1
    v_mfma_f32_16x16x32_bf16 v[84:87], v[116:119], v[128:131], v[84:87]
    ds_read_b128 v[184:187], v43 offset:512
    v_mfma_f32_16x16x32_bf16 v[88:91], v[100:103], v[148:151], v[88:91]
    s_waitcnt lgkmcnt(2)
    s_barrier
    v_mfma_f32_16x16x32_bf16 v[88:91], v[116:119], v[132:135], v[88:91]
    ds_read_b128 v[216:219], v44 offset:31360
    v_mfma_f32_16x16x32_bf16 v[92:95], v[104:107], v[148:151], v[92:95]
    buffer_load_dwordx4 a[68:71], v8, s[40:43], s25 offen offset:2048 sc1
    v_mfma_f32_16x16x32_bf16 v[92:95], v[116:119], v[136:139], v[92:95]
    ds_read_b128 v[188:191], v43 offset:0
    v_mfma_f32_16x16x32_bf16 v[88:91], v[96:99], v[152:155], v[88:91]
    v_mfma_f32_16x16x32_bf16 v[88:91], v[120:123], v[128:131], v[88:91]
    ds_read_b128 v[220:223], v44 offset:31872
    v_mfma_f32_16x16x32_bf16 v[92:95], v[100:103], v[152:155], v[92:95]
    v_mfma_f32_16x16x32_bf16 v[92:95], v[120:123], v[132:135], v[92:95]
    buffer_load_dwordx4 a[72:75], v8, s[40:43], s25 offen offset:3072 sc1
    v_mfma_f32_16x16x32_bf16 v[92:95], v[96:99], v[156:159], v[92:95]
    v_mfma_f32_16x16x32_bf16 v[92:95], v[124:127], v[128:131], v[92:95]
    v_mfma_f32_16x16x32_bf16 v[64:67], v[160:163], v[192:195], v[64:67]
    s_mul_i32 m0, s64, 8448
    v_mfma_f32_16x16x32_bf16 v[68:71], v[160:163], v[196:199], v[68:71]
    buffer_load_dwordx4 a[76:79], v9, s[40:43], s25 offen offset:0 sc1
    v_mfma_f32_16x16x32_bf16 v[68:71], v[164:167], v[192:195], v[68:71]
    v_mfma_f32_16x16x32_bf16 v[72:75], v[160:163], v[200:203], v[72:75]
    ds_read_b128 v[96:99], v43 offset:39616
    v_mfma_f32_16x16x32_bf16 v[72:75], v[164:167], v[196:199], v[72:75]
    s_nop 0
    ds_write_addtid_b32 v64 offset:0
    v_mfma_f32_16x16x32_bf16 v[72:75], v[168:171], v[192:195], v[72:75]
    ds_read_b128 v[128:131], v44 offset:192
    ds_write_addtid_b32 v65 offset:264
    v_mfma_f32_16x16x32_bf16 v[76:79], v[160:163], v[204:207], v[76:79]
    ds_write_addtid_b32 v66 offset:528
    s_mov_b32 s25, 409600
    v_mfma_f32_16x16x32_bf16 v[76:79], v[164:167], v[200:203], v[76:79]
    ds_read_b128 v[100:103], v43 offset:39104
    ds_write_addtid_b32 v67 offset:792
    v_mfma_f32_16x16x32_bf16 v[76:79], v[168:171], v[196:199], v[76:79]
    ds_write_addtid_b32 v68 offset:1056
    buffer_load_dwordx4 a[80:83], v8, s[40:43], s25 offen offset:0 sc1
    v_mfma_f32_16x16x32_bf16 v[76:79], v[172:175], v[192:195], v[76:79]
    ds_read_b128 v[132:135], v44 offset:704
    s_waitcnt lgkmcnt(9)
    v_mfma_f32_16x16x32_bf16 v[80:83], v[160:163], v[208:211], v[80:83]
    ds_write_addtid_b32 v69 offset:1320
    v_mfma_f32_16x16x32_bf16 v[80:83], v[164:167], v[204:207], v[80:83]
    ds_read_b128 v[104:107], v43 offset:38592
    ds_write_addtid_b32 v70 offset:1584
    v_mfma_f32_16x16x32_bf16 v[80:83], v[168:171], v[200:203], v[80:83]
    ds_write_addtid_b32 v71 offset:1848
    buffer_load_dwordx4 a[84:87], v8, s[40:43], s25 offen offset:1024 sc1
    v_mfma_f32_16x16x32_bf16 v[80:83], v[172:175], v[196:199], v[80:83]
    ds_read_b128 v[136:139], v44 offset:1216
    ds_write_addtid_b32 v72 offset:2112
    v_mfma_f32_16x16x32_bf16 v[80:83], v[176:179], v[192:195], v[80:83]
    ds_read_b128 v[108:111], v43 offset:38080
    ds_write_addtid_b32 v73 offset:2376
    v_mfma_f32_16x16x32_bf16 v[84:87], v[160:163], v[212:215], v[84:87]
    ds_write_addtid_b32 v74 offset:2640
    buffer_load_dwordx4 a[88:91], v8, s[40:43], s25 offen offset:2048 sc1
    v_mfma_f32_16x16x32_bf16 v[84:87], v[164:167], v[208:211], v[84:87]
    ds_read_b128 v[140:143], v44 offset:1728
    ds_write_addtid_b32 v75 offset:2904
    v_mfma_f32_16x16x32_bf16 v[84:87], v[168:171], v[204:207], v[84:87]
    ds_write_addtid_b32 v76 offset:3168
    v_mfma_f32_16x16x32_bf16 v[84:87], v[172:175], v[200:203], v[84:87]
    ds_read_b128 v[112:115], v43 offset:37568
    ds_write_addtid_b32 v77 offset:3432
    v_mfma_f32_16x16x32_bf16 v[84:87], v[176:179], v[196:199], v[84:87]
    ds_write_addtid_b32 v78 offset:3696
    v_mfma_f32_16x16x32_bf16 v[84:87], v[180:183], v[192:195], v[84:87]
    ds_read_b128 v[144:147], v44 offset:2240
    ds_write_addtid_b32 v79 offset:3960
    v_mfma_f32_16x16x32_bf16 v[88:91], v[160:163], v[216:219], v[88:91]
    ds_write_addtid_b32 v80 offset:4224
    buffer_load_dwordx4 a[92:95], v8, s[40:43], s25 offen offset:3072 sc1
    v_mfma_f32_16x16x32_bf16 v[88:91], v[164:167], v[212:215], v[88:91]
    ds_read_b128 v[116:119], v43 offset:37056
    ds_write_addtid_b32 v81 offset:4488
    v_mfma_f32_16x16x32_bf16 v[88:91], v[168:171], v[208:211], v[88:91]
    ds_read_b128 v[148:151], v44 offset:2752
    ds_write_addtid_b32 v82 offset:4752
    v_mfma_f32_16x16x32_bf16 v[88:91], v[172:175], v[204:207], v[88:91]
    ds_write_addtid_b32 v83 offset:5016
    buffer_load_dwordx4 a[96:99], v9, s[40:43], s25 offen offset:0 sc1
    v_mfma_f32_16x16x32_bf16 v[88:91], v[176:179], v[200:203], v[88:91]
    ds_read_b128 v[120:123], v43 offset:36544
    ds_write_addtid_b32 v84 offset:5280
    v_mfma_f32_16x16x32_bf16 v[88:91], v[180:183], v[196:199], v[88:91]
    ds_write_addtid_b32 v85 offset:5544
    v_mfma_f32_16x16x32_bf16 v[88:91], v[184:187], v[192:195], v[88:91]
    ds_read_b128 v[152:155], v44 offset:3264
    ds_write_addtid_b32 v86 offset:5808
    v_mfma_f32_16x16x32_bf16 v[92:95], v[160:163], v[220:223], v[92:95]
    ds_write_addtid_b32 v87 offset:6072
    s_mov_b32 s25, 450560
    v_mfma_f32_16x16x32_bf16 v[92:95], v[164:167], v[216:219], v[92:95]
    ds_read_b128 v[124:127], v43 offset:36032
    buffer_load_dwordx4 a[100:103], v8, s[40:43], s25 offen offset:0 sc1
    v_mfma_f32_16x16x32_bf16 v[92:95], v[168:171], v[212:215], v[92:95]
    v_mfma_f32_16x16x32_bf16 v[92:95], v[172:175], v[208:211], v[92:95]
    ds_read_b128 v[156:159], v44 offset:3776
    ds_write_addtid_b32 v88 offset:6336
    v_mfma_f32_16x16x32_bf16 v[92:95], v[176:179], v[204:207], v[92:95]
    ds_write_addtid_b32 v89 offset:6600
    v_mfma_f32_16x16x32_bf16 v[92:95], v[180:183], v[200:203], v[92:95]
    ds_write_addtid_b32 v90 offset:6864
    buffer_load_dwordx4 a[104:107], v8, s[40:43], s25 offen offset:1024 sc1
    v_mfma_f32_16x16x32_bf16 v[92:95], v[184:187], v[196:199], v[92:95]
    ds_write_addtid_b32 v91 offset:7128
    v_mfma_f32_16x16x32_bf16 v[92:95], v[188:191], v[192:195], v[92:95]
    s_waitcnt lgkmcnt(15)
    v_mfma_f32_16x16x32_bf16 v[64:67], v[96:99], v[128:131], 0
    v_mfma_f32_16x16x32_bf16 v[68:71], v[96:99], v[132:135], 0
    ds_read_b128 v[160:163], v43 offset:39552
    v_mfma_f32_16x16x32_bf16 v[68:71], v[100:103], v[128:131], v[68:71]
    buffer_load_dwordx4 a[108:111], v8, s[40:43], s25 offen offset:2048 sc1
    v_mfma_f32_16x16x32_bf16 v[72:75], v[100:103], v[132:135], 0
    ds_read_b128 v[192:195], v44 offset:128
    ds_write_addtid_b32 v92 offset:7392
    v_mfma_f32_16x16x32_bf16 v[72:75], v[96:99], v[136:139], v[72:75]
    ds_write_addtid_b32 v93 offset:7656
    v_mfma_f32_16x16x32_bf16 v[72:75], v[104:107], v[128:131], v[72:75]
    ds_read_b128 v[164:167], v43 offset:39040
    ds_write_addtid_b32 v94 offset:7920
    v_mfma_f32_16x16x32_bf16 v[76:79], v[100:103], v[136:139], 0
    ds_write_addtid_b32 v95 offset:8184
    buffer_load_dwordx4 a[112:115], v8, s[40:43], s25 offen offset:3072 sc1
    v_mfma_f32_16x16x32_bf16 v[76:79], v[104:107], v[132:135], v[76:79]
    ds_read_b128 v[196:199], v44 offset:640
    s_waitcnt vmcnt(16)
    v_mfma_f32_16x16x32_bf16 v[80:83], v[104:107], v[136:139], 0
    v_mfma_f32_16x16x32_bf16 v[76:79], v[96:99], v[140:143], v[76:79]
    ds_read_b128 v[168:171], v43 offset:38528
    v_mfma_f32_16x16x32_bf16 v[76:79], v[108:111], v[128:131], v[76:79]
    s_waitcnt lgkmcnt(2)
    s_barrier
    v_mfma_f32_16x16x32_bf16 v[80:83], v[100:103], v[140:143], v[80:83]
    ds_read_b128 v[200:203], v44 offset:1152
    buffer_load_dwordx4 a[116:119], v9, s[40:43], s25 offen offset:0 sc1
    v_mfma_f32_16x16x32_bf16 v[80:83], v[108:111], v[132:135], v[80:83]
    s_lshl_b32 s77, s69, 7
    s_add_u32 s77, s77, 163840
    s_cmp_lg_u32 s64, 0
    s_cbranch_scc1 L_fs_27
    s_mov_b64 exec, 1
    buffer_store_dwordx2 v[22:23], v2, s[40:43], s77 offen sc1
    s_mov_b64 exec, -1
L_fs_27:
    v_mfma_f32_16x16x32_bf16 v[84:87], v[104:107], v[140:143], 0
    ds_read_b128 v[172:175], v43 offset:38016
    ds_read_b64 v[24:25], v45 offset:0
    v_mfma_f32_16x16x32_bf16 v[84:87], v[108:111], v[136:139], v[84:87]
    ds_read_b64 v[26:27], v45 offset:128
    s_mov_b32 s25, 163840
    v_mfma_f32_16x16x32_bf16 v[88:91], v[108:111], v[140:143], 0
    ds_read_b128 v[204:207], v44 offset:1664
    v_mfma_f32_16x16x32_bf16 v[80:83], v[96:99], v[144:147], v[80:83]
    ds_read_b64 v[28:29], v45 offset:8
    buffer_load_dwordx4 v[232:235], v9, s[40:43], s25 offen offset:0 sc1
    v_mfma_f32_16x16x32_bf16 v[80:83], v[112:115], v[128:131], v[80:83]
    ds_read_b128 v[176:179], v43 offset:37504
    ds_read_b64 v[30:31], v45 offset:136
    v_mfma_f32_16x16x32_bf16 v[84:87], v[100:103], v[144:147], v[84:87]
    ds_read_b64 v[32:33], v45 offset:8448
    ds_read_b64 v[34:35], v45 offset:8576
    v_mfma_f32_16x16x32_bf16 v[84:87], v[112:115], v[132:135], v[84:87]
    ds_read_b128 v[208:211], v44 offset:2176
    ds_read_b64 v[36:37], v45 offset:8456
    v_mfma_f32_16x16x32_bf16 v[88:91], v[104:107], v[144:147], v[88:91]
    ds_read_b64 v[38:39], v45 offset:8584
    s_mov_b32 s25, 204800
    s_lshl_b32 s24, s69, 2
    v_mfma_f32_16x16x32_bf16 v[88:91], v[112:115], v[136:139], v[88:91]
    ds_read_b128 v[180:183], v43 offset:36992
    s_add_u32 s24, s24, s64
    s_lshl_b32 s24, s24, 11
    v_mfma_f32_16x16x32_bf16 v[92:95], v[108:111], v[144:147], 0
    s_add_u32 s24, s24, 8658944
    buffer_load_dwordx4 v[236:239], v8, s[40:43], s25 offen offset:0 sc1
    v_mfma_f32_16x16x32_bf16 v[92:95], v[112:115], v[140:143], v[92:95]
    ds_read_b128 v[212:215], v44 offset:2688
    v_mfma_f32_16x16x32_bf16 v[84:87], v[96:99], v[148:151], v[84:87]
    v_mfma_f32_16x16x32_bf16 v[84:87], v[116:119], v[128:131], v[84:87]
    ds_read_b128 v[184:187], v43 offset:36480
    buffer_load_dwordx4 v[240:243], v8, s[40:43], s25 offen offset:1024 sc1
    v_mfma_f32_16x16x32_bf16 v[88:91], v[100:103], v[148:151], v[88:91]
    v_mfma_f32_16x16x32_bf16 v[88:91], v[116:119], v[132:135], v[88:91]
    ds_read_b128 v[216:219], v44 offset:3200
    s_waitcnt lgkmcnt(4)
    v_add_f32 v24, v24, v32
    v_mfma_f32_16x16x32_bf16 v[92:95], v[104:107], v[148:151], v[92:95]
    v_add_f32 v25, v25, v33
    v_add_f32 v26, v26, v34
    v_add_f32_e64 v27, v27, v35
    v_mfma_f32_16x16x32_bf16 v[92:95], v[116:119], v[136:139], v[92:95]
    ds_read_b128 v[188:191], v43 offset:35968
    buffer_load_dwordx4 v[244:247], v8, s[40:43], s25 offen offset:2048 sc1
    v_mfma_f32_16x16x32_bf16 v[88:91], v[96:99], v[152:155], v[88:91]
    v_add_f32 v28, v28, v36
    v_add_f32 v29, v29, v37
    v_add_f32_e64 v30, v30, v38
    v_mfma_f32_16x16x32_bf16 v[88:91], v[120:123], v[128:131], v[88:91]
    ds_read_b128 v[220:223], v44 offset:3712
    v_add_f32_e64 v31, v31, v39
    v_mfma_f32_16x16x32_bf16 v[92:95], v[100:103], v[152:155], v[92:95]
    v_cvt_pk_bf16_f32 v48, v24, v26
    v_cvt_pk_bf16_f32 v49, v28, v30
    v_cvt_pk_bf16_f32 v50, v25, v27
    v_mfma_f32_16x16x32_bf16 v[92:95], v[120:123], v[132:135], v[92:95]
    v_cvt_pk_bf16_f32 v51, v29, v31
    v_mfma_f32_16x16x32_bf16 v[92:95], v[96:99], v[156:159], v[92:95]
    ds_read_b64 v[24:25], v45 offset:2112
    buffer_load_dwordx4 v[248:251], v8, s[40:43], s25 offen offset:3072 sc1
    v_mfma_f32_16x16x32_bf16 v[92:95], v[124:127], v[128:131], v[92:95]
    ds_read_b64 v[26:27], v45 offset:2240
    v_mfma_f32_16x16x32_bf16 v[64:67], v[160:163], v[192:195], v[64:67]
    ds_read_b64 v[28:29], v45 offset:2120
    ds_read_b64 v[30:31], v45 offset:2248
    v_mfma_f32_16x16x32_bf16 v[68:71], v[160:163], v[196:199], v[68:71]
    ds_read_b128 v[96:99], v43 offset:39488
    ds_read_b64 v[32:33], v45 offset:10560
    v_mfma_f32_16x16x32_bf16 v[68:71], v[164:167], v[192:195], v[68:71]
    ds_read_b64 v[34:35], v45 offset:10688
    buffer_load_dwordx4 v[252:255], v9, s[40:43], s25 offen offset:0 sc1
    v_mfma_f32_16x16x32_bf16 v[72:75], v[164:167], v[196:199], v[72:75]
    ds_read_b128 v[128:131], v44 offset:64
    ds_read_b64 v[36:37], v45 offset:10568
    v_mfma_f32_16x16x32_bf16 v[72:75], v[160:163], v[200:203], v[72:75]
    ds_read_b64 v[38:39], v45 offset:10696
    buffer_store_dwordx4 v[48:51], v2, s[40:43], s24 offen offset:0 sc1
    v_mfma_f32_16x16x32_bf16 v[72:75], v[168:171], v[192:195], v[72:75]
    ds_read_b128 v[100:103], v43 offset:38976
    v_mfma_f32_16x16x32_bf16 v[76:79], v[164:167], v[200:203], v[76:79]
    s_mov_b32 s25, 491520
    v_or_b32 v8, s94, v8
    v_or_b32 v9, s94, v9
    v_mfma_f32_16x16x32_bf16 v[76:79], v[168:171], v[196:199], v[76:79]
    ds_read_b128 v[132:135], v44 offset:576
    buffer_load_dwordx4 a[120:123], v8, s[40:43], s25 offen offset:0 sc1
    v_mfma_f32_16x16x32_bf16 v[80:83], v[168:171], v[200:203], v[80:83]
    v_mfma_f32_16x16x32_bf16 v[76:79], v[160:163], v[204:207], v[76:79]
    ds_read_b128 v[104:107], v43 offset:38464
    s_waitcnt lgkmcnt(3)
    v_add_f32 v24, v24, v32
    v_mfma_f32_16x16x32_bf16 v[76:79], v[172:175], v[192:195], v[76:79]
    v_add_f32 v25, v25, v33
    v_add_f32 v26, v26, v34
    v_add_f32_e64 v27, v27, v35
    v_mfma_f32_16x16x32_bf16 v[80:83], v[164:167], v[204:207], v[80:83]
    ds_read_b128 v[136:139], v44 offset:1088
    buffer_load_dwordx4 a[124:127], v8, s[40:43], s25 offen offset:1024 sc1
    v_mfma_f32_16x16x32_bf16 v[80:83], v[172:175], v[196:199], v[80:83]
    v_add_f32 v28, v28, v36
    v_add_f32 v29, v29, v37
    v_add_f32_e64 v30, v30, v38
    v_mfma_f32_16x16x32_bf16 v[84:87], v[168:171], v[204:207], v[84:87]
    ds_read_b128 v[108:111], v43 offset:37952
    v_add_f32_e64 v31, v31, v39
    v_mfma_f32_16x16x32_bf16 v[84:87], v[172:175], v[200:203], v[84:87]
    v_cvt_pk_bf16_f32 v52, v24, v26
    v_cvt_pk_bf16_f32 v53, v28, v30
    v_cvt_pk_bf16_f32 v54, v25, v27
    v_mfma_f32_16x16x32_bf16 v[88:91], v[172:175], v[204:207], v[88:91]
    ds_read_b128 v[140:143], v44 offset:1600
    v_cvt_pk_bf16_f32 v55, v29, v31
    v_mfma_f32_16x16x32_bf16 v[80:83], v[160:163], v[208:211], v[80:83]
    buffer_store_dwordx4 v[52:55], v2, s[40:43], s24 offen offset:1024 sc1
    buffer_load_dwordx4 a[128:131], v8, s[40:43], s25 offen offset:2048 sc1
    v_mfma_f32_16x16x32_bf16 v[80:83], v[176:179], v[192:195], v[80:83]
    ds_read_b128 v[112:115], v43 offset:37440
    v_mfma_f32_16x16x32_bf16 v[84:87], v[164:167], v[208:211], v[84:87]
    v_mfma_f32_16x16x32_bf16 v[84:87], v[176:179], v[196:199], v[84:87]
    ds_read_b128 v[144:147], v44 offset:2112
    s_barrier
    v_mfma_f32_16x16x32_bf16 v[88:91], v[168:171], v[208:211], v[88:91]
    buffer_load_dwordx4 a[132:135], v8, s[40:43], s25 offen offset:3072 sc1
    v_mfma_f32_16x16x32_bf16 v[88:91], v[176:179], v[200:203], v[88:91]
    ds_read_b128 v[116:119], v43 offset:36928
    v_mfma_f32_16x16x32_bf16 v[92:95], v[172:175], v[208:211], v[92:95]
    v_mfma_f32_16x16x32_bf16 v[92:95], v[176:179], v[204:207], v[92:95]
    ds_read_b128 v[148:151], v44 offset:2624
    v_mfma_f32_16x16x32_bf16 v[84:87], v[160:163], v[212:215], v[84:87]
    v_mfma_f32_16x16x32_bf16 v[84:87], v[180:183], v[192:195], v[84:87]
    ds_read_b128 v[120:123], v43 offset:36416
    buffer_load_dwordx4 a[136:139], v9, s[40:43], s25 offen offset:0 sc1
    v_mfma_f32_16x16x32_bf16 v[88:91], v[164:167], v[212:215], v[88:91]
    v_mfma_f32_16x16x32_bf16 v[88:91], v[180:183], v[196:199], v[88:91]
    ds_read_b128 v[152:155], v44 offset:3136
    v_mfma_f32_16x16x32_bf16 v[92:95], v[168:171], v[212:215], v[92:95]
    s_mov_b32 s25, 532480
    v_mfma_f32_16x16x32_bf16 v[92:95], v[180:183], v[200:203], v[92:95]
    ds_read_b128 v[124:127], v43 offset:35904
    buffer_load_dwordx2 v[20:21], v18, s[40:43], 0 offen sc1
    v_mfma_f32_16x16x32_bf16 v[88:91], v[160:163], v[216:219], v[88:91]
    v_mfma_f32_16x16x32_bf16 v[88:91], v[184:187], v[192:195], v[88:91]
    ds_read_b128 v[156:159], v44 offset:3648
    buffer_load_dwordx4 a[140:143], v8, s[40:43], s25 offen offset:0 sc1
    v_mfma_f32_16x16x32_bf16 v[92:95], v[164:167], v[216:219], v[92:95]
    v_mfma_f32_16x16x32_bf16 v[92:95], v[184:187], v[196:199], v[92:95]
    v_mfma_f32_16x16x32_bf16 v[92:95], v[160:163], v[220:223], v[92:95]
    v_mfma_f32_16x16x32_bf16 v[92:95], v[188:191], v[192:195], v[92:95]
    buffer_load_dwordx4 a[144:147], v8, s[40:43], s25 offen offset:1024 sc1
    s_waitcnt lgkmcnt(8)
    v_mfma_f32_16x16x32_bf16 v[64:67], v[96:99], v[128:131], v[64:67]
    v_mfma_f32_16x16x32_bf16 v[68:71], v[96:99], v[132:135], v[68:71]
    ds_read_b128 v[160:163], v43 offset:39424
    v_mfma_f32_16x16x32_bf16 v[68:71], v[100:103], v[128:131], v[68:71]
    v_mfma_f32_16x16x32_bf16 v[72:75], v[100:103], v[132:135], v[72:75]
    ds_read_b128 v[192:195], v44 offset:0
    v_mfma_f32_16x16x32_bf16 v[72:75], v[96:99], v[136:139], v[72:75]
    buffer_load_dwordx4 a[148:151], v8, s[40:43], s25 offen offset:2048 sc1
    v_mfma_f32_16x16x32_bf16 v[72:75], v[104:107], v[128:131], v[72:75]
    ds_read_b128 v[164:167], v43 offset:38912
    v_mfma_f32_16x16x32_bf16 v[76:79], v[100:103], v[136:139], v[76:79]
    v_mfma_f32_16x16x32_bf16 v[76:79], v[104:107], v[132:135], v[76:79]
    ds_read_b128 v[196:199], v44 offset:512
    v_mfma_f32_16x16x32_bf16 v[80:83], v[104:107], v[136:139], v[80:83]
    buffer_load_dwordx4 a[152:155], v8, s[40:43], s25 offen offset:3072 sc1
    v_mfma_f32_16x16x32_bf16 v[76:79], v[96:99], v[140:143], v[76:79]
    ds_read_b128 v[168:171], v43 offset:38400
    v_mfma_f32_16x16x32_bf16 v[76:79], v[108:111], v[128:131], v[76:79]
    v_mfma_f32_16x16x32_bf16 v[80:83], v[100:103], v[140:143], v[80:83]
    ds_read_b128 v[200:203], v44 offset:1024
    v_mfma_f32_16x16x32_bf16 v[80:83], v[108:111], v[132:135], v[80:83]
    v_mfma_f32_16x16x32_bf16 v[84:87], v[104:107], v[140:143], v[84:87]
    ds_read_b128 v[172:175], v43 offset:37888
    buffer_load_dwordx4 a[156:159], v9, s[40:43], s25 offen offset:0 sc1
    v_mfma_f32_16x16x32_bf16 v[84:87], v[108:111], v[136:139], v[84:87]
    v_mfma_f32_16x16x32_bf16 v[88:91], v[108:111], v[140:143], v[88:91]
    ds_read_b128 v[204:207], v44 offset:1536
    s_waitcnt lgkmcnt(8)
    v_mfma_f32_16x16x32_bf16 v[80:83], v[96:99], v[144:147], v[80:83]
    v_mfma_f32_16x16x32_bf16 v[80:83], v[112:115], v[128:131], v[80:83]
    ds_read_b128 v[176:179], v43 offset:37376
    v_mfma_f32_16x16x32_bf16 v[84:87], v[100:103], v[144:147], v[84:87]
    v_mfma_f32_16x16x32_bf16 v[84:87], v[112:115], v[132:135], v[84:87]
    ds_read_b128 v[208:211], v44 offset:2048
    v_mfma_f32_16x16x32_bf16 v[88:91], v[104:107], v[144:147], v[88:91]
    v_mfma_f32_16x16x32_bf16 v[88:91], v[112:115], v[136:139], v[88:91]
    ds_read_b128 v[180:183], v43 offset:36864
    v_mfma_f32_16x16x32_bf16 v[92:95], v[108:111], v[144:147], v[92:95]
    v_mfma_f32_16x16x32_bf16 v[92:95], v[112:115], v[140:143], v[92:95]
    ds_read_b128 v[212:215], v44 offset:2560
    v_mfma_f32_16x16x32_bf16 v[84:87], v[96:99], v[148:151], v[84:87]
    v_mfma_f32_16x16x32_bf16 v[84:87], v[116:119], v[128:131], v[84:87]
    ds_read_b128 v[184:187], v43 offset:36352
    v_mfma_f32_16x16x32_bf16 v[88:91], v[100:103], v[148:151], v[88:91]
    v_mfma_f32_16x16x32_bf16 v[88:91], v[116:119], v[132:135], v[88:91]
    ds_read_b128 v[216:219], v44 offset:3072
    v_mfma_f32_16x16x32_bf16 v[92:95], v[104:107], v[148:151], v[92:95]
    v_mfma_f32_16x16x32_bf16 v[92:95], v[116:119], v[136:139], v[92:95]
    ds_read_b128 v[188:191], v43 offset:35840
    v_mfma_f32_16x16x32_bf16 v[88:91], v[96:99], v[152:155], v[88:91]
    v_mfma_f32_16x16x32_bf16 v[88:91], v[120:123], v[128:131], v[88:91]
    ds_read_b128 v[220:223], v44 offset:3584
    v_mfma_f32_16x16x32_bf16 v[92:95], v[100:103], v[152:155], v[92:95]
    v_mfma_f32_16x16x32_bf16 v[92:95], v[120:123], v[132:135], v[92:95]
    v_mfma_f32_16x16x32_bf16 v[92:95], v[96:99], v[156:159], v[92:95]
    v_mfma_f32_16x16x32_bf16 v[92:95], v[124:127], v[128:131], v[92:95]
    s_waitcnt lgkmcnt(8)
    v_mfma_f32_16x16x32_bf16 v[64:67], v[160:163], v[192:195], v[64:67]
    s_mul_i32 m0, s64, 8448
    v_mfma_f32_16x16x32_bf16 v[68:71], v[160:163], v[196:199], v[68:71]
    s_waitcnt vmcnt(5)
    v_cmp_ne_u64_e64 vcc, s[70:71], v[20:21]
    s_cbranch_vccnz L_poll_29
L_ok_28:
    v_mfma_f32_16x16x32_bf16 v[68:71], v[164:167], v[192:195], v[68:71]
    s_mov_b32 s95, 0
    buffer_load_dwordx4 v[96:99], v10, s[40:43], s95 offen offset:0 sc1
    v_mfma_f32_16x16x32_bf16 v[72:75], v[160:163], v[200:203], v[72:75]
    v_mfma_f32_16x16x32_bf16 v[72:75], v[164:167], v[196:199], v[72:75]
    ds_write_addtid_b32 v64 offset:0
    buffer_load_dwordx4 v[100:103], v10, s[40:43], s95 offen offset:1024 sc1
    v_mfma_f32_16x16x32_bf16 v[72:75], v[168:171], v[192:195], v[72:75]
    ds_write_addtid_b32 v65 offset:264
    v_mfma_f32_16x16x32_bf16 v[76:79], v[160:163], v[204:207], v[76:79]
    ds_write_addtid_b32 v66 offset:528
    v_mfma_f32_16x16x32_bf16 v[76:79], v[164:167], v[200:203], v[76:79]
    ds_write_addtid_b32 v67 offset:792
    buffer_load_dwordx4 v[104:107], v10, s[40:43], s95 offen offset:2048 sc1
    v_mfma_f32_16x16x32_bf16 v[76:79], v[168:171], v[196:199], v[76:79]
    ds_write_addtid_b32 v68 offset:1056
    v_mfma_f32_16x16x32_bf16 v[76:79], v[172:175], v[192:195], v[76:79]
    ds_write_addtid_b32 v69 offset:1320
    s_waitcnt lgkmcnt(6)
    v_mfma_f32_16x16x32_bf16 v[80:83], v[160:163], v[208:211], v[80:83]
    ds_write_addtid_b32 v70 offset:1584
    buffer_load_dwordx4 v[108:111], v10, s[40:43], s95 offen offset:3072 sc1
    v_mfma_f32_16x16x32_bf16 v[80:83], v[164:167], v[204:207], v[80:83]
    ds_write_addtid_b32 v71 offset:1848
    v_mfma_f32_16x16x32_bf16 v[80:83], v[168:171], v[200:203], v[80:83]
    ds_write_addtid_b32 v72 offset:2112
    v_mfma_f32_16x16x32_bf16 v[80:83], v[172:175], v[196:199], v[80:83]
    ds_write_addtid_b32 v73 offset:2376
    s_mov_b32 s95, 4096
    v_mfma_f32_16x16x32_bf16 v[80:83], v[176:179], v[192:195], v[80:83]
    ds_write_addtid_b32 v74 offset:2640
    buffer_load_dwordx4 v[112:115], v10, s[40:43], s95 offen offset:0 sc1
    v_mfma_f32_16x16x32_bf16 v[84:87], v[160:163], v[212:215], v[84:87]
    ds_write_addtid_b32 v75 offset:2904
    v_mfma_f32_16x16x32_bf16 v[84:87], v[164:167], v[208:211], v[84:87]
    ds_write_addtid_b32 v76 offset:3168
    v_mfma_f32_16x16x32_bf16 v[84:87], v[168:171], v[204:207], v[84:87]
    ds_write_addtid_b32 v77 offset:3432
    buffer_load_dwordx4 v[116:119], v10, s[40:43], s95 offen offset:1024 sc1
    v_mfma_f32_16x16x32_bf16 v[84:87], v[172:175], v[200:203], v[84:87]
    ds_write_addtid_b32 v78 offset:3696
    v_mfma_f32_16x16x32_bf16 v[84:87], v[176:179], v[196:199], v[84:87]
    ds_write_addtid_b32 v79 offset:3960
    v_mfma_f32_16x16x32_bf16 v[84:87], v[180:183], v[192:195], v[84:87]
    ds_write_addtid_b32 v80 offset:4224
    buffer_load_dwordx4 v[120:123], v10, s[40:43], s95 offen offset:2048 sc1
    v_mfma_f32_16x16x32_bf16 v[88:91], v[160:163], v[216:219], v[88:91]
    ds_write_addtid_b32 v81 offset:4488
    v_mfma_f32_16x16x32_bf16 v[88:91], v[164:167], v[212:215], v[88:91]
    ds_write_addtid_b32 v82 offset:4752
    v_mfma_f32_16x16x32_bf16 v[88:91], v[168:171], v[208:211], v[88:91]
    ds_write_addtid_b32 v83 offset:5016
    v_mfma_f32_16x16x32_bf16 v[88:91], v[172:175], v[204:207], v[88:91]
    ds_write_addtid_b32 v84 offset:5280
    buffer_load_dwordx4 v[124:127], v10, s[40:43], s95 offen offset:3072 sc1
    v_mfma_f32_16x16x32_bf16 v[88:91], v[176:179], v[200:203], v[88:91]
    ds_write_addtid_b32 v85 offset:5544
    v_mfma_f32_16x16x32_bf16 v[88:91], v[180:183], v[196:199], v[88:91]
    ds_write_addtid_b32 v86 offset:5808
    s_mov_b32 s95, 8192
    v_mfma_f32_16x16x32_bf16 v[88:91], v[184:187], v[192:195], v[88:91]
    ds_write_addtid_b32 v87 offset:6072
    buffer_load_dwordx4 v[128:131], v10, s[40:43], s95 offen offset:0 sc1
    v_mfma_f32_16x16x32_bf16 v[92:95], v[160:163], v[220:223], v[92:95]
    v_mfma_f32_16x16x32_bf16 v[92:95], v[164:167], v[216:219], v[92:95]
    v_mfma_f32_16x16x32_bf16 v[92:95], v[168:171], v[212:215], v[92:95]
    buffer_load_dwordx4 v[132:135], v10, s[40:43], s95 offen offset:1024 sc1
    v_mfma_f32_16x16x32_bf16 v[92:95], v[172:175], v[208:211], v[92:95]
    s_nop 0
    ds_write_addtid_b32 v88 offset:6336
    v_mfma_f32_16x16x32_bf16 v[92:95], v[176:179], v[204:207], v[92:95]
    ds_write_addtid_b32 v89 offset:6600
    v_mfma_f32_16x16x32_bf16 v[92:95], v[180:183], v[200:203], v[92:95]
    ds_write_addtid_b32 v90 offset:6864
    v_mfma_f32_16x16x32_bf16 v[92:95], v[184:187], v[196:199], v[92:95]
    ds_write_addtid_b32 v91 offset:7128
    v_mfma_f32_16x16x32_bf16 v[92:95], v[188:191], v[192:195], v[92:95]
    s_nop 7
    ds_write_addtid_b32 v92 offset:7392
    ds_write_addtid_b32 v93 offset:7656
    ds_write_addtid_b32 v94 offset:7920
    ds_write_addtid_b32 v95 offset:8184
    s_barrier
    s_lshl_b32 s77, s69, 7
    s_add_u32 s77, s77, 163968
    s_cmp_lg_u32 s64, 0
    s_cbranch_scc1 L_fs_31
    s_mov_b64 exec, 1
    buffer_store_dwordx2 v[22:23], v2, s[40:43], s77 offen sc1
    s_mov_b64 exec, -1
L_fs_31:
    s_add_u32 s69, s69, 2
    s_branch L_join
L_spend:
L_poll_22:
    s_mov_b32 s81, 0
L_poll_22_l:
    s_sleep 2
    buffer_load_dwordx2 v[20:21], v47, s[40:43], 0 offen sc1
    s_add_u32 s81, s81, 1
    s_waitcnt vmcnt(0)
    v_cmp_ne_u64 vcc, s[70:71], v[20:21]
    s_cbranch_vccz L_ok_21
    s_cmp_lt_u32 s81, 32768
    s_cbranch_scc1 L_poll_22_l
    s_branch L_ok_21
L_poll_29:
    s_mov_b32 s81, 0
L_poll_29_l:
    s_sleep 2
    buffer_load_dwordx2 v[20:21], v18, s[40:43], 0 offen sc1
    s_add_u32 s81, s81, 1
    s_waitcnt vmcnt(0)
    v_cmp_ne_u64 vcc, s[70:71], v[20:21]
    s_cbranch_vccz L_ok_28
    s_cmp_lt_u32 s81, 32768
    s_cbranch_scc1 L_poll_29_l
    s_branch L_ok_28
L_ret:
    s_mov_b64 exec, -1
    s_branch L_back_m
    s_endpgm
.section .rodata,"a"
.p2align 6
.amdhsa_kernel recurrent_scan__ssm_conv_s4__dense_activation_gelu__prompt_kernel
  .amdhsa_next_free_vgpr 512
  .amdhsa_next_free_sgpr 102
  .amdhsa_accum_offset 256
  .amdhsa_group_segment_fixed_size 0
  .amdhsa_kernarg_size 136
  .amdhsa_user_sgpr_count 2
  .amdhsa_user_sgpr_kernarg_segment_ptr 1
  .amdhsa_system_sgpr_workgroup_id_x 1
.end_amdhsa_kernel
```
